```python
import torch

def _softmax(x, axis=-1):
    return torch.softmax(x, dim=axis)
def _gelu(x):
    return torch.nn.functional.gelu(x, approximate="tanh")
def _silu(x):
    return torch.nn.functional.silu(x)
def _sigmoid(x):
    return torch.sigmoid(x)
def _layernorm(x, axis=-1, eps=1e-5):
    m = x.mean(dim=axis, keepdim=True)
    v = x.var(dim=axis, keepdim=True, unbiased=False)
    return (x - m) / torch.sqrt(v + eps)
def _scatter_add(tgt, idx, src, axis=0):
    return tgt.clone().index_add_(axis, idx, src)
def _segment_sum(src, seg, n):
    out = torch.zeros((n,) + src.shape[1:], dtype=src.dtype)
    return out.index_add_(0, seg, src)
def _pad(x, pw):
    flat = tuple(v for pair in reversed(pw) for v in pair)
    return torch.nn.functional.pad(x, flat)

kernel_name = 'recurrent_scan__mha_block__glu_gated_geglu__prompt'

def setup_inputs():

    _w = (lambda a: (lambda t: t.to(torch.bfloat16) if t.is_floating_point() else t)(torch.as_tensor(a)))
    def _A_setup():
        B, S, D, H = 1, 2048, 640, 32
        return {
            "x": _w((lambda *s: torch.randn(*s, dtype=torch.bfloat16) * 0.05)(B, S, D)),
            "wqkv": _w((lambda *s: torch.randn(*s, dtype=torch.bfloat16) * 0.2)(D, 3 * D)),
            "wo": _w((lambda *s: torch.randn(*s, dtype=torch.bfloat16) * 0.2)(D, D)),
        }
    _A_in = _A_setup()

    def _B_setup():
        B, S, Dm, Df = 1, 2048, 640, 1728
        return {
            "x": _w((lambda *s: torch.randn(*s, dtype=torch.bfloat16) * 0.05)(B, S, Dm)),
            "w_gate": _w((lambda *s: torch.randn(*s, dtype=torch.bfloat16) * 0.1)(Dm, Df) * (Dm ** -0.5)),
            "w_up": _w((lambda *s: torch.randn(*s, dtype=torch.bfloat16) * 0.1)(Dm, Df) * (Dm ** -0.5)),
            "w_down": _w((lambda *s: torch.randn(*s, dtype=torch.bfloat16) * 0.1)(Df, Dm) * (Df ** -0.5)),
        }
    _B_in = _B_setup()

    return {
        "A_x": _A_in["x"],
        "A_wqkv": _A_in["wqkv"],
        "A_wo": _A_in["wo"],
        "B_x": _B_in["x"],
        "B_w_gate": _B_in["w_gate"],
        "B_w_up": _B_in["w_up"],
        "B_w_down": _B_in["w_down"],
    }

def reference(A_x, A_wqkv, A_wo, B_x, B_w_gate, B_w_up, B_w_down):
    def _A_ref(x, wqkv, wo):
        B, S, D = x.shape
        H = 32
        Dh = D // H
        qkv = (lambda x, *d: x.permute(*d))((x @ wqkv).reshape(B, S, 3, H, Dh), 2, 0, 3, 1, 4)
        q, k, v = qkv[0], qkv[1], qkv[2]
        scores = torch.einsum("bhqd,bhkd->bhqk", q, k) * (Dh ** -0.5)
        p = _softmax(scores, axis=-1)
        o = torch.einsum("bhqk,bhkd->bhqd", p, v)
        return (lambda x, *d: x.permute(*d))(o, 0, 2, 1, 3).reshape(B, S, D) @ wo

    def _B_ref(x, w_gate, w_up, w_down):
        g = torch.einsum("bsd,df->bsf", x, w_gate)
        u = torch.einsum("bsd,df->bsf", x, w_up)
        h = _gelu(g) * u
        return torch.einsum("bsf,fd->bsd", h, w_down)

    x = A_x
    xn = _layernorm(x, axis=-1)
    s = _A_ref(xn, A_wqkv, A_wo)
    g = _silu(_B_ref(xn, B_w_gate, B_w_up, B_w_down))
    return x + s * g
```

```asm
; @launch kernel=k12_kernel grid=(256,1,1) block=(768,1,1) lds=163840
; @launch kernel=k3_kernel grid=(256,1,1) block=(256,1,1) lds=72704
.amdgcn_target "amdgcn-amd-amdhsa--gfx950"
.text
.globl k12_kernel
.p2align 8
.type k12_kernel,@function
k12_kernel:
    s_cmp_ge_u32 s2, 256
    s_cbranch_scc1 L_k12_end
    s_load_dwordx4 s[16:19], s[0:1], 0
    s_load_dwordx4 s[20:23], s[0:1], 16
    s_load_dwordx4 s[24:27], s[0:1], 32
    s_load_dwordx2 s[28:29], s[0:1], 48
    s_load_dwordx2 s[30:31], s[0:1], 72
    s_load_dwordx2 s[60:61], s[0:1], 64
    v_and_b32 v155, 63, v0
    v_lshrrev_b32 v1, 6, v0
    s_nop 0
    v_readfirstlane_b32 s32, v1
    s_nop 0
    s_and_b32 s33, s32, 3
    s_lshr_b32 s34, s32, 2
    s_cmp_lg_u32 s32, 7
    s_cbranch_scc1 L_nopf_1
    s_getpc_b64 s[82:83]
L_pc_2:
    s_sub_u32 s82, s82, L_pc_2 - k12_kernel
    s_subb_u32 s83, s83, 0
    v_lshlrev_b32 v1, 7, v155
    v_min_u32 v3, L_k1_codeend - k12_kernel - 4, v1
    global_load_dword v2, v3, s[82:83]
    v_add_u32 v1, 8192, v1
    v_min_u32 v3, L_k1_codeend - k12_kernel - 4, v1
    global_load_dword v2, v3, s[82:83]
    v_add_u32 v1, 8192, v1
    v_min_u32 v3, L_k1_codeend - k12_kernel - 4, v1
    global_load_dword v2, v3, s[82:83]
    v_add_u32 v1, 8192, v1
    v_min_u32 v3, L_k1_codeend - k12_kernel - 4, v1
    global_load_dword v2, v3, s[82:83]
    v_add_u32 v1, 8192, v1
    v_min_u32 v3, L_k1_codeend - k12_kernel - 4, v1
    global_load_dword v2, v3, s[82:83]
L_nopf_1:
    s_and_b32 s46, s2, 7
    s_lshr_b32 s47, s2, 3
    s_and_b32 s35, s46, 1
    s_lshl_b32 s35, s35, 2
    s_and_b32 s52, s47, 3
    s_add_u32 s35, s35, s52
    s_lshr_b32 s53, s46, 1
    s_lshr_b32 s54, s47, 2
    s_cmp_ge_u32 s53, 2
    s_cselect_b32 s46, 1, 0
    s_sub_u32 s54, s54, s46
    s_and_b32 s54, s54, 7
    s_lshl_b32 s36, s54, 2
    s_add_u32 s36, s36, s53
    s_waitcnt lgkmcnt(0)
    s_mov_b32 s4, s16
    s_mov_b32 s5, s17
    s_mov_b32 s6, 2621440
    s_mov_b32 s7, 0x20000
    s_mov_b32 s12, s30
    s_mov_b32 s13, s31
    s_mov_b32 s14, 0x2000000
    s_mov_b32 s15, 0x20000
    s_mov_b32 s62, 256
    s_mov_b32 s63, 0x20000
    s_cmp_ge_u32 s36, 30
    s_cbranch_scc1 L_k1_T
    s_cmp_ge_u32 s36, 12
    s_cbranch_scc1 L_k1_G
    s_mov_b32 s8, s18
    s_mov_b32 s9, s19
    s_mov_b32 s10, 2457600
    s_mov_b32 s11, 0x20000
    s_lshr_b32 s51, s36, 2
    s_cmp_eq_u32 s51, 0
    s_cselect_b32 s55, 0x3ea52b5c, 1.0
    s_cmp_ge_u32 s32, 8
    s_cbranch_scc1 L_k1_Qld
    v_and_b32 v156, 15, v155
    v_lshrrev_b32 v157, 4, v155
    v_lshrrev_b32 v158, 1, v156
    v_xor_b32 v158, v158, v157
    v_lshlrev_b32 v158, 4, v158
    v_lshl_add_u32 v158, v156, 7, v158
    s_lshl_b32 s46, s33, 13
    v_add_u32 v148, s46, v158
    v_xor_b32 v149, 64, v148
    v_lshrrev_b32 v158, 2, v156
    v_lshl_add_u32 v158, v157, 3, v158
    v_mul_u32_u24 v158, 320, v158
    v_and_b32 v159, 3, v155
    v_lshl_add_u32 v158, v159, 3, v158
    s_mul_i32 s46, s34, 5
    s_lshl_b32 s47, s46, 5
    s_add_u32 s47, s47, 98304
    v_add_u32 v158, s47, v158
    v_and_b32 v159, 1, v157
    v_lshlrev_b32 v159, 5, v159
    v_add_u32 v160, v158, v159
    v_sub_u32 v161, v158, v159
    s_and_b32 s46, s46, 1
    s_cmp_eq_u32 s46, 0
    s_cselect_b64 vcc, -1, 0
    v_cndmask_b32 v151, v161, v160, vcc
    v_cndmask_b32 v152, v160, v161, vcc
    v_mov_b32 v4, 0
    v_mov_b32 v5, 0
    v_mov_b32 v6, 0
    v_mov_b32 v7, 0
    v_mov_b32 v8, 0
    v_mov_b32 v9, 0
    v_mov_b32 v10, 0
    v_mov_b32 v11, 0
    v_mov_b32 v12, 0
    v_mov_b32 v13, 0
    v_mov_b32 v14, 0
    v_mov_b32 v15, 0
    v_mov_b32 v16, 0
    v_mov_b32 v17, 0
    v_mov_b32 v18, 0
    v_mov_b32 v19, 0
    v_mov_b32 v20, 0
    v_mov_b32 v21, 0
    v_mov_b32 v22, 0
    v_mov_b32 v23, 0
    v_mov_b32 v24, 0
    v_mov_b32 v25, 0
    v_mov_b32 v26, 0
    v_mov_b32 v27, 0
    v_mov_b32 v28, 0
    v_mov_b32 v29, 0
    v_mov_b32 v30, 0
    v_mov_b32 v31, 0
    v_mov_b32 v32, 0
    v_mov_b32 v33, 0
    v_mov_b32 v34, 0
    v_mov_b32 v35, 0
    v_mov_b32 v36, 0
    v_mov_b32 v37, 0
    v_mov_b32 v38, 0
    v_mov_b32 v39, 0
    v_mov_b32 v40, 0
    v_mov_b32 v41, 0
    v_mov_b32 v42, 0
    v_mov_b32 v43, 0
    v_mov_b32 v44, 0
    v_mov_b32 v45, 0
    v_mov_b32 v46, 0
    v_mov_b32 v47, 0
    v_mov_b32 v48, 0
    v_mov_b32 v49, 0
    v_mov_b32 v50, 0
    v_mov_b32 v51, 0
    v_mov_b32 v52, 0
    v_mov_b32 v53, 0
    v_mov_b32 v54, 0
    v_mov_b32 v55, 0
    v_mov_b32 v56, 0
    v_mov_b32 v57, 0
    v_mov_b32 v58, 0
    v_mov_b32 v59, 0
    v_mov_b32 v60, 0
    v_mov_b32 v61, 0
    v_mov_b32 v62, 0
    v_mov_b32 v63, 0
    v_mov_b32 v64, 0
    v_mov_b32 v65, 0
    v_mov_b32 v66, 0
    v_mov_b32 v67, 0
    v_mov_b32 v68, 0
    v_mov_b32 v69, 0
    v_mov_b32 v70, 0
    v_mov_b32 v71, 0
    v_mov_b32 v72, 0
    v_mov_b32 v73, 0
    v_mov_b32 v74, 0
    v_mov_b32 v75, 0
    v_mov_b32 v76, 0
    v_mov_b32 v77, 0
    v_mov_b32 v78, 0
    v_mov_b32 v79, 0
    v_mov_b32 v80, 0
    v_mov_b32 v81, 0
    v_mov_b32 v82, 0
    v_mov_b32 v83, 0
    s_mul_i32 s53, s34, 40960
    v_and_b32 v100, 15, v155
    v_lshrrev_b32 v101, 4, v155
    s_cmp_eq_u32 s51, 1
    s_cbranch_scc1 L_aK_3
    s_cmp_eq_u32 s51, 2
    s_cbranch_scc1 L_aV_4
    v_add_u32 v102, 0, v101
    v_mul_u32_u24 v103, 52429, v102
    v_lshrrev_b32 v103, 18, v103
    v_mul_u32_u24 v104, 5, v103
    v_sub_u32 v104, v102, v104
    v_mul_u32_u24 v103, 10240, v103
    v_lshl_add_u32 v103, v104, 3, v103
    v_mul_u32_u24 v104, 40, v100
    v_add_u32 v156, v103, v104
    v_add_u32 v102, 4, v101
    v_mul_u32_u24 v103, 52429, v102
    v_lshrrev_b32 v103, 18, v103
    v_mul_u32_u24 v104, 5, v103
    v_sub_u32 v104, v102, v104
    v_mul_u32_u24 v103, 10240, v103
    v_lshl_add_u32 v103, v104, 3, v103
    v_mul_u32_u24 v104, 40, v100
    v_add_u32 v157, v103, v104
    v_add_u32 v102, 8, v101
    v_mul_u32_u24 v103, 52429, v102
    v_lshrrev_b32 v103, 18, v103
    v_mul_u32_u24 v104, 5, v103
    v_sub_u32 v104, v102, v104
    v_mul_u32_u24 v103, 10240, v103
    v_lshl_add_u32 v103, v104, 3, v103
    v_mul_u32_u24 v104, 40, v100
    v_add_u32 v158, v103, v104
    v_add_u32 v102, 12, v101
    v_mul_u32_u24 v103, 52429, v102
    v_lshrrev_b32 v103, 18, v103
    v_mul_u32_u24 v104, 5, v103
    v_sub_u32 v104, v102, v104
    v_mul_u32_u24 v103, 10240, v103
    v_lshl_add_u32 v103, v104, 3, v103
    v_mul_u32_u24 v104, 40, v100
    v_add_u32 v159, v103, v104
    v_add_u32 v102, 16, v101
    v_mul_u32_u24 v103, 52429, v102
    v_lshrrev_b32 v103, 18, v103
    v_mul_u32_u24 v104, 5, v103
    v_sub_u32 v104, v102, v104
    v_mul_u32_u24 v103, 10240, v103
    v_lshl_add_u32 v103, v104, 3, v103
    v_mul_u32_u24 v104, 40, v100
    v_add_u32 v160, v103, v104
    s_mul_i32 s46, s33, 2560
    s_add_u32 s46, s46, s53
    v_add_u32 v156, s46, v156
    v_add_u32 v157, s46, v157
    v_add_u32 v158, s46, v158
    v_add_u32 v159, s46, v159
    v_add_u32 v160, s46, v160
    s_branch L_aEnd_5
L_aK_3:
    v_and_b32 v105, 3, v100
    v_bfe_u32 v102, v100, 2, 1
    v_lshl_or_b32 v105, v102, 3, v105
    v_bfe_u32 v102, v100, 3, 1
    v_lshl_or_b32 v105, v102, 2, v105
    v_add_u32 v102, 0, v101
    v_mul_u32_u24 v103, 52429, v102
    v_lshrrev_b32 v103, 18, v103
    v_mul_u32_u24 v104, 5, v103
    v_sub_u32 v104, v102, v104
    v_mul_u32_u24 v103, 10240, v103
    v_lshrrev_b32 v102, 1, v104
    v_lshl_add_u32 v103, v102, 9, v103
    v_and_b32 v102, 1, v104
    v_lshl_add_u32 v103, v102, 3, v103
    v_cmp_eq_u32 vcc, 4, v104
    v_mov_b32 v102, 4
    v_mov_b32 v104, 3
    v_cndmask_b32 v102, v102, v104, vcc
    v_lshlrev_b32 v104, v102, v105
    v_add_u32 v156, v103, v104
    v_mov_b32 v104, 16
    v_lshlrev_b32 v104, v102, v104
    v_add_u32 v161, v156, v104
    v_add_u32 v102, 4, v101
    v_mul_u32_u24 v103, 52429, v102
    v_lshrrev_b32 v103, 18, v103
    v_mul_u32_u24 v104, 5, v103
    v_sub_u32 v104, v102, v104
    v_mul_u32_u24 v103, 10240, v103
    v_lshrrev_b32 v102, 1, v104
    v_lshl_add_u32 v103, v102, 9, v103
    v_and_b32 v102, 1, v104
    v_lshl_add_u32 v103, v102, 3, v103
    v_cmp_eq_u32 vcc, 4, v104
    v_mov_b32 v102, 4
    v_mov_b32 v104, 3
    v_cndmask_b32 v102, v102, v104, vcc
    v_lshlrev_b32 v104, v102, v105
    v_add_u32 v157, v103, v104
    v_mov_b32 v104, 16
    v_lshlrev_b32 v104, v102, v104
    v_add_u32 v162, v157, v104
    v_add_u32 v102, 8, v101
    v_mul_u32_u24 v103, 52429, v102
    v_lshrrev_b32 v103, 18, v103
    v_mul_u32_u24 v104, 5, v103
    v_sub_u32 v104, v102, v104
    v_mul_u32_u24 v103, 10240, v103
    v_lshrrev_b32 v102, 1, v104
    v_lshl_add_u32 v103, v102, 9, v103
    v_and_b32 v102, 1, v104
    v_lshl_add_u32 v103, v102, 3, v103
    v_cmp_eq_u32 vcc, 4, v104
    v_mov_b32 v102, 4
    v_mov_b32 v104, 3
    v_cndmask_b32 v102, v102, v104, vcc
    v_lshlrev_b32 v104, v102, v105
    v_add_u32 v158, v103, v104
    v_mov_b32 v104, 16
    v_lshlrev_b32 v104, v102, v104
    v_add_u32 v163, v158, v104
    v_add_u32 v102, 12, v101
    v_mul_u32_u24 v103, 52429, v102
    v_lshrrev_b32 v103, 18, v103
    v_mul_u32_u24 v104, 5, v103
    v_sub_u32 v104, v102, v104
    v_mul_u32_u24 v103, 10240, v103
    v_lshrrev_b32 v102, 1, v104
    v_lshl_add_u32 v103, v102, 9, v103
    v_and_b32 v102, 1, v104
    v_lshl_add_u32 v103, v102, 3, v103
    v_cmp_eq_u32 vcc, 4, v104
    v_mov_b32 v102, 4
    v_mov_b32 v104, 3
    v_cndmask_b32 v102, v102, v104, vcc
    v_lshlrev_b32 v104, v102, v105
    v_add_u32 v159, v103, v104
    v_mov_b32 v104, 16
    v_lshlrev_b32 v104, v102, v104
    v_add_u32 v164, v159, v104
    v_add_u32 v102, 16, v101
    v_mul_u32_u24 v103, 52429, v102
    v_lshrrev_b32 v103, 18, v103
    v_mul_u32_u24 v104, 5, v103
    v_sub_u32 v104, v102, v104
    v_mul_u32_u24 v103, 10240, v103
    v_lshrrev_b32 v102, 1, v104
    v_lshl_add_u32 v103, v102, 9, v103
    v_and_b32 v102, 1, v104
    v_lshl_add_u32 v103, v102, 3, v103
    v_cmp_eq_u32 vcc, 4, v104
    v_mov_b32 v102, 4
    v_mov_b32 v104, 3
    v_cndmask_b32 v102, v102, v104, vcc
    v_lshlrev_b32 v104, v102, v105
    v_add_u32 v160, v103, v104
    v_mov_b32 v104, 16
    v_lshlrev_b32 v104, v102, v104
    v_add_u32 v165, v160, v104
    s_mul_i32 s46, s33, 2560
    s_add_u32 s46, s46, s53
    v_add_u32 v156, s46, v156
    v_add_u32 v157, s46, v157
    v_add_u32 v158, s46, v158
    v_add_u32 v159, s46, v159
    v_add_u32 v160, s46, v160
    v_add_u32 v161, s46, v161
    v_add_u32 v162, s46, v162
    v_add_u32 v163, s46, v163
    v_add_u32 v164, s46, v164
    v_add_u32 v165, s46, v165
    s_branch L_aEnd_5
L_aV_4:
    v_add_u32 v102, 0, v100
    v_mul_u32_u24 v103, 52429, v102
    v_lshrrev_b32 v103, 20, v103
    v_mul_u32_u24 v104, 20, v103
    v_sub_u32 v104, v102, v104
    v_mul_u32_u24 v103, 10240, v103
    v_lshl_add_u32 v103, v104, 4, v103
    v_lshrrev_b32 v102, 1, v101
    v_mul_u32_u24 v102, 320, v102
    v_add_u32 v103, v103, v102
    v_and_b32 v102, 1, v101
    v_lshl_add_u32 v156, v102, 3, v103
    v_add_u32 v102, 16, v100
    v_mul_u32_u24 v103, 52429, v102
    v_lshrrev_b32 v103, 20, v103
    v_mul_u32_u24 v104, 20, v103
    v_sub_u32 v104, v102, v104
    v_mul_u32_u24 v103, 10240, v103
    v_lshl_add_u32 v103, v104, 4, v103
    v_lshrrev_b32 v102, 1, v101
    v_mul_u32_u24 v102, 320, v102
    v_add_u32 v103, v103, v102
    v_and_b32 v102, 1, v101
    v_lshl_add_u32 v157, v102, 3, v103
    v_add_u32 v102, 32, v100
    v_mul_u32_u24 v103, 52429, v102
    v_lshrrev_b32 v103, 20, v103
    v_mul_u32_u24 v104, 20, v103
    v_sub_u32 v104, v102, v104
    v_mul_u32_u24 v103, 10240, v103
    v_lshl_add_u32 v103, v104, 4, v103
    v_lshrrev_b32 v102, 1, v101
    v_mul_u32_u24 v102, 320, v102
    v_add_u32 v103, v103, v102
    v_and_b32 v102, 1, v101
    v_lshl_add_u32 v158, v102, 3, v103
    v_add_u32 v102, 48, v100
    v_mul_u32_u24 v103, 52429, v102
    v_lshrrev_b32 v103, 20, v103
    v_mul_u32_u24 v104, 20, v103
    v_sub_u32 v104, v102, v104
    v_mul_u32_u24 v103, 10240, v103
    v_lshl_add_u32 v103, v104, 4, v103
    v_lshrrev_b32 v102, 1, v101
    v_mul_u32_u24 v102, 320, v102
    v_add_u32 v103, v103, v102
    v_and_b32 v102, 1, v101
    v_lshl_add_u32 v159, v102, 3, v103
    v_add_u32 v102, 64, v100
    v_mul_u32_u24 v103, 52429, v102
    v_lshrrev_b32 v103, 20, v103
    v_mul_u32_u24 v104, 20, v103
    v_sub_u32 v104, v102, v104
    v_mul_u32_u24 v103, 10240, v103
    v_lshl_add_u32 v103, v104, 4, v103
    v_lshrrev_b32 v102, 1, v101
    v_mul_u32_u24 v102, 320, v102
    v_add_u32 v103, v103, v102
    v_and_b32 v102, 1, v101
    v_lshl_add_u32 v160, v102, 3, v103
    s_mul_i32 s46, s33, 2560
    s_add_u32 s46, s46, s53
    v_add_u32 v156, s46, v156
    v_add_u32 v157, s46, v157
    v_add_u32 v158, s46, v158
    v_add_u32 v159, s46, v159
    v_add_u32 v160, s46, v160
L_aEnd_5:
    s_cmp_eq_u32 s51, 2
    s_cbranch_scc1 L_k1_V
    s_barrier
    s_mov_b32 s48, 0
    s_mov_b32 s38, 0
    s_mov_b32 s37, 0
    ds_read_b128 v[100:103], v148 offset:0
    ds_read_b128 v[104:107], v148 offset:2048
    ds_read_b128 v[108:111], v148 offset:4096
    ds_read_b128 v[112:115], v148 offset:6144
    v_mov_b32 v153, v151
    v_mov_b32 v154, v152
    ds_read_b64_tr_b16 v[132:133], v153 offset:0
    ds_read_b64_tr_b16 v[134:135], v153 offset:1280
    ds_read_b64_tr_b16 v[136:137], v154 offset:32
    ds_read_b64_tr_b16 v[138:139], v154 offset:1312
L_k1q_cl:
    v_add_u32 v150, s48, v149
    ds_read_b64_tr_b16 v[140:141], v153 offset:64
    ds_read_b64_tr_b16 v[142:143], v153 offset:1344
    ds_read_b128 v[116:119], v150 offset:0
    ds_read_b128 v[120:123], v150 offset:2048
    s_waitcnt lgkmcnt(6)
    v_mfma_f32_16x16x32_bf16 v[4:7], v[132:135], v[100:103], v[4:7]
    v_mfma_f32_16x16x32_bf16 v[24:27], v[132:135], v[104:107], v[24:27]
    v_mfma_f32_16x16x32_bf16 v[44:47], v[132:135], v[108:111], v[44:47]
    v_mfma_f32_16x16x32_bf16 v[64:67], v[132:135], v[112:115], v[64:67]
    ds_read_b64_tr_b16 v[144:145], v154 offset:96
    ds_read_b64_tr_b16 v[146:147], v154 offset:1376
    ds_read_b128 v[124:127], v150 offset:4096
    ds_read_b128 v[128:131], v150 offset:6144
    s_waitcnt lgkmcnt(8)
    v_mfma_f32_16x16x32_bf16 v[8:11], v[136:139], v[100:103], v[8:11]
    v_mfma_f32_16x16x32_bf16 v[28:31], v[136:139], v[104:107], v[28:31]
    v_mfma_f32_16x16x32_bf16 v[48:51], v[136:139], v[108:111], v[48:51]
    v_mfma_f32_16x16x32_bf16 v[68:71], v[136:139], v[112:115], v[68:71]
    ds_read_b64_tr_b16 v[132:133], v153 offset:128
    ds_read_b64_tr_b16 v[134:135], v153 offset:1408
    s_waitcnt lgkmcnt(8)
    v_mfma_f32_16x16x32_bf16 v[12:15], v[140:143], v[100:103], v[12:15]
    v_mfma_f32_16x16x32_bf16 v[32:35], v[140:143], v[104:107], v[32:35]
    v_mfma_f32_16x16x32_bf16 v[52:55], v[140:143], v[108:111], v[52:55]
    v_mfma_f32_16x16x32_bf16 v[72:75], v[140:143], v[112:115], v[72:75]
    s_waitcnt lgkmcnt(0)
    s_barrier
    s_add_u32 s38, s38, 12288
    s_cmp_eq_u32 s38, 61440
    s_cselect_b32 s38, 0, s38
    v_add_u32 v153, s38, v151
    v_add_u32 v154, s38, v152
    ds_read_b64_tr_b16 v[136:137], v153 offset:0
    ds_read_b64_tr_b16 v[138:139], v153 offset:1280
    v_mfma_f32_16x16x32_bf16 v[16:19], v[144:147], v[100:103], v[16:19]
    v_mfma_f32_16x16x32_bf16 v[36:39], v[144:147], v[104:107], v[36:39]
    v_mfma_f32_16x16x32_bf16 v[56:59], v[144:147], v[108:111], v[56:59]
    v_mfma_f32_16x16x32_bf16 v[76:79], v[144:147], v[112:115], v[76:79]
    ds_read_b64_tr_b16 v[140:141], v154 offset:32
    ds_read_b64_tr_b16 v[142:143], v154 offset:1312
    v_mfma_f32_16x16x32_bf16 v[20:23], v[132:135], v[100:103], v[20:23]
    v_mfma_f32_16x16x32_bf16 v[40:43], v[132:135], v[104:107], v[40:43]
    v_mfma_f32_16x16x32_bf16 v[60:63], v[132:135], v[108:111], v[60:63]
    v_mfma_f32_16x16x32_bf16 v[80:83], v[132:135], v[112:115], v[80:83]
    s_add_u32 s48, s48, 32768
    s_cmp_eq_u32 s48, 98304
    s_cselect_b32 s48, 0, s48
    v_add_u32 v150, s48, v148
    ds_read_b64_tr_b16 v[144:145], v153 offset:64
    ds_read_b64_tr_b16 v[146:147], v153 offset:1344
    ds_read_b128 v[100:103], v150 offset:0
    ds_read_b128 v[104:107], v150 offset:2048
    s_waitcnt lgkmcnt(6)
    v_mfma_f32_16x16x32_bf16 v[4:7], v[136:139], v[116:119], v[4:7]
    v_mfma_f32_16x16x32_bf16 v[24:27], v[136:139], v[120:123], v[24:27]
    v_mfma_f32_16x16x32_bf16 v[44:47], v[136:139], v[124:127], v[44:47]
    v_mfma_f32_16x16x32_bf16 v[64:67], v[136:139], v[128:131], v[64:67]
    ds_read_b64_tr_b16 v[132:133], v154 offset:96
    ds_read_b64_tr_b16 v[134:135], v154 offset:1376
    ds_read_b128 v[108:111], v150 offset:4096
    ds_read_b128 v[112:115], v150 offset:6144
    s_waitcnt lgkmcnt(8)
    v_mfma_f32_16x16x32_bf16 v[8:11], v[140:143], v[116:119], v[8:11]
    v_mfma_f32_16x16x32_bf16 v[28:31], v[140:143], v[120:123], v[28:31]
    v_mfma_f32_16x16x32_bf16 v[48:51], v[140:143], v[124:127], v[48:51]
    v_mfma_f32_16x16x32_bf16 v[68:71], v[140:143], v[128:131], v[68:71]
    ds_read_b64_tr_b16 v[136:137], v153 offset:128
    ds_read_b64_tr_b16 v[138:139], v153 offset:1408
    s_waitcnt lgkmcnt(8)
    v_mfma_f32_16x16x32_bf16 v[12:15], v[144:147], v[116:119], v[12:15]
    v_mfma_f32_16x16x32_bf16 v[32:35], v[144:147], v[120:123], v[32:35]
    v_mfma_f32_16x16x32_bf16 v[52:55], v[144:147], v[124:127], v[52:55]
    v_mfma_f32_16x16x32_bf16 v[72:75], v[144:147], v[128:131], v[72:75]
    s_waitcnt lgkmcnt(0)
    s_barrier
    s_add_u32 s38, s38, 12288
    s_cmp_eq_u32 s38, 61440
    s_cselect_b32 s38, 0, s38
    v_add_u32 v153, s38, v151
    v_add_u32 v154, s38, v152
    ds_read_b64_tr_b16 v[140:141], v153 offset:0
    ds_read_b64_tr_b16 v[142:143], v153 offset:1280
    v_mfma_f32_16x16x32_bf16 v[16:19], v[132:135], v[116:119], v[16:19]
    v_mfma_f32_16x16x32_bf16 v[36:39], v[132:135], v[120:123], v[36:39]
    v_mfma_f32_16x16x32_bf16 v[56:59], v[132:135], v[124:127], v[56:59]
    v_mfma_f32_16x16x32_bf16 v[76:79], v[132:135], v[128:131], v[76:79]
    ds_read_b64_tr_b16 v[144:145], v154 offset:32
    ds_read_b64_tr_b16 v[146:147], v154 offset:1312
    v_mfma_f32_16x16x32_bf16 v[20:23], v[136:139], v[116:119], v[20:23]
    v_mfma_f32_16x16x32_bf16 v[40:43], v[136:139], v[120:123], v[40:43]
    v_mfma_f32_16x16x32_bf16 v[60:63], v[136:139], v[124:127], v[60:63]
    v_mfma_f32_16x16x32_bf16 v[80:83], v[136:139], v[128:131], v[80:83]
    v_add_u32 v150, s48, v149
    ds_read_b64_tr_b16 v[132:133], v153 offset:64
    ds_read_b64_tr_b16 v[134:135], v153 offset:1344
    ds_read_b128 v[116:119], v150 offset:0
    ds_read_b128 v[120:123], v150 offset:2048
    s_waitcnt lgkmcnt(6)
    v_mfma_f32_16x16x32_bf16 v[4:7], v[140:143], v[100:103], v[4:7]
    v_mfma_f32_16x16x32_bf16 v[24:27], v[140:143], v[104:107], v[24:27]
    v_mfma_f32_16x16x32_bf16 v[44:47], v[140:143], v[108:111], v[44:47]
    v_mfma_f32_16x16x32_bf16 v[64:67], v[140:143], v[112:115], v[64:67]
    ds_read_b64_tr_b16 v[136:137], v154 offset:96
    ds_read_b64_tr_b16 v[138:139], v154 offset:1376
    ds_read_b128 v[124:127], v150 offset:4096
    ds_read_b128 v[128:131], v150 offset:6144
    s_waitcnt lgkmcnt(8)
    v_mfma_f32_16x16x32_bf16 v[8:11], v[144:147], v[100:103], v[8:11]
    v_mfma_f32_16x16x32_bf16 v[28:31], v[144:147], v[104:107], v[28:31]
    v_mfma_f32_16x16x32_bf16 v[48:51], v[144:147], v[108:111], v[48:51]
    v_mfma_f32_16x16x32_bf16 v[68:71], v[144:147], v[112:115], v[68:71]
    ds_read_b64_tr_b16 v[140:141], v153 offset:128
    ds_read_b64_tr_b16 v[142:143], v153 offset:1408
    s_waitcnt lgkmcnt(8)
    v_mfma_f32_16x16x32_bf16 v[12:15], v[132:135], v[100:103], v[12:15]
    v_mfma_f32_16x16x32_bf16 v[32:35], v[132:135], v[104:107], v[32:35]
    v_mfma_f32_16x16x32_bf16 v[52:55], v[132:135], v[108:111], v[52:55]
    v_mfma_f32_16x16x32_bf16 v[72:75], v[132:135], v[112:115], v[72:75]
    s_waitcnt lgkmcnt(0)
    s_barrier
    s_add_u32 s38, s38, 12288
    s_cmp_eq_u32 s38, 61440
    s_cselect_b32 s38, 0, s38
    v_add_u32 v153, s38, v151
    v_add_u32 v154, s38, v152
    ds_read_b64_tr_b16 v[144:145], v153 offset:0
    ds_read_b64_tr_b16 v[146:147], v153 offset:1280
    v_mfma_f32_16x16x32_bf16 v[16:19], v[136:139], v[100:103], v[16:19]
    v_mfma_f32_16x16x32_bf16 v[36:39], v[136:139], v[104:107], v[36:39]
    v_mfma_f32_16x16x32_bf16 v[56:59], v[136:139], v[108:111], v[56:59]
    v_mfma_f32_16x16x32_bf16 v[76:79], v[136:139], v[112:115], v[76:79]
    ds_read_b64_tr_b16 v[132:133], v154 offset:32
    ds_read_b64_tr_b16 v[134:135], v154 offset:1312
    v_mfma_f32_16x16x32_bf16 v[20:23], v[140:143], v[100:103], v[20:23]
    v_mfma_f32_16x16x32_bf16 v[40:43], v[140:143], v[104:107], v[40:43]
    v_mfma_f32_16x16x32_bf16 v[60:63], v[140:143], v[108:111], v[60:63]
    v_mfma_f32_16x16x32_bf16 v[80:83], v[140:143], v[112:115], v[80:83]
    s_add_u32 s48, s48, 32768
    s_cmp_eq_u32 s48, 98304
    s_cselect_b32 s48, 0, s48
    v_add_u32 v150, s48, v148
    ds_read_b64_tr_b16 v[136:137], v153 offset:64
    ds_read_b64_tr_b16 v[138:139], v153 offset:1344
    ds_read_b128 v[100:103], v150 offset:0
    ds_read_b128 v[104:107], v150 offset:2048
    s_waitcnt lgkmcnt(6)
    v_mfma_f32_16x16x32_bf16 v[4:7], v[144:147], v[116:119], v[4:7]
    v_mfma_f32_16x16x32_bf16 v[24:27], v[144:147], v[120:123], v[24:27]
    v_mfma_f32_16x16x32_bf16 v[44:47], v[144:147], v[124:127], v[44:47]
    v_mfma_f32_16x16x32_bf16 v[64:67], v[144:147], v[128:131], v[64:67]
    ds_read_b64_tr_b16 v[140:141], v154 offset:96
    ds_read_b64_tr_b16 v[142:143], v154 offset:1376
    ds_read_b128 v[108:111], v150 offset:4096
    ds_read_b128 v[112:115], v150 offset:6144
    s_waitcnt lgkmcnt(8)
    v_mfma_f32_16x16x32_bf16 v[8:11], v[132:135], v[116:119], v[8:11]
    v_mfma_f32_16x16x32_bf16 v[28:31], v[132:135], v[120:123], v[28:31]
    v_mfma_f32_16x16x32_bf16 v[48:51], v[132:135], v[124:127], v[48:51]
    v_mfma_f32_16x16x32_bf16 v[68:71], v[132:135], v[128:131], v[68:71]
    ds_read_b64_tr_b16 v[144:145], v153 offset:128
    ds_read_b64_tr_b16 v[146:147], v153 offset:1408
    s_waitcnt lgkmcnt(8)
    v_mfma_f32_16x16x32_bf16 v[12:15], v[136:139], v[116:119], v[12:15]
    v_mfma_f32_16x16x32_bf16 v[32:35], v[136:139], v[120:123], v[32:35]
    v_mfma_f32_16x16x32_bf16 v[52:55], v[136:139], v[124:127], v[52:55]
    v_mfma_f32_16x16x32_bf16 v[72:75], v[136:139], v[128:131], v[72:75]
    s_waitcnt lgkmcnt(0)
    s_barrier
    s_add_u32 s38, s38, 12288
    s_cmp_eq_u32 s38, 61440
    s_cselect_b32 s38, 0, s38
    v_add_u32 v153, s38, v151
    v_add_u32 v154, s38, v152
    ds_read_b64_tr_b16 v[132:133], v153 offset:0
    ds_read_b64_tr_b16 v[134:135], v153 offset:1280
    v_mfma_f32_16x16x32_bf16 v[16:19], v[140:143], v[116:119], v[16:19]
    v_mfma_f32_16x16x32_bf16 v[36:39], v[140:143], v[120:123], v[36:39]
    v_mfma_f32_16x16x32_bf16 v[56:59], v[140:143], v[124:127], v[56:59]
    v_mfma_f32_16x16x32_bf16 v[76:79], v[140:143], v[128:131], v[76:79]
    ds_read_b64_tr_b16 v[136:137], v154 offset:32
    ds_read_b64_tr_b16 v[138:139], v154 offset:1312
    v_mfma_f32_16x16x32_bf16 v[20:23], v[144:147], v[116:119], v[20:23]
    v_mfma_f32_16x16x32_bf16 v[40:43], v[144:147], v[120:123], v[40:43]
    v_mfma_f32_16x16x32_bf16 v[60:63], v[144:147], v[124:127], v[60:63]
    v_mfma_f32_16x16x32_bf16 v[80:83], v[144:147], v[128:131], v[80:83]
    s_add_u32 s37, s37, 1
    s_cmp_lt_u32 s37, 5
    s_cbranch_scc1 L_k1q_cl
    s_waitcnt lgkmcnt(0)
    s_barrier
    v_and_b32 v140, 15, v155
    v_lshlrev_b32 v140, 3, v140
    s_lshl_b32 s46, s33, 9
    s_add_u32 s46, s46, 159744
    v_add_u32 v140, s46, v140
    ds_read_b64 v[100:101], v140 offset:0
    ds_read_b64 v[104:105], v140 offset:128
    ds_read_b64 v[108:109], v140 offset:256
    ds_read_b64 v[112:113], v140 offset:384
    v_lshrrev_b32 v141, 4, v155
    v_lshlrev_b32 v141, 4, v141
    s_mul_i32 s46, s34, 320
    s_add_u32 s46, s46, 161792
    v_add_u32 v141, s46, v141
    ds_read_b128 v[116:119], v141 offset:0
    ds_read_b128 v[120:123], v141 offset:64
    ds_read_b128 v[124:127], v141 offset:128
    ds_read_b128 v[128:131], v141 offset:192
    ds_read_b128 v[132:135], v141 offset:256
    s_waitcnt lgkmcnt(0)
    v_mul_f32 v101, s55, v101
    v_mul_f32 v105, s55, v105
    v_mul_f32 v109, s55, v109
    v_mul_f32 v113, s55, v113
    v_lshlrev_b32 v140, 4, v155
    s_lshl_b32 s46, s32, 10
    v_add_u32 v141, s46, v140
    v_add_u32 v142, 65536, v141
    s_and_b32 s46, s36, 3
    s_mul_i32 s54, s46, 655360
    s_mul_i32 s46, s35, 10240
    s_add_u32 s54, s54, s46
    s_cmp_eq_u32 s51, 1
    s_cbranch_scc1 L_eK_6
    v_pk_fma_f32 v[4:5], v[100:101], v[116:117], v[4:5] op_sel:[0,0,0] op_sel_hi:[0,1,1]
    v_pk_fma_f32 v[6:7], v[100:101], v[118:119], v[6:7] op_sel:[0,0,0] op_sel_hi:[0,1,1]
    v_pk_mul_f32 v[4:5], v[4:5], v[100:101] op_sel:[0,1] op_sel_hi:[1,1]
    v_pk_mul_f32 v[6:7], v[6:7], v[100:101] op_sel:[0,1] op_sel_hi:[1,1]
    v_cvt_pk_bf16_f32 v4, v4, v5
    v_cvt_pk_bf16_f32 v5, v6, v7
    ds_write_b64 v156, v[4:5] offset:0
    v_pk_fma_f32 v[8:9], v[100:101], v[120:121], v[8:9] op_sel:[0,0,0] op_sel_hi:[0,1,1]
    v_pk_fma_f32 v[10:11], v[100:101], v[122:123], v[10:11] op_sel:[0,0,0] op_sel_hi:[0,1,1]
    v_pk_mul_f32 v[8:9], v[8:9], v[100:101] op_sel:[0,1] op_sel_hi:[1,1]
    v_pk_mul_f32 v[10:11], v[10:11], v[100:101] op_sel:[0,1] op_sel_hi:[1,1]
    v_cvt_pk_bf16_f32 v8, v8, v9
    v_cvt_pk_bf16_f32 v9, v10, v11
    ds_write_b64 v157, v[8:9] offset:0
    v_pk_fma_f32 v[12:13], v[100:101], v[124:125], v[12:13] op_sel:[0,0,0] op_sel_hi:[0,1,1]
    v_pk_fma_f32 v[14:15], v[100:101], v[126:127], v[14:15] op_sel:[0,0,0] op_sel_hi:[0,1,1]
    v_pk_mul_f32 v[12:13], v[12:13], v[100:101] op_sel:[0,1] op_sel_hi:[1,1]
    v_pk_mul_f32 v[14:15], v[14:15], v[100:101] op_sel:[0,1] op_sel_hi:[1,1]
    v_cvt_pk_bf16_f32 v12, v12, v13
    v_cvt_pk_bf16_f32 v13, v14, v15
    ds_write_b64 v158, v[12:13] offset:0
    v_pk_fma_f32 v[16:17], v[100:101], v[128:129], v[16:17] op_sel:[0,0,0] op_sel_hi:[0,1,1]
    v_pk_fma_f32 v[18:19], v[100:101], v[130:131], v[18:19] op_sel:[0,0,0] op_sel_hi:[0,1,1]
    v_pk_mul_f32 v[16:17], v[16:17], v[100:101] op_sel:[0,1] op_sel_hi:[1,1]
    v_pk_mul_f32 v[18:19], v[18:19], v[100:101] op_sel:[0,1] op_sel_hi:[1,1]
    v_cvt_pk_bf16_f32 v16, v16, v17
    v_cvt_pk_bf16_f32 v17, v18, v19
    ds_write_b64 v159, v[16:17] offset:0
    v_pk_fma_f32 v[20:21], v[100:101], v[132:133], v[20:21] op_sel:[0,0,0] op_sel_hi:[0,1,1]
    v_pk_fma_f32 v[22:23], v[100:101], v[134:135], v[22:23] op_sel:[0,0,0] op_sel_hi:[0,1,1]
    v_pk_mul_f32 v[20:21], v[20:21], v[100:101] op_sel:[0,1] op_sel_hi:[1,1]
    v_pk_mul_f32 v[22:23], v[22:23], v[100:101] op_sel:[0,1] op_sel_hi:[1,1]
    v_cvt_pk_bf16_f32 v20, v20, v21
    v_cvt_pk_bf16_f32 v21, v22, v23
    ds_write_b64 v160, v[20:21] offset:0
    v_pk_fma_f32 v[24:25], v[104:105], v[116:117], v[24:25] op_sel:[0,0,0] op_sel_hi:[0,1,1]
    v_pk_fma_f32 v[26:27], v[104:105], v[118:119], v[26:27] op_sel:[0,0,0] op_sel_hi:[0,1,1]
    v_pk_mul_f32 v[24:25], v[24:25], v[104:105] op_sel:[0,1] op_sel_hi:[1,1]
    v_pk_mul_f32 v[26:27], v[26:27], v[104:105] op_sel:[0,1] op_sel_hi:[1,1]
    v_cvt_pk_bf16_f32 v24, v24, v25
    v_cvt_pk_bf16_f32 v25, v26, v27
    ds_write_b64 v156, v[24:25] offset:640
    v_pk_fma_f32 v[28:29], v[104:105], v[120:121], v[28:29] op_sel:[0,0,0] op_sel_hi:[0,1,1]
    v_pk_fma_f32 v[30:31], v[104:105], v[122:123], v[30:31] op_sel:[0,0,0] op_sel_hi:[0,1,1]
    v_pk_mul_f32 v[28:29], v[28:29], v[104:105] op_sel:[0,1] op_sel_hi:[1,1]
    v_pk_mul_f32 v[30:31], v[30:31], v[104:105] op_sel:[0,1] op_sel_hi:[1,1]
    v_cvt_pk_bf16_f32 v28, v28, v29
    v_cvt_pk_bf16_f32 v29, v30, v31
    ds_write_b64 v157, v[28:29] offset:640
    v_pk_fma_f32 v[32:33], v[104:105], v[124:125], v[32:33] op_sel:[0,0,0] op_sel_hi:[0,1,1]
    v_pk_fma_f32 v[34:35], v[104:105], v[126:127], v[34:35] op_sel:[0,0,0] op_sel_hi:[0,1,1]
    v_pk_mul_f32 v[32:33], v[32:33], v[104:105] op_sel:[0,1] op_sel_hi:[1,1]
    v_pk_mul_f32 v[34:35], v[34:35], v[104:105] op_sel:[0,1] op_sel_hi:[1,1]
    v_cvt_pk_bf16_f32 v32, v32, v33
    v_cvt_pk_bf16_f32 v33, v34, v35
    ds_write_b64 v158, v[32:33] offset:640
    v_pk_fma_f32 v[36:37], v[104:105], v[128:129], v[36:37] op_sel:[0,0,0] op_sel_hi:[0,1,1]
    v_pk_fma_f32 v[38:39], v[104:105], v[130:131], v[38:39] op_sel:[0,0,0] op_sel_hi:[0,1,1]
    v_pk_mul_f32 v[36:37], v[36:37], v[104:105] op_sel:[0,1] op_sel_hi:[1,1]
    v_pk_mul_f32 v[38:39], v[38:39], v[104:105] op_sel:[0,1] op_sel_hi:[1,1]
    v_cvt_pk_bf16_f32 v36, v36, v37
    v_cvt_pk_bf16_f32 v37, v38, v39
    ds_write_b64 v159, v[36:37] offset:640
    v_pk_fma_f32 v[40:41], v[104:105], v[132:133], v[40:41] op_sel:[0,0,0] op_sel_hi:[0,1,1]
    v_pk_fma_f32 v[42:43], v[104:105], v[134:135], v[42:43] op_sel:[0,0,0] op_sel_hi:[0,1,1]
    v_pk_mul_f32 v[40:41], v[40:41], v[104:105] op_sel:[0,1] op_sel_hi:[1,1]
    v_pk_mul_f32 v[42:43], v[42:43], v[104:105] op_sel:[0,1] op_sel_hi:[1,1]
    v_cvt_pk_bf16_f32 v40, v40, v41
    v_cvt_pk_bf16_f32 v41, v42, v43
    ds_write_b64 v160, v[40:41] offset:640
    v_pk_fma_f32 v[44:45], v[108:109], v[116:117], v[44:45] op_sel:[0,0,0] op_sel_hi:[0,1,1]
    v_pk_fma_f32 v[46:47], v[108:109], v[118:119], v[46:47] op_sel:[0,0,0] op_sel_hi:[0,1,1]
    v_pk_mul_f32 v[44:45], v[44:45], v[108:109] op_sel:[0,1] op_sel_hi:[1,1]
    v_pk_mul_f32 v[46:47], v[46:47], v[108:109] op_sel:[0,1] op_sel_hi:[1,1]
    v_cvt_pk_bf16_f32 v44, v44, v45
    v_cvt_pk_bf16_f32 v45, v46, v47
    ds_write_b64 v156, v[44:45] offset:1280
    v_pk_fma_f32 v[48:49], v[108:109], v[120:121], v[48:49] op_sel:[0,0,0] op_sel_hi:[0,1,1]
    v_pk_fma_f32 v[50:51], v[108:109], v[122:123], v[50:51] op_sel:[0,0,0] op_sel_hi:[0,1,1]
    v_pk_mul_f32 v[48:49], v[48:49], v[108:109] op_sel:[0,1] op_sel_hi:[1,1]
    v_pk_mul_f32 v[50:51], v[50:51], v[108:109] op_sel:[0,1] op_sel_hi:[1,1]
    v_cvt_pk_bf16_f32 v48, v48, v49
    v_cvt_pk_bf16_f32 v49, v50, v51
    ds_write_b64 v157, v[48:49] offset:1280
    v_pk_fma_f32 v[52:53], v[108:109], v[124:125], v[52:53] op_sel:[0,0,0] op_sel_hi:[0,1,1]
    v_pk_fma_f32 v[54:55], v[108:109], v[126:127], v[54:55] op_sel:[0,0,0] op_sel_hi:[0,1,1]
    v_pk_mul_f32 v[52:53], v[52:53], v[108:109] op_sel:[0,1] op_sel_hi:[1,1]
    v_pk_mul_f32 v[54:55], v[54:55], v[108:109] op_sel:[0,1] op_sel_hi:[1,1]
    v_cvt_pk_bf16_f32 v52, v52, v53
    v_cvt_pk_bf16_f32 v53, v54, v55
    ds_write_b64 v158, v[52:53] offset:1280
    v_pk_fma_f32 v[56:57], v[108:109], v[128:129], v[56:57] op_sel:[0,0,0] op_sel_hi:[0,1,1]
    v_pk_fma_f32 v[58:59], v[108:109], v[130:131], v[58:59] op_sel:[0,0,0] op_sel_hi:[0,1,1]
    v_pk_mul_f32 v[56:57], v[56:57], v[108:109] op_sel:[0,1] op_sel_hi:[1,1]
    v_pk_mul_f32 v[58:59], v[58:59], v[108:109] op_sel:[0,1] op_sel_hi:[1,1]
    v_cvt_pk_bf16_f32 v56, v56, v57
    v_cvt_pk_bf16_f32 v57, v58, v59
    ds_write_b64 v159, v[56:57] offset:1280
    v_pk_fma_f32 v[60:61], v[108:109], v[132:133], v[60:61] op_sel:[0,0,0] op_sel_hi:[0,1,1]
    v_pk_fma_f32 v[62:63], v[108:109], v[134:135], v[62:63] op_sel:[0,0,0] op_sel_hi:[0,1,1]
    v_pk_mul_f32 v[60:61], v[60:61], v[108:109] op_sel:[0,1] op_sel_hi:[1,1]
    v_pk_mul_f32 v[62:63], v[62:63], v[108:109] op_sel:[0,1] op_sel_hi:[1,1]
    v_cvt_pk_bf16_f32 v60, v60, v61
    v_cvt_pk_bf16_f32 v61, v62, v63
    ds_write_b64 v160, v[60:61] offset:1280
    v_pk_fma_f32 v[64:65], v[112:113], v[116:117], v[64:65] op_sel:[0,0,0] op_sel_hi:[0,1,1]
    v_pk_fma_f32 v[66:67], v[112:113], v[118:119], v[66:67] op_sel:[0,0,0] op_sel_hi:[0,1,1]
    v_pk_mul_f32 v[64:65], v[64:65], v[112:113] op_sel:[0,1] op_sel_hi:[1,1]
    v_pk_mul_f32 v[66:67], v[66:67], v[112:113] op_sel:[0,1] op_sel_hi:[1,1]
    v_cvt_pk_bf16_f32 v64, v64, v65
    v_cvt_pk_bf16_f32 v65, v66, v67
    ds_write_b64 v156, v[64:65] offset:1920
    v_pk_fma_f32 v[68:69], v[112:113], v[120:121], v[68:69] op_sel:[0,0,0] op_sel_hi:[0,1,1]
    v_pk_fma_f32 v[70:71], v[112:113], v[122:123], v[70:71] op_sel:[0,0,0] op_sel_hi:[0,1,1]
    v_pk_mul_f32 v[68:69], v[68:69], v[112:113] op_sel:[0,1] op_sel_hi:[1,1]
    v_pk_mul_f32 v[70:71], v[70:71], v[112:113] op_sel:[0,1] op_sel_hi:[1,1]
    v_cvt_pk_bf16_f32 v68, v68, v69
    v_cvt_pk_bf16_f32 v69, v70, v71
    ds_write_b64 v157, v[68:69] offset:1920
    v_pk_fma_f32 v[72:73], v[112:113], v[124:125], v[72:73] op_sel:[0,0,0] op_sel_hi:[0,1,1]
    v_pk_fma_f32 v[74:75], v[112:113], v[126:127], v[74:75] op_sel:[0,0,0] op_sel_hi:[0,1,1]
    v_pk_mul_f32 v[72:73], v[72:73], v[112:113] op_sel:[0,1] op_sel_hi:[1,1]
    v_pk_mul_f32 v[74:75], v[74:75], v[112:113] op_sel:[0,1] op_sel_hi:[1,1]
    v_cvt_pk_bf16_f32 v72, v72, v73
    v_cvt_pk_bf16_f32 v73, v74, v75
    ds_write_b64 v158, v[72:73] offset:1920
    v_pk_fma_f32 v[76:77], v[112:113], v[128:129], v[76:77] op_sel:[0,0,0] op_sel_hi:[0,1,1]
    v_pk_fma_f32 v[78:79], v[112:113], v[130:131], v[78:79] op_sel:[0,0,0] op_sel_hi:[0,1,1]
    v_pk_mul_f32 v[76:77], v[76:77], v[112:113] op_sel:[0,1] op_sel_hi:[1,1]
    v_pk_mul_f32 v[78:79], v[78:79], v[112:113] op_sel:[0,1] op_sel_hi:[1,1]
    v_cvt_pk_bf16_f32 v76, v76, v77
    v_cvt_pk_bf16_f32 v77, v78, v79
    ds_write_b64 v159, v[76:77] offset:1920
    v_pk_fma_f32 v[80:81], v[112:113], v[132:133], v[80:81] op_sel:[0,0,0] op_sel_hi:[0,1,1]
    v_pk_fma_f32 v[82:83], v[112:113], v[134:135], v[82:83] op_sel:[0,0,0] op_sel_hi:[0,1,1]
    v_pk_mul_f32 v[80:81], v[80:81], v[112:113] op_sel:[0,1] op_sel_hi:[1,1]
    v_pk_mul_f32 v[82:83], v[82:83], v[112:113] op_sel:[0,1] op_sel_hi:[1,1]
    v_cvt_pk_bf16_f32 v80, v80, v81
    v_cvt_pk_bf16_f32 v81, v82, v83
    ds_write_b64 v160, v[80:81] offset:1920
    s_add_u32 s54, s54, 0
    s_branch L_eEnd_8
L_eK_6:
    v_pk_fma_f32 v[4:5], v[100:101], v[116:117], v[4:5] op_sel:[0,0,0] op_sel_hi:[0,1,1]
    v_pk_fma_f32 v[6:7], v[100:101], v[118:119], v[6:7] op_sel:[0,0,0] op_sel_hi:[0,1,1]
    v_pk_mul_f32 v[4:5], v[4:5], v[100:101] op_sel:[0,1] op_sel_hi:[1,1]
    v_pk_mul_f32 v[6:7], v[6:7], v[100:101] op_sel:[0,1] op_sel_hi:[1,1]
    v_cvt_pk_bf16_f32 v4, v4, v5
    v_cvt_pk_bf16_f32 v5, v6, v7
    ds_write_b64 v156, v[4:5] offset:0
    v_pk_fma_f32 v[8:9], v[100:101], v[120:121], v[8:9] op_sel:[0,0,0] op_sel_hi:[0,1,1]
    v_pk_fma_f32 v[10:11], v[100:101], v[122:123], v[10:11] op_sel:[0,0,0] op_sel_hi:[0,1,1]
    v_pk_mul_f32 v[8:9], v[8:9], v[100:101] op_sel:[0,1] op_sel_hi:[1,1]
    v_pk_mul_f32 v[10:11], v[10:11], v[100:101] op_sel:[0,1] op_sel_hi:[1,1]
    v_cvt_pk_bf16_f32 v8, v8, v9
    v_cvt_pk_bf16_f32 v9, v10, v11
    ds_write_b64 v157, v[8:9] offset:0
    v_pk_fma_f32 v[12:13], v[100:101], v[124:125], v[12:13] op_sel:[0,0,0] op_sel_hi:[0,1,1]
    v_pk_fma_f32 v[14:15], v[100:101], v[126:127], v[14:15] op_sel:[0,0,0] op_sel_hi:[0,1,1]
    v_pk_mul_f32 v[12:13], v[12:13], v[100:101] op_sel:[0,1] op_sel_hi:[1,1]
    v_pk_mul_f32 v[14:15], v[14:15], v[100:101] op_sel:[0,1] op_sel_hi:[1,1]
    v_cvt_pk_bf16_f32 v12, v12, v13
    v_cvt_pk_bf16_f32 v13, v14, v15
    ds_write_b64 v158, v[12:13] offset:0
    v_pk_fma_f32 v[16:17], v[100:101], v[128:129], v[16:17] op_sel:[0,0,0] op_sel_hi:[0,1,1]
    v_pk_fma_f32 v[18:19], v[100:101], v[130:131], v[18:19] op_sel:[0,0,0] op_sel_hi:[0,1,1]
    v_pk_mul_f32 v[16:17], v[16:17], v[100:101] op_sel:[0,1] op_sel_hi:[1,1]
    v_pk_mul_f32 v[18:19], v[18:19], v[100:101] op_sel:[0,1] op_sel_hi:[1,1]
    v_cvt_pk_bf16_f32 v16, v16, v17
    v_cvt_pk_bf16_f32 v17, v18, v19
    ds_write_b64 v159, v[16:17] offset:0
    v_pk_fma_f32 v[20:21], v[100:101], v[132:133], v[20:21] op_sel:[0,0,0] op_sel_hi:[0,1,1]
    v_pk_fma_f32 v[22:23], v[100:101], v[134:135], v[22:23] op_sel:[0,0,0] op_sel_hi:[0,1,1]
    v_pk_mul_f32 v[20:21], v[20:21], v[100:101] op_sel:[0,1] op_sel_hi:[1,1]
    v_pk_mul_f32 v[22:23], v[22:23], v[100:101] op_sel:[0,1] op_sel_hi:[1,1]
    v_cvt_pk_bf16_f32 v20, v20, v21
    v_cvt_pk_bf16_f32 v21, v22, v23
    ds_write_b64 v160, v[20:21] offset:0
    v_pk_fma_f32 v[24:25], v[104:105], v[116:117], v[24:25] op_sel:[0,0,0] op_sel_hi:[0,1,1]
    v_pk_fma_f32 v[26:27], v[104:105], v[118:119], v[26:27] op_sel:[0,0,0] op_sel_hi:[0,1,1]
    v_pk_mul_f32 v[24:25], v[24:25], v[104:105] op_sel:[0,1] op_sel_hi:[1,1]
    v_pk_mul_f32 v[26:27], v[26:27], v[104:105] op_sel:[0,1] op_sel_hi:[1,1]
    v_cvt_pk_bf16_f32 v24, v24, v25
    v_cvt_pk_bf16_f32 v25, v26, v27
    ds_write_b64 v161, v[24:25] offset:0
    v_pk_fma_f32 v[28:29], v[104:105], v[120:121], v[28:29] op_sel:[0,0,0] op_sel_hi:[0,1,1]
    v_pk_fma_f32 v[30:31], v[104:105], v[122:123], v[30:31] op_sel:[0,0,0] op_sel_hi:[0,1,1]
    v_pk_mul_f32 v[28:29], v[28:29], v[104:105] op_sel:[0,1] op_sel_hi:[1,1]
    v_pk_mul_f32 v[30:31], v[30:31], v[104:105] op_sel:[0,1] op_sel_hi:[1,1]
    v_cvt_pk_bf16_f32 v28, v28, v29
    v_cvt_pk_bf16_f32 v29, v30, v31
    ds_write_b64 v162, v[28:29] offset:0
    v_pk_fma_f32 v[32:33], v[104:105], v[124:125], v[32:33] op_sel:[0,0,0] op_sel_hi:[0,1,1]
    v_pk_fma_f32 v[34:35], v[104:105], v[126:127], v[34:35] op_sel:[0,0,0] op_sel_hi:[0,1,1]
    v_pk_mul_f32 v[32:33], v[32:33], v[104:105] op_sel:[0,1] op_sel_hi:[1,1]
    v_pk_mul_f32 v[34:35], v[34:35], v[104:105] op_sel:[0,1] op_sel_hi:[1,1]
    v_cvt_pk_bf16_f32 v32, v32, v33
    v_cvt_pk_bf16_f32 v33, v34, v35
    ds_write_b64 v163, v[32:33] offset:0
    v_pk_fma_f32 v[36:37], v[104:105], v[128:129], v[36:37] op_sel:[0,0,0] op_sel_hi:[0,1,1]
    v_pk_fma_f32 v[38:39], v[104:105], v[130:131], v[38:39] op_sel:[0,0,0] op_sel_hi:[0,1,1]
    v_pk_mul_f32 v[36:37], v[36:37], v[104:105] op_sel:[0,1] op_sel_hi:[1,1]
    v_pk_mul_f32 v[38:39], v[38:39], v[104:105] op_sel:[0,1] op_sel_hi:[1,1]
    v_cvt_pk_bf16_f32 v36, v36, v37
    v_cvt_pk_bf16_f32 v37, v38, v39
    ds_write_b64 v164, v[36:37] offset:0
    v_pk_fma_f32 v[40:41], v[104:105], v[132:133], v[40:41] op_sel:[0,0,0] op_sel_hi:[0,1,1]
    v_pk_fma_f32 v[42:43], v[104:105], v[134:135], v[42:43] op_sel:[0,0,0] op_sel_hi:[0,1,1]
    v_pk_mul_f32 v[40:41], v[40:41], v[104:105] op_sel:[0,1] op_sel_hi:[1,1]
    v_pk_mul_f32 v[42:43], v[42:43], v[104:105] op_sel:[0,1] op_sel_hi:[1,1]
    v_cvt_pk_bf16_f32 v40, v40, v41
    v_cvt_pk_bf16_f32 v41, v42, v43
    ds_write_b64 v165, v[40:41] offset:0
    v_pk_fma_f32 v[44:45], v[108:109], v[116:117], v[44:45] op_sel:[0,0,0] op_sel_hi:[0,1,1]
    v_pk_fma_f32 v[46:47], v[108:109], v[118:119], v[46:47] op_sel:[0,0,0] op_sel_hi:[0,1,1]
    v_pk_mul_f32 v[44:45], v[44:45], v[108:109] op_sel:[0,1] op_sel_hi:[1,1]
    v_pk_mul_f32 v[46:47], v[46:47], v[108:109] op_sel:[0,1] op_sel_hi:[1,1]
    v_cvt_pk_bf16_f32 v44, v44, v45
    v_cvt_pk_bf16_f32 v45, v46, v47
    ds_write_b64 v156, v[44:45] offset:1280
    v_pk_fma_f32 v[48:49], v[108:109], v[120:121], v[48:49] op_sel:[0,0,0] op_sel_hi:[0,1,1]
    v_pk_fma_f32 v[50:51], v[108:109], v[122:123], v[50:51] op_sel:[0,0,0] op_sel_hi:[0,1,1]
    v_pk_mul_f32 v[48:49], v[48:49], v[108:109] op_sel:[0,1] op_sel_hi:[1,1]
    v_pk_mul_f32 v[50:51], v[50:51], v[108:109] op_sel:[0,1] op_sel_hi:[1,1]
    v_cvt_pk_bf16_f32 v48, v48, v49
    v_cvt_pk_bf16_f32 v49, v50, v51
    ds_write_b64 v157, v[48:49] offset:1280
    v_pk_fma_f32 v[52:53], v[108:109], v[124:125], v[52:53] op_sel:[0,0,0] op_sel_hi:[0,1,1]
    v_pk_fma_f32 v[54:55], v[108:109], v[126:127], v[54:55] op_sel:[0,0,0] op_sel_hi:[0,1,1]
    v_pk_mul_f32 v[52:53], v[52:53], v[108:109] op_sel:[0,1] op_sel_hi:[1,1]
    v_pk_mul_f32 v[54:55], v[54:55], v[108:109] op_sel:[0,1] op_sel_hi:[1,1]
    v_cvt_pk_bf16_f32 v52, v52, v53
    v_cvt_pk_bf16_f32 v53, v54, v55
    ds_write_b64 v158, v[52:53] offset:1280
    v_pk_fma_f32 v[56:57], v[108:109], v[128:129], v[56:57] op_sel:[0,0,0] op_sel_hi:[0,1,1]
    v_pk_fma_f32 v[58:59], v[108:109], v[130:131], v[58:59] op_sel:[0,0,0] op_sel_hi:[0,1,1]
    v_pk_mul_f32 v[56:57], v[56:57], v[108:109] op_sel:[0,1] op_sel_hi:[1,1]
    v_pk_mul_f32 v[58:59], v[58:59], v[108:109] op_sel:[0,1] op_sel_hi:[1,1]
    v_cvt_pk_bf16_f32 v56, v56, v57
    v_cvt_pk_bf16_f32 v57, v58, v59
    ds_write_b64 v159, v[56:57] offset:1280
    v_pk_fma_f32 v[60:61], v[108:109], v[132:133], v[60:61] op_sel:[0,0,0] op_sel_hi:[0,1,1]
    v_pk_fma_f32 v[62:63], v[108:109], v[134:135], v[62:63] op_sel:[0,0,0] op_sel_hi:[0,1,1]
    v_pk_mul_f32 v[60:61], v[60:61], v[108:109] op_sel:[0,1] op_sel_hi:[1,1]
    v_pk_mul_f32 v[62:63], v[62:63], v[108:109] op_sel:[0,1] op_sel_hi:[1,1]
    v_cvt_pk_bf16_f32 v60, v60, v61
    v_cvt_pk_bf16_f32 v61, v62, v63
    ds_write_b64 v160, v[60:61] offset:1280
    v_pk_fma_f32 v[64:65], v[112:113], v[116:117], v[64:65] op_sel:[0,0,0] op_sel_hi:[0,1,1]
    v_pk_fma_f32 v[66:67], v[112:113], v[118:119], v[66:67] op_sel:[0,0,0] op_sel_hi:[0,1,1]
    v_pk_mul_f32 v[64:65], v[64:65], v[112:113] op_sel:[0,1] op_sel_hi:[1,1]
    v_pk_mul_f32 v[66:67], v[66:67], v[112:113] op_sel:[0,1] op_sel_hi:[1,1]
    v_cvt_pk_bf16_f32 v64, v64, v65
    v_cvt_pk_bf16_f32 v65, v66, v67
    ds_write_b64 v161, v[64:65] offset:1280
    v_pk_fma_f32 v[68:69], v[112:113], v[120:121], v[68:69] op_sel:[0,0,0] op_sel_hi:[0,1,1]
    v_pk_fma_f32 v[70:71], v[112:113], v[122:123], v[70:71] op_sel:[0,0,0] op_sel_hi:[0,1,1]
    v_pk_mul_f32 v[68:69], v[68:69], v[112:113] op_sel:[0,1] op_sel_hi:[1,1]
    v_pk_mul_f32 v[70:71], v[70:71], v[112:113] op_sel:[0,1] op_sel_hi:[1,1]
    v_cvt_pk_bf16_f32 v68, v68, v69
    v_cvt_pk_bf16_f32 v69, v70, v71
    ds_write_b64 v162, v[68:69] offset:1280
    v_pk_fma_f32 v[72:73], v[112:113], v[124:125], v[72:73] op_sel:[0,0,0] op_sel_hi:[0,1,1]
    v_pk_fma_f32 v[74:75], v[112:113], v[126:127], v[74:75] op_sel:[0,0,0] op_sel_hi:[0,1,1]
    v_pk_mul_f32 v[72:73], v[72:73], v[112:113] op_sel:[0,1] op_sel_hi:[1,1]
    v_pk_mul_f32 v[74:75], v[74:75], v[112:113] op_sel:[0,1] op_sel_hi:[1,1]
    v_cvt_pk_bf16_f32 v72, v72, v73
    v_cvt_pk_bf16_f32 v73, v74, v75
    ds_write_b64 v163, v[72:73] offset:1280
    v_pk_fma_f32 v[76:77], v[112:113], v[128:129], v[76:77] op_sel:[0,0,0] op_sel_hi:[0,1,1]
    v_pk_fma_f32 v[78:79], v[112:113], v[130:131], v[78:79] op_sel:[0,0,0] op_sel_hi:[0,1,1]
    v_pk_mul_f32 v[76:77], v[76:77], v[112:113] op_sel:[0,1] op_sel_hi:[1,1]
    v_pk_mul_f32 v[78:79], v[78:79], v[112:113] op_sel:[0,1] op_sel_hi:[1,1]
    v_cvt_pk_bf16_f32 v76, v76, v77
    v_cvt_pk_bf16_f32 v77, v78, v79
    ds_write_b64 v164, v[76:77] offset:1280
    v_pk_fma_f32 v[80:81], v[112:113], v[132:133], v[80:81] op_sel:[0,0,0] op_sel_hi:[0,1,1]
    v_pk_fma_f32 v[82:83], v[112:113], v[134:135], v[82:83] op_sel:[0,0,0] op_sel_hi:[0,1,1]
    v_pk_mul_f32 v[80:81], v[80:81], v[112:113] op_sel:[0,1] op_sel_hi:[1,1]
    v_pk_mul_f32 v[82:83], v[82:83], v[112:113] op_sel:[0,1] op_sel_hi:[1,1]
    v_cvt_pk_bf16_f32 v80, v80, v81
    v_cvt_pk_bf16_f32 v81, v82, v83
    ds_write_b64 v165, v[80:81] offset:1280
    s_add_u32 s54, s54, 3145728
    s_branch L_eEnd_8
L_eEnd_8:
    s_waitcnt lgkmcnt(0)
    s_barrier
    ds_read_b128 v[4:7], v141 offset:0
    ds_read_b128 v[8:11], v141 offset:8192
    ds_read_b128 v[12:15], v141 offset:16384
    ds_read_b128 v[16:19], v141 offset:24576
    ds_read_b128 v[20:23], v141 offset:32768
    ds_read_b128 v[24:27], v141 offset:40960
    ds_read_b128 v[28:31], v141 offset:49152
    ds_read_b128 v[32:35], v141 offset:57344
    ds_read_b128 v[36:39], v142 offset:0
    ds_read_b128 v[40:43], v142 offset:8192
    s_add_u32 s46, s32, 0
    s_mul_i32 s47, s46, 52429
    s_lshr_b32 s47, s47, 19
    s_mul_i32 s47, s47, 71680
    s_lshl_b32 s46, s46, 10
    s_add_u32 s46, s46, s47
    s_add_u32 s46, s46, s54
    s_waitcnt lgkmcnt(9)
    buffer_store_dwordx4 v[4:7], v140, s[12:15], s46 offen sc0 sc1
    s_add_u32 s46, s32, 8
    s_mul_i32 s47, s46, 52429
    s_lshr_b32 s47, s47, 19
    s_mul_i32 s47, s47, 71680
    s_lshl_b32 s46, s46, 10
    s_add_u32 s46, s46, s47
    s_add_u32 s46, s46, s54
    s_waitcnt lgkmcnt(8)
    buffer_store_dwordx4 v[8:11], v140, s[12:15], s46 offen sc0 sc1
    s_add_u32 s46, s32, 16
    s_mul_i32 s47, s46, 52429
    s_lshr_b32 s47, s47, 19
    s_mul_i32 s47, s47, 71680
    s_lshl_b32 s46, s46, 10
    s_add_u32 s46, s46, s47
    s_add_u32 s46, s46, s54
    s_waitcnt lgkmcnt(7)
    buffer_store_dwordx4 v[12:15], v140, s[12:15], s46 offen sc0 sc1
    s_add_u32 s46, s32, 24
    s_mul_i32 s47, s46, 52429
    s_lshr_b32 s47, s47, 19
    s_mul_i32 s47, s47, 71680
    s_lshl_b32 s46, s46, 10
    s_add_u32 s46, s46, s47
    s_add_u32 s46, s46, s54
    s_waitcnt lgkmcnt(6)
    buffer_store_dwordx4 v[16:19], v140, s[12:15], s46 offen sc0 sc1
    s_add_u32 s46, s32, 32
    s_mul_i32 s47, s46, 52429
    s_lshr_b32 s47, s47, 19
    s_mul_i32 s47, s47, 71680
    s_lshl_b32 s46, s46, 10
    s_add_u32 s46, s46, s47
    s_add_u32 s46, s46, s54
    s_waitcnt lgkmcnt(5)
    buffer_store_dwordx4 v[20:23], v140, s[12:15], s46 offen sc0 sc1
    s_add_u32 s46, s32, 40
    s_mul_i32 s47, s46, 52429
    s_lshr_b32 s47, s47, 19
    s_mul_i32 s47, s47, 71680
    s_lshl_b32 s46, s46, 10
    s_add_u32 s46, s46, s47
    s_add_u32 s46, s46, s54
    s_waitcnt lgkmcnt(4)
    buffer_store_dwordx4 v[24:27], v140, s[12:15], s46 offen sc0 sc1
    s_add_u32 s46, s32, 48
    s_mul_i32 s47, s46, 52429
    s_lshr_b32 s47, s47, 19
    s_mul_i32 s47, s47, 71680
    s_lshl_b32 s46, s46, 10
    s_add_u32 s46, s46, s47
    s_add_u32 s46, s46, s54
    s_waitcnt lgkmcnt(3)
    buffer_store_dwordx4 v[28:31], v140, s[12:15], s46 offen sc0 sc1
    s_add_u32 s46, s32, 56
    s_mul_i32 s47, s46, 52429
    s_lshr_b32 s47, s47, 19
    s_mul_i32 s47, s47, 71680
    s_lshl_b32 s46, s46, 10
    s_add_u32 s46, s46, s47
    s_add_u32 s46, s46, s54
    s_waitcnt lgkmcnt(2)
    buffer_store_dwordx4 v[32:35], v140, s[12:15], s46 offen sc0 sc1
    s_add_u32 s46, s32, 64
    s_mul_i32 s47, s46, 52429
    s_lshr_b32 s47, s47, 19
    s_mul_i32 s47, s47, 71680
    s_lshl_b32 s46, s46, 10
    s_add_u32 s46, s46, s47
    s_add_u32 s46, s46, s54
    s_waitcnt lgkmcnt(1)
    buffer_store_dwordx4 v[36:39], v140, s[12:15], s46 offen sc0 sc1
    s_add_u32 s46, s32, 72
    s_mul_i32 s47, s46, 52429
    s_lshr_b32 s47, s47, 19
    s_mul_i32 s47, s47, 71680
    s_lshl_b32 s46, s46, 10
    s_add_u32 s46, s46, s47
    s_add_u32 s46, s46, s54
    s_waitcnt lgkmcnt(0)
    buffer_store_dwordx4 v[40:43], v140, s[12:15], s46 offen sc0 sc1
    s_waitcnt vmcnt(0)
    s_barrier
    s_cmp_lg_u32 s32, 0
    s_cbranch_scc1 L_nosig_9
    s_and_b32 s52, s36, 3
    s_lshl_b32 s53, s51, 3
    s_add_u32 s53, s53, s35
    s_lshl_b32 s46, s52, 5
    s_add_u32 s46, s46, s53
    s_lshl_b32 s46, s46, 2
    s_add_u32 s46, s46, 26411008
    s_mov_b64 exec, 1
    v_mov_b32 v156, 1
    buffer_store_dword v156, off, s[12:15], s46 sc0 sc1
    s_mov_b64 exec, -1
L_nosig_9:
    s_branch L_k12_ph2
L_k1_V:
    s_barrier
    s_mov_b32 s48, 0
    s_mov_b32 s38, 0
    s_mov_b32 s37, 0
    ds_read_b128 v[100:103], v148 offset:0
    ds_read_b128 v[104:107], v148 offset:2048
    ds_read_b128 v[108:111], v148 offset:4096
    ds_read_b128 v[112:115], v148 offset:6144
    v_mov_b32 v153, v151
    v_mov_b32 v154, v152
    ds_read_b64_tr_b16 v[132:133], v153 offset:0
    ds_read_b64_tr_b16 v[134:135], v153 offset:1280
    ds_read_b64_tr_b16 v[136:137], v154 offset:32
    ds_read_b64_tr_b16 v[138:139], v154 offset:1312
L_k1v_cl:
    v_add_u32 v150, s48, v149
    ds_read_b64_tr_b16 v[140:141], v153 offset:64
    ds_read_b64_tr_b16 v[142:143], v153 offset:1344
    ds_read_b128 v[116:119], v150 offset:0
    ds_read_b128 v[120:123], v150 offset:2048
    s_waitcnt lgkmcnt(6)
    v_mfma_f32_16x16x32_bf16 v[4:7], v[100:103], v[132:135], v[4:7]
    v_mfma_f32_16x16x32_bf16 v[24:27], v[104:107], v[132:135], v[24:27]
    v_mfma_f32_16x16x32_bf16 v[44:47], v[108:111], v[132:135], v[44:47]
    v_mfma_f32_16x16x32_bf16 v[64:67], v[112:115], v[132:135], v[64:67]
    ds_read_b64_tr_b16 v[144:145], v154 offset:96
    ds_read_b64_tr_b16 v[146:147], v154 offset:1376
    ds_read_b128 v[124:127], v150 offset:4096
    ds_read_b128 v[128:131], v150 offset:6144
    s_waitcnt lgkmcnt(8)
    v_mfma_f32_16x16x32_bf16 v[8:11], v[100:103], v[136:139], v[8:11]
    v_mfma_f32_16x16x32_bf16 v[28:31], v[104:107], v[136:139], v[28:31]
    v_mfma_f32_16x16x32_bf16 v[48:51], v[108:111], v[136:139], v[48:51]
    v_mfma_f32_16x16x32_bf16 v[68:71], v[112:115], v[136:139], v[68:71]
    ds_read_b64_tr_b16 v[132:133], v153 offset:128
    ds_read_b64_tr_b16 v[134:135], v153 offset:1408
    s_waitcnt lgkmcnt(8)
    v_mfma_f32_16x16x32_bf16 v[12:15], v[100:103], v[140:143], v[12:15]
    v_mfma_f32_16x16x32_bf16 v[32:35], v[104:107], v[140:143], v[32:35]
    v_mfma_f32_16x16x32_bf16 v[52:55], v[108:111], v[140:143], v[52:55]
    v_mfma_f32_16x16x32_bf16 v[72:75], v[112:115], v[140:143], v[72:75]
    s_waitcnt lgkmcnt(0)
    s_barrier
    s_add_u32 s38, s38, 12288
    s_cmp_eq_u32 s38, 61440
    s_cselect_b32 s38, 0, s38
    v_add_u32 v153, s38, v151
    v_add_u32 v154, s38, v152
    ds_read_b64_tr_b16 v[136:137], v153 offset:0
    ds_read_b64_tr_b16 v[138:139], v153 offset:1280
    v_mfma_f32_16x16x32_bf16 v[16:19], v[100:103], v[144:147], v[16:19]
    v_mfma_f32_16x16x32_bf16 v[36:39], v[104:107], v[144:147], v[36:39]
    v_mfma_f32_16x16x32_bf16 v[56:59], v[108:111], v[144:147], v[56:59]
    v_mfma_f32_16x16x32_bf16 v[76:79], v[112:115], v[144:147], v[76:79]
    ds_read_b64_tr_b16 v[140:141], v154 offset:32
    ds_read_b64_tr_b16 v[142:143], v154 offset:1312
    v_mfma_f32_16x16x32_bf16 v[20:23], v[100:103], v[132:135], v[20:23]
    v_mfma_f32_16x16x32_bf16 v[40:43], v[104:107], v[132:135], v[40:43]
    v_mfma_f32_16x16x32_bf16 v[60:63], v[108:111], v[132:135], v[60:63]
    v_mfma_f32_16x16x32_bf16 v[80:83], v[112:115], v[132:135], v[80:83]
    s_add_u32 s48, s48, 32768
    s_cmp_eq_u32 s48, 98304
    s_cselect_b32 s48, 0, s48
    v_add_u32 v150, s48, v148
    ds_read_b64_tr_b16 v[144:145], v153 offset:64
    ds_read_b64_tr_b16 v[146:147], v153 offset:1344
    ds_read_b128 v[100:103], v150 offset:0
    ds_read_b128 v[104:107], v150 offset:2048
    s_waitcnt lgkmcnt(6)
    v_mfma_f32_16x16x32_bf16 v[4:7], v[116:119], v[136:139], v[4:7]
    v_mfma_f32_16x16x32_bf16 v[24:27], v[120:123], v[136:139], v[24:27]
    v_mfma_f32_16x16x32_bf16 v[44:47], v[124:127], v[136:139], v[44:47]
    v_mfma_f32_16x16x32_bf16 v[64:67], v[128:131], v[136:139], v[64:67]
    ds_read_b64_tr_b16 v[132:133], v154 offset:96
    ds_read_b64_tr_b16 v[134:135], v154 offset:1376
    ds_read_b128 v[108:111], v150 offset:4096
    ds_read_b128 v[112:115], v150 offset:6144
    s_waitcnt lgkmcnt(8)
    v_mfma_f32_16x16x32_bf16 v[8:11], v[116:119], v[140:143], v[8:11]
    v_mfma_f32_16x16x32_bf16 v[28:31], v[120:123], v[140:143], v[28:31]
    v_mfma_f32_16x16x32_bf16 v[48:51], v[124:127], v[140:143], v[48:51]
    v_mfma_f32_16x16x32_bf16 v[68:71], v[128:131], v[140:143], v[68:71]
    ds_read_b64_tr_b16 v[136:137], v153 offset:128
    ds_read_b64_tr_b16 v[138:139], v153 offset:1408
    s_waitcnt lgkmcnt(8)
    v_mfma_f32_16x16x32_bf16 v[12:15], v[116:119], v[144:147], v[12:15]
    v_mfma_f32_16x16x32_bf16 v[32:35], v[120:123], v[144:147], v[32:35]
    v_mfma_f32_16x16x32_bf16 v[52:55], v[124:127], v[144:147], v[52:55]
    v_mfma_f32_16x16x32_bf16 v[72:75], v[128:131], v[144:147], v[72:75]
    s_waitcnt lgkmcnt(0)
    s_barrier
    s_add_u32 s38, s38, 12288
    s_cmp_eq_u32 s38, 61440
    s_cselect_b32 s38, 0, s38
    v_add_u32 v153, s38, v151
    v_add_u32 v154, s38, v152
    ds_read_b64_tr_b16 v[140:141], v153 offset:0
    ds_read_b64_tr_b16 v[142:143], v153 offset:1280
    v_mfma_f32_16x16x32_bf16 v[16:19], v[116:119], v[132:135], v[16:19]
    v_mfma_f32_16x16x32_bf16 v[36:39], v[120:123], v[132:135], v[36:39]
    v_mfma_f32_16x16x32_bf16 v[56:59], v[124:127], v[132:135], v[56:59]
    v_mfma_f32_16x16x32_bf16 v[76:79], v[128:131], v[132:135], v[76:79]
    ds_read_b64_tr_b16 v[144:145], v154 offset:32
    ds_read_b64_tr_b16 v[146:147], v154 offset:1312
    v_mfma_f32_16x16x32_bf16 v[20:23], v[116:119], v[136:139], v[20:23]
    v_mfma_f32_16x16x32_bf16 v[40:43], v[120:123], v[136:139], v[40:43]
    v_mfma_f32_16x16x32_bf16 v[60:63], v[124:127], v[136:139], v[60:63]
    v_mfma_f32_16x16x32_bf16 v[80:83], v[128:131], v[136:139], v[80:83]
    v_add_u32 v150, s48, v149
    ds_read_b64_tr_b16 v[132:133], v153 offset:64
    ds_read_b64_tr_b16 v[134:135], v153 offset:1344
    ds_read_b128 v[116:119], v150 offset:0
    ds_read_b128 v[120:123], v150 offset:2048
    s_waitcnt lgkmcnt(6)
    v_mfma_f32_16x16x32_bf16 v[4:7], v[100:103], v[140:143], v[4:7]
    v_mfma_f32_16x16x32_bf16 v[24:27], v[104:107], v[140:143], v[24:27]
    v_mfma_f32_16x16x32_bf16 v[44:47], v[108:111], v[140:143], v[44:47]
    v_mfma_f32_16x16x32_bf16 v[64:67], v[112:115], v[140:143], v[64:67]
    ds_read_b64_tr_b16 v[136:137], v154 offset:96
    ds_read_b64_tr_b16 v[138:139], v154 offset:1376
    ds_read_b128 v[124:127], v150 offset:4096
    ds_read_b128 v[128:131], v150 offset:6144
    s_waitcnt lgkmcnt(8)
    v_mfma_f32_16x16x32_bf16 v[8:11], v[100:103], v[144:147], v[8:11]
    v_mfma_f32_16x16x32_bf16 v[28:31], v[104:107], v[144:147], v[28:31]
    v_mfma_f32_16x16x32_bf16 v[48:51], v[108:111], v[144:147], v[48:51]
    v_mfma_f32_16x16x32_bf16 v[68:71], v[112:115], v[144:147], v[68:71]
    ds_read_b64_tr_b16 v[140:141], v153 offset:128
    ds_read_b64_tr_b16 v[142:143], v153 offset:1408
    s_waitcnt lgkmcnt(8)
    v_mfma_f32_16x16x32_bf16 v[12:15], v[100:103], v[132:135], v[12:15]
    v_mfma_f32_16x16x32_bf16 v[32:35], v[104:107], v[132:135], v[32:35]
    v_mfma_f32_16x16x32_bf16 v[52:55], v[108:111], v[132:135], v[52:55]
    v_mfma_f32_16x16x32_bf16 v[72:75], v[112:115], v[132:135], v[72:75]
    s_waitcnt lgkmcnt(0)
    s_barrier
    s_add_u32 s38, s38, 12288
    s_cmp_eq_u32 s38, 61440
    s_cselect_b32 s38, 0, s38
    v_add_u32 v153, s38, v151
    v_add_u32 v154, s38, v152
    ds_read_b64_tr_b16 v[144:145], v153 offset:0
    ds_read_b64_tr_b16 v[146:147], v153 offset:1280
    v_mfma_f32_16x16x32_bf16 v[16:19], v[100:103], v[136:139], v[16:19]
    v_mfma_f32_16x16x32_bf16 v[36:39], v[104:107], v[136:139], v[36:39]
    v_mfma_f32_16x16x32_bf16 v[56:59], v[108:111], v[136:139], v[56:59]
    v_mfma_f32_16x16x32_bf16 v[76:79], v[112:115], v[136:139], v[76:79]
    ds_read_b64_tr_b16 v[132:133], v154 offset:32
    ds_read_b64_tr_b16 v[134:135], v154 offset:1312
    v_mfma_f32_16x16x32_bf16 v[20:23], v[100:103], v[140:143], v[20:23]
    v_mfma_f32_16x16x32_bf16 v[40:43], v[104:107], v[140:143], v[40:43]
    v_mfma_f32_16x16x32_bf16 v[60:63], v[108:111], v[140:143], v[60:63]
    v_mfma_f32_16x16x32_bf16 v[80:83], v[112:115], v[140:143], v[80:83]
    s_add_u32 s48, s48, 32768
    s_cmp_eq_u32 s48, 98304
    s_cselect_b32 s48, 0, s48
    v_add_u32 v150, s48, v148
    ds_read_b64_tr_b16 v[136:137], v153 offset:64
    ds_read_b64_tr_b16 v[138:139], v153 offset:1344
    ds_read_b128 v[100:103], v150 offset:0
    ds_read_b128 v[104:107], v150 offset:2048
    s_waitcnt lgkmcnt(6)
    v_mfma_f32_16x16x32_bf16 v[4:7], v[116:119], v[144:147], v[4:7]
    v_mfma_f32_16x16x32_bf16 v[24:27], v[120:123], v[144:147], v[24:27]
    v_mfma_f32_16x16x32_bf16 v[44:47], v[124:127], v[144:147], v[44:47]
    v_mfma_f32_16x16x32_bf16 v[64:67], v[128:131], v[144:147], v[64:67]
    ds_read_b64_tr_b16 v[140:141], v154 offset:96
    ds_read_b64_tr_b16 v[142:143], v154 offset:1376
    ds_read_b128 v[108:111], v150 offset:4096
    ds_read_b128 v[112:115], v150 offset:6144
    s_waitcnt lgkmcnt(8)
    v_mfma_f32_16x16x32_bf16 v[8:11], v[116:119], v[132:135], v[8:11]
    v_mfma_f32_16x16x32_bf16 v[28:31], v[120:123], v[132:135], v[28:31]
    v_mfma_f32_16x16x32_bf16 v[48:51], v[124:127], v[132:135], v[48:51]
    v_mfma_f32_16x16x32_bf16 v[68:71], v[128:131], v[132:135], v[68:71]
    ds_read_b64_tr_b16 v[144:145], v153 offset:128
    ds_read_b64_tr_b16 v[146:147], v153 offset:1408
    s_waitcnt lgkmcnt(8)
    v_mfma_f32_16x16x32_bf16 v[12:15], v[116:119], v[136:139], v[12:15]
    v_mfma_f32_16x16x32_bf16 v[32:35], v[120:123], v[136:139], v[32:35]
    v_mfma_f32_16x16x32_bf16 v[52:55], v[124:127], v[136:139], v[52:55]
    v_mfma_f32_16x16x32_bf16 v[72:75], v[128:131], v[136:139], v[72:75]
    s_waitcnt lgkmcnt(0)
    s_barrier
    s_add_u32 s38, s38, 12288
    s_cmp_eq_u32 s38, 61440
    s_cselect_b32 s38, 0, s38
    v_add_u32 v153, s38, v151
    v_add_u32 v154, s38, v152
    ds_read_b64_tr_b16 v[132:133], v153 offset:0
    ds_read_b64_tr_b16 v[134:135], v153 offset:1280
    v_mfma_f32_16x16x32_bf16 v[16:19], v[116:119], v[140:143], v[16:19]
    v_mfma_f32_16x16x32_bf16 v[36:39], v[120:123], v[140:143], v[36:39]
    v_mfma_f32_16x16x32_bf16 v[56:59], v[124:127], v[140:143], v[56:59]
    v_mfma_f32_16x16x32_bf16 v[76:79], v[128:131], v[140:143], v[76:79]
    ds_read_b64_tr_b16 v[136:137], v154 offset:32
    ds_read_b64_tr_b16 v[138:139], v154 offset:1312
    v_mfma_f32_16x16x32_bf16 v[20:23], v[116:119], v[144:147], v[20:23]
    v_mfma_f32_16x16x32_bf16 v[40:43], v[120:123], v[144:147], v[40:43]
    v_mfma_f32_16x16x32_bf16 v[60:63], v[124:127], v[144:147], v[60:63]
    v_mfma_f32_16x16x32_bf16 v[80:83], v[128:131], v[144:147], v[80:83]
    s_add_u32 s37, s37, 1
    s_cmp_lt_u32 s37, 5
    s_cbranch_scc1 L_k1v_cl
    s_waitcnt lgkmcnt(0)
    s_barrier
    v_lshrrev_b32 v140, 4, v155
    v_lshlrev_b32 v140, 5, v140
    s_lshl_b32 s46, s33, 9
    s_add_u32 s46, s46, 159744
    v_add_u32 v140, s46, v140
    ds_read_b128 v[100:103], v140 offset:0
    ds_read_b128 v[104:107], v140 offset:16
    ds_read_b128 v[108:111], v140 offset:128
    ds_read_b128 v[112:115], v140 offset:144
    ds_read_b128 v[116:119], v140 offset:256
    ds_read_b128 v[120:123], v140 offset:272
    ds_read_b128 v[124:127], v140 offset:384
    ds_read_b128 v[128:131], v140 offset:400
    v_and_b32 v141, 15, v155
    v_lshlrev_b32 v141, 2, v141
    s_mul_i32 s46, s34, 320
    s_add_u32 s46, s46, 161792
    v_add_u32 v141, s46, v141
    ds_read_b32 v132, v141 offset:0
    ds_read_b32 v133, v141 offset:64
    ds_read_b32 v134, v141 offset:128
    ds_read_b32 v135, v141 offset:192
    ds_read_b32 v136, v141 offset:256
    s_waitcnt lgkmcnt(0)
    v_swap_b32 v101, v102
    v_swap_b32 v105, v106
    v_swap_b32 v109, v110
    v_swap_b32 v113, v114
    v_swap_b32 v117, v118
    v_swap_b32 v121, v122
    v_swap_b32 v125, v126
    v_swap_b32 v129, v130
    v_lshlrev_b32 v140, 4, v155
    s_lshl_b32 s46, s32, 10
    v_add_u32 v141, s46, v140
    v_add_u32 v142, 65536, v141
    s_and_b32 s46, s36, 3
    s_mul_i32 s54, s46, 655360
    s_mul_i32 s46, s35, 10240
    s_add_u32 s54, s54, s46
    v_pk_fma_f32 v[4:5], v[100:101], v[132:133], v[4:5] op_sel:[0,0,0] op_sel_hi:[1,0,1]
    v_pk_fma_f32 v[6:7], v[104:105], v[132:133], v[6:7] op_sel:[0,0,0] op_sel_hi:[1,0,1]
    v_pk_mul_f32 v[4:5], v[4:5], v[102:103]
    v_pk_mul_f32 v[6:7], v[6:7], v[106:107]
    v_cvt_pk_bf16_f32 v4, v4, v5
    v_cvt_pk_bf16_f32 v5, v6, v7
    ds_write_b64 v156, v[4:5] offset:0
    v_pk_fma_f32 v[8:9], v[100:101], v[132:133], v[8:9] op_sel:[0,1,0] op_sel_hi:[1,1,1]
    v_pk_fma_f32 v[10:11], v[104:105], v[132:133], v[10:11] op_sel:[0,1,0] op_sel_hi:[1,1,1]
    v_pk_mul_f32 v[8:9], v[8:9], v[102:103]
    v_pk_mul_f32 v[10:11], v[10:11], v[106:107]
    v_cvt_pk_bf16_f32 v8, v8, v9
    v_cvt_pk_bf16_f32 v9, v10, v11
    ds_write_b64 v157, v[8:9] offset:0
    v_pk_fma_f32 v[12:13], v[100:101], v[134:135], v[12:13] op_sel:[0,0,0] op_sel_hi:[1,0,1]
    v_pk_fma_f32 v[14:15], v[104:105], v[134:135], v[14:15] op_sel:[0,0,0] op_sel_hi:[1,0,1]
    v_pk_mul_f32 v[12:13], v[12:13], v[102:103]
    v_pk_mul_f32 v[14:15], v[14:15], v[106:107]
    v_cvt_pk_bf16_f32 v12, v12, v13
    v_cvt_pk_bf16_f32 v13, v14, v15
    ds_write_b64 v158, v[12:13] offset:0
    v_pk_fma_f32 v[16:17], v[100:101], v[134:135], v[16:17] op_sel:[0,1,0] op_sel_hi:[1,1,1]
    v_pk_fma_f32 v[18:19], v[104:105], v[134:135], v[18:19] op_sel:[0,1,0] op_sel_hi:[1,1,1]
    v_pk_mul_f32 v[16:17], v[16:17], v[102:103]
    v_pk_mul_f32 v[18:19], v[18:19], v[106:107]
    v_cvt_pk_bf16_f32 v16, v16, v17
    v_cvt_pk_bf16_f32 v17, v18, v19
    ds_write_b64 v159, v[16:17] offset:0
    v_pk_fma_f32 v[20:21], v[100:101], v[136:137], v[20:21] op_sel:[0,0,0] op_sel_hi:[1,0,1]
    v_pk_fma_f32 v[22:23], v[104:105], v[136:137], v[22:23] op_sel:[0,0,0] op_sel_hi:[1,0,1]
    v_pk_mul_f32 v[20:21], v[20:21], v[102:103]
    v_pk_mul_f32 v[22:23], v[22:23], v[106:107]
    v_cvt_pk_bf16_f32 v20, v20, v21
    v_cvt_pk_bf16_f32 v21, v22, v23
    ds_write_b64 v160, v[20:21] offset:0
    v_pk_fma_f32 v[24:25], v[108:109], v[132:133], v[24:25] op_sel:[0,0,0] op_sel_hi:[1,0,1]
    v_pk_fma_f32 v[26:27], v[112:113], v[132:133], v[26:27] op_sel:[0,0,0] op_sel_hi:[1,0,1]
    v_pk_mul_f32 v[24:25], v[24:25], v[110:111]
    v_pk_mul_f32 v[26:27], v[26:27], v[114:115]
    v_cvt_pk_bf16_f32 v24, v24, v25
    v_cvt_pk_bf16_f32 v25, v26, v27
    ds_write_b64 v156, v[24:25] offset:640
    v_pk_fma_f32 v[28:29], v[108:109], v[132:133], v[28:29] op_sel:[0,1,0] op_sel_hi:[1,1,1]
    v_pk_fma_f32 v[30:31], v[112:113], v[132:133], v[30:31] op_sel:[0,1,0] op_sel_hi:[1,1,1]
    v_pk_mul_f32 v[28:29], v[28:29], v[110:111]
    v_pk_mul_f32 v[30:31], v[30:31], v[114:115]
    v_cvt_pk_bf16_f32 v28, v28, v29
    v_cvt_pk_bf16_f32 v29, v30, v31
    ds_write_b64 v157, v[28:29] offset:640
    v_pk_fma_f32 v[32:33], v[108:109], v[134:135], v[32:33] op_sel:[0,0,0] op_sel_hi:[1,0,1]
    v_pk_fma_f32 v[34:35], v[112:113], v[134:135], v[34:35] op_sel:[0,0,0] op_sel_hi:[1,0,1]
    v_pk_mul_f32 v[32:33], v[32:33], v[110:111]
    v_pk_mul_f32 v[34:35], v[34:35], v[114:115]
    v_cvt_pk_bf16_f32 v32, v32, v33
    v_cvt_pk_bf16_f32 v33, v34, v35
    ds_write_b64 v158, v[32:33] offset:640
    v_pk_fma_f32 v[36:37], v[108:109], v[134:135], v[36:37] op_sel:[0,1,0] op_sel_hi:[1,1,1]
    v_pk_fma_f32 v[38:39], v[112:113], v[134:135], v[38:39] op_sel:[0,1,0] op_sel_hi:[1,1,1]
    v_pk_mul_f32 v[36:37], v[36:37], v[110:111]
    v_pk_mul_f32 v[38:39], v[38:39], v[114:115]
    v_cvt_pk_bf16_f32 v36, v36, v37
    v_cvt_pk_bf16_f32 v37, v38, v39
    ds_write_b64 v159, v[36:37] offset:640
    v_pk_fma_f32 v[40:41], v[108:109], v[136:137], v[40:41] op_sel:[0,0,0] op_sel_hi:[1,0,1]
    v_pk_fma_f32 v[42:43], v[112:113], v[136:137], v[42:43] op_sel:[0,0,0] op_sel_hi:[1,0,1]
    v_pk_mul_f32 v[40:41], v[40:41], v[110:111]
    v_pk_mul_f32 v[42:43], v[42:43], v[114:115]
    v_cvt_pk_bf16_f32 v40, v40, v41
    v_cvt_pk_bf16_f32 v41, v42, v43
    ds_write_b64 v160, v[40:41] offset:640
    v_pk_fma_f32 v[44:45], v[116:117], v[132:133], v[44:45] op_sel:[0,0,0] op_sel_hi:[1,0,1]
    v_pk_fma_f32 v[46:47], v[120:121], v[132:133], v[46:47] op_sel:[0,0,0] op_sel_hi:[1,0,1]
    v_pk_mul_f32 v[44:45], v[44:45], v[118:119]
    v_pk_mul_f32 v[46:47], v[46:47], v[122:123]
    v_cvt_pk_bf16_f32 v44, v44, v45
    v_cvt_pk_bf16_f32 v45, v46, v47
    ds_write_b64 v156, v[44:45] offset:1280
    v_pk_fma_f32 v[48:49], v[116:117], v[132:133], v[48:49] op_sel:[0,1,0] op_sel_hi:[1,1,1]
    v_pk_fma_f32 v[50:51], v[120:121], v[132:133], v[50:51] op_sel:[0,1,0] op_sel_hi:[1,1,1]
    v_pk_mul_f32 v[48:49], v[48:49], v[118:119]
    v_pk_mul_f32 v[50:51], v[50:51], v[122:123]
    v_cvt_pk_bf16_f32 v48, v48, v49
    v_cvt_pk_bf16_f32 v49, v50, v51
    ds_write_b64 v157, v[48:49] offset:1280
    v_pk_fma_f32 v[52:53], v[116:117], v[134:135], v[52:53] op_sel:[0,0,0] op_sel_hi:[1,0,1]
    v_pk_fma_f32 v[54:55], v[120:121], v[134:135], v[54:55] op_sel:[0,0,0] op_sel_hi:[1,0,1]
    v_pk_mul_f32 v[52:53], v[52:53], v[118:119]
    v_pk_mul_f32 v[54:55], v[54:55], v[122:123]
    v_cvt_pk_bf16_f32 v52, v52, v53
    v_cvt_pk_bf16_f32 v53, v54, v55
    ds_write_b64 v158, v[52:53] offset:1280
    v_pk_fma_f32 v[56:57], v[116:117], v[134:135], v[56:57] op_sel:[0,1,0] op_sel_hi:[1,1,1]
    v_pk_fma_f32 v[58:59], v[120:121], v[134:135], v[58:59] op_sel:[0,1,0] op_sel_hi:[1,1,1]
    v_pk_mul_f32 v[56:57], v[56:57], v[118:119]
    v_pk_mul_f32 v[58:59], v[58:59], v[122:123]
    v_cvt_pk_bf16_f32 v56, v56, v57
    v_cvt_pk_bf16_f32 v57, v58, v59
    ds_write_b64 v159, v[56:57] offset:1280
    v_pk_fma_f32 v[60:61], v[116:117], v[136:137], v[60:61] op_sel:[0,0,0] op_sel_hi:[1,0,1]
    v_pk_fma_f32 v[62:63], v[120:121], v[136:137], v[62:63] op_sel:[0,0,0] op_sel_hi:[1,0,1]
    v_pk_mul_f32 v[60:61], v[60:61], v[118:119]
    v_pk_mul_f32 v[62:63], v[62:63], v[122:123]
    v_cvt_pk_bf16_f32 v60, v60, v61
    v_cvt_pk_bf16_f32 v61, v62, v63
    ds_write_b64 v160, v[60:61] offset:1280
    v_pk_fma_f32 v[64:65], v[124:125], v[132:133], v[64:65] op_sel:[0,0,0] op_sel_hi:[1,0,1]
    v_pk_fma_f32 v[66:67], v[128:129], v[132:133], v[66:67] op_sel:[0,0,0] op_sel_hi:[1,0,1]
    v_pk_mul_f32 v[64:65], v[64:65], v[126:127]
    v_pk_mul_f32 v[66:67], v[66:67], v[130:131]
    v_cvt_pk_bf16_f32 v64, v64, v65
    v_cvt_pk_bf16_f32 v65, v66, v67
    ds_write_b64 v156, v[64:65] offset:1920
    v_pk_fma_f32 v[68:69], v[124:125], v[132:133], v[68:69] op_sel:[0,1,0] op_sel_hi:[1,1,1]
    v_pk_fma_f32 v[70:71], v[128:129], v[132:133], v[70:71] op_sel:[0,1,0] op_sel_hi:[1,1,1]
    v_pk_mul_f32 v[68:69], v[68:69], v[126:127]
    v_pk_mul_f32 v[70:71], v[70:71], v[130:131]
    v_cvt_pk_bf16_f32 v68, v68, v69
    v_cvt_pk_bf16_f32 v69, v70, v71
    ds_write_b64 v157, v[68:69] offset:1920
    v_pk_fma_f32 v[72:73], v[124:125], v[134:135], v[72:73] op_sel:[0,0,0] op_sel_hi:[1,0,1]
    v_pk_fma_f32 v[74:75], v[128:129], v[134:135], v[74:75] op_sel:[0,0,0] op_sel_hi:[1,0,1]
    v_pk_mul_f32 v[72:73], v[72:73], v[126:127]
    v_pk_mul_f32 v[74:75], v[74:75], v[130:131]
    v_cvt_pk_bf16_f32 v72, v72, v73
    v_cvt_pk_bf16_f32 v73, v74, v75
    ds_write_b64 v158, v[72:73] offset:1920
    v_pk_fma_f32 v[76:77], v[124:125], v[134:135], v[76:77] op_sel:[0,1,0] op_sel_hi:[1,1,1]
    v_pk_fma_f32 v[78:79], v[128:129], v[134:135], v[78:79] op_sel:[0,1,0] op_sel_hi:[1,1,1]
    v_pk_mul_f32 v[76:77], v[76:77], v[126:127]
    v_pk_mul_f32 v[78:79], v[78:79], v[130:131]
    v_cvt_pk_bf16_f32 v76, v76, v77
    v_cvt_pk_bf16_f32 v77, v78, v79
    ds_write_b64 v159, v[76:77] offset:1920
    v_pk_fma_f32 v[80:81], v[124:125], v[136:137], v[80:81] op_sel:[0,0,0] op_sel_hi:[1,0,1]
    v_pk_fma_f32 v[82:83], v[128:129], v[136:137], v[82:83] op_sel:[0,0,0] op_sel_hi:[1,0,1]
    v_pk_mul_f32 v[80:81], v[80:81], v[126:127]
    v_pk_mul_f32 v[82:83], v[82:83], v[130:131]
    v_cvt_pk_bf16_f32 v80, v80, v81
    v_cvt_pk_bf16_f32 v81, v82, v83
    ds_write_b64 v160, v[80:81] offset:1920
    s_add_u32 s54, s54, 5767168
    s_branch L_eEnd_12
    s_cmp_eq_u32 s51, 1
    s_cbranch_scc1 L_eK_10
    v_pk_fma_f32 v[4:5], v[100:101], v[116:117], v[4:5] op_sel:[0,0,0] op_sel_hi:[0,1,1]
    v_pk_fma_f32 v[6:7], v[100:101], v[118:119], v[6:7] op_sel:[0,0,0] op_sel_hi:[0,1,1]
    v_pk_mul_f32 v[4:5], v[4:5], v[100:101] op_sel:[0,1] op_sel_hi:[1,1]
    v_pk_mul_f32 v[6:7], v[6:7], v[100:101] op_sel:[0,1] op_sel_hi:[1,1]
    v_cvt_pk_bf16_f32 v4, v4, v5
    v_cvt_pk_bf16_f32 v5, v6, v7
    ds_write_b64 v156, v[4:5] offset:0
    v_pk_fma_f32 v[8:9], v[100:101], v[120:121], v[8:9] op_sel:[0,0,0] op_sel_hi:[0,1,1]
    v_pk_fma_f32 v[10:11], v[100:101], v[122:123], v[10:11] op_sel:[0,0,0] op_sel_hi:[0,1,1]
    v_pk_mul_f32 v[8:9], v[8:9], v[100:101] op_sel:[0,1] op_sel_hi:[1,1]
    v_pk_mul_f32 v[10:11], v[10:11], v[100:101] op_sel:[0,1] op_sel_hi:[1,1]
    v_cvt_pk_bf16_f32 v8, v8, v9
    v_cvt_pk_bf16_f32 v9, v10, v11
    ds_write_b64 v157, v[8:9] offset:0
    v_pk_fma_f32 v[12:13], v[100:101], v[124:125], v[12:13] op_sel:[0,0,0] op_sel_hi:[0,1,1]
    v_pk_fma_f32 v[14:15], v[100:101], v[126:127], v[14:15] op_sel:[0,0,0] op_sel_hi:[0,1,1]
    v_pk_mul_f32 v[12:13], v[12:13], v[100:101] op_sel:[0,1] op_sel_hi:[1,1]
    v_pk_mul_f32 v[14:15], v[14:15], v[100:101] op_sel:[0,1] op_sel_hi:[1,1]
    v_cvt_pk_bf16_f32 v12, v12, v13
    v_cvt_pk_bf16_f32 v13, v14, v15
    ds_write_b64 v158, v[12:13] offset:0
    v_pk_fma_f32 v[16:17], v[100:101], v[128:129], v[16:17] op_sel:[0,0,0] op_sel_hi:[0,1,1]
    v_pk_fma_f32 v[18:19], v[100:101], v[130:131], v[18:19] op_sel:[0,0,0] op_sel_hi:[0,1,1]
    v_pk_mul_f32 v[16:17], v[16:17], v[100:101] op_sel:[0,1] op_sel_hi:[1,1]
    v_pk_mul_f32 v[18:19], v[18:19], v[100:101] op_sel:[0,1] op_sel_hi:[1,1]
    v_cvt_pk_bf16_f32 v16, v16, v17
    v_cvt_pk_bf16_f32 v17, v18, v19
    ds_write_b64 v159, v[16:17] offset:0
    v_pk_fma_f32 v[20:21], v[100:101], v[132:133], v[20:21] op_sel:[0,0,0] op_sel_hi:[0,1,1]
    v_pk_fma_f32 v[22:23], v[100:101], v[134:135], v[22:23] op_sel:[0,0,0] op_sel_hi:[0,1,1]
    v_pk_mul_f32 v[20:21], v[20:21], v[100:101] op_sel:[0,1] op_sel_hi:[1,1]
    v_pk_mul_f32 v[22:23], v[22:23], v[100:101] op_sel:[0,1] op_sel_hi:[1,1]
    v_cvt_pk_bf16_f32 v20, v20, v21
    v_cvt_pk_bf16_f32 v21, v22, v23
    ds_write_b64 v160, v[20:21] offset:0
    v_pk_fma_f32 v[24:25], v[104:105], v[116:117], v[24:25] op_sel:[0,0,0] op_sel_hi:[0,1,1]
    v_pk_fma_f32 v[26:27], v[104:105], v[118:119], v[26:27] op_sel:[0,0,0] op_sel_hi:[0,1,1]
    v_pk_mul_f32 v[24:25], v[24:25], v[104:105] op_sel:[0,1] op_sel_hi:[1,1]
    v_pk_mul_f32 v[26:27], v[26:27], v[104:105] op_sel:[0,1] op_sel_hi:[1,1]
    v_cvt_pk_bf16_f32 v24, v24, v25
    v_cvt_pk_bf16_f32 v25, v26, v27
    ds_write_b64 v156, v[24:25] offset:640
    v_pk_fma_f32 v[28:29], v[104:105], v[120:121], v[28:29] op_sel:[0,0,0] op_sel_hi:[0,1,1]
    v_pk_fma_f32 v[30:31], v[104:105], v[122:123], v[30:31] op_sel:[0,0,0] op_sel_hi:[0,1,1]
    v_pk_mul_f32 v[28:29], v[28:29], v[104:105] op_sel:[0,1] op_sel_hi:[1,1]
    v_pk_mul_f32 v[30:31], v[30:31], v[104:105] op_sel:[0,1] op_sel_hi:[1,1]
    v_cvt_pk_bf16_f32 v28, v28, v29
    v_cvt_pk_bf16_f32 v29, v30, v31
    ds_write_b64 v157, v[28:29] offset:640
    v_pk_fma_f32 v[32:33], v[104:105], v[124:125], v[32:33] op_sel:[0,0,0] op_sel_hi:[0,1,1]
    v_pk_fma_f32 v[34:35], v[104:105], v[126:127], v[34:35] op_sel:[0,0,0] op_sel_hi:[0,1,1]
    v_pk_mul_f32 v[32:33], v[32:33], v[104:105] op_sel:[0,1] op_sel_hi:[1,1]
    v_pk_mul_f32 v[34:35], v[34:35], v[104:105] op_sel:[0,1] op_sel_hi:[1,1]
    v_cvt_pk_bf16_f32 v32, v32, v33
    v_cvt_pk_bf16_f32 v33, v34, v35
    ds_write_b64 v158, v[32:33] offset:640
    v_pk_fma_f32 v[36:37], v[104:105], v[128:129], v[36:37] op_sel:[0,0,0] op_sel_hi:[0,1,1]
    v_pk_fma_f32 v[38:39], v[104:105], v[130:131], v[38:39] op_sel:[0,0,0] op_sel_hi:[0,1,1]
    v_pk_mul_f32 v[36:37], v[36:37], v[104:105] op_sel:[0,1] op_sel_hi:[1,1]
    v_pk_mul_f32 v[38:39], v[38:39], v[104:105] op_sel:[0,1] op_sel_hi:[1,1]
    v_cvt_pk_bf16_f32 v36, v36, v37
    v_cvt_pk_bf16_f32 v37, v38, v39
    ds_write_b64 v159, v[36:37] offset:640
    v_pk_fma_f32 v[40:41], v[104:105], v[132:133], v[40:41] op_sel:[0,0,0] op_sel_hi:[0,1,1]
    v_pk_fma_f32 v[42:43], v[104:105], v[134:135], v[42:43] op_sel:[0,0,0] op_sel_hi:[0,1,1]
    v_pk_mul_f32 v[40:41], v[40:41], v[104:105] op_sel:[0,1] op_sel_hi:[1,1]
    v_pk_mul_f32 v[42:43], v[42:43], v[104:105] op_sel:[0,1] op_sel_hi:[1,1]
    v_cvt_pk_bf16_f32 v40, v40, v41
    v_cvt_pk_bf16_f32 v41, v42, v43
    ds_write_b64 v160, v[40:41] offset:640
    v_pk_fma_f32 v[44:45], v[108:109], v[116:117], v[44:45] op_sel:[0,0,0] op_sel_hi:[0,1,1]
    v_pk_fma_f32 v[46:47], v[108:109], v[118:119], v[46:47] op_sel:[0,0,0] op_sel_hi:[0,1,1]
    v_pk_mul_f32 v[44:45], v[44:45], v[108:109] op_sel:[0,1] op_sel_hi:[1,1]
    v_pk_mul_f32 v[46:47], v[46:47], v[108:109] op_sel:[0,1] op_sel_hi:[1,1]
    v_cvt_pk_bf16_f32 v44, v44, v45
    v_cvt_pk_bf16_f32 v45, v46, v47
    ds_write_b64 v156, v[44:45] offset:1280
    v_pk_fma_f32 v[48:49], v[108:109], v[120:121], v[48:49] op_sel:[0,0,0] op_sel_hi:[0,1,1]
    v_pk_fma_f32 v[50:51], v[108:109], v[122:123], v[50:51] op_sel:[0,0,0] op_sel_hi:[0,1,1]
    v_pk_mul_f32 v[48:49], v[48:49], v[108:109] op_sel:[0,1] op_sel_hi:[1,1]
    v_pk_mul_f32 v[50:51], v[50:51], v[108:109] op_sel:[0,1] op_sel_hi:[1,1]
    v_cvt_pk_bf16_f32 v48, v48, v49
    v_cvt_pk_bf16_f32 v49, v50, v51
    ds_write_b64 v157, v[48:49] offset:1280
    v_pk_fma_f32 v[52:53], v[108:109], v[124:125], v[52:53] op_sel:[0,0,0] op_sel_hi:[0,1,1]
    v_pk_fma_f32 v[54:55], v[108:109], v[126:127], v[54:55] op_sel:[0,0,0] op_sel_hi:[0,1,1]
    v_pk_mul_f32 v[52:53], v[52:53], v[108:109] op_sel:[0,1] op_sel_hi:[1,1]
    v_pk_mul_f32 v[54:55], v[54:55], v[108:109] op_sel:[0,1] op_sel_hi:[1,1]
    v_cvt_pk_bf16_f32 v52, v52, v53
    v_cvt_pk_bf16_f32 v53, v54, v55
    ds_write_b64 v158, v[52:53] offset:1280
    v_pk_fma_f32 v[56:57], v[108:109], v[128:129], v[56:57] op_sel:[0,0,0] op_sel_hi:[0,1,1]
    v_pk_fma_f32 v[58:59], v[108:109], v[130:131], v[58:59] op_sel:[0,0,0] op_sel_hi:[0,1,1]
    v_pk_mul_f32 v[56:57], v[56:57], v[108:109] op_sel:[0,1] op_sel_hi:[1,1]
    v_pk_mul_f32 v[58:59], v[58:59], v[108:109] op_sel:[0,1] op_sel_hi:[1,1]
    v_cvt_pk_bf16_f32 v56, v56, v57
    v_cvt_pk_bf16_f32 v57, v58, v59
    ds_write_b64 v159, v[56:57] offset:1280
    v_pk_fma_f32 v[60:61], v[108:109], v[132:133], v[60:61] op_sel:[0,0,0] op_sel_hi:[0,1,1]
    v_pk_fma_f32 v[62:63], v[108:109], v[134:135], v[62:63] op_sel:[0,0,0] op_sel_hi:[0,1,1]
    v_pk_mul_f32 v[60:61], v[60:61], v[108:109] op_sel:[0,1] op_sel_hi:[1,1]
    v_pk_mul_f32 v[62:63], v[62:63], v[108:109] op_sel:[0,1] op_sel_hi:[1,1]
    v_cvt_pk_bf16_f32 v60, v60, v61
    v_cvt_pk_bf16_f32 v61, v62, v63
    ds_write_b64 v160, v[60:61] offset:1280
    v_pk_fma_f32 v[64:65], v[112:113], v[116:117], v[64:65] op_sel:[0,0,0] op_sel_hi:[0,1,1]
    v_pk_fma_f32 v[66:67], v[112:113], v[118:119], v[66:67] op_sel:[0,0,0] op_sel_hi:[0,1,1]
    v_pk_mul_f32 v[64:65], v[64:65], v[112:113] op_sel:[0,1] op_sel_hi:[1,1]
    v_pk_mul_f32 v[66:67], v[66:67], v[112:113] op_sel:[0,1] op_sel_hi:[1,1]
    v_cvt_pk_bf16_f32 v64, v64, v65
    v_cvt_pk_bf16_f32 v65, v66, v67
    ds_write_b64 v156, v[64:65] offset:1920
    v_pk_fma_f32 v[68:69], v[112:113], v[120:121], v[68:69] op_sel:[0,0,0] op_sel_hi:[0,1,1]
    v_pk_fma_f32 v[70:71], v[112:113], v[122:123], v[70:71] op_sel:[0,0,0] op_sel_hi:[0,1,1]
    v_pk_mul_f32 v[68:69], v[68:69], v[112:113] op_sel:[0,1] op_sel_hi:[1,1]
    v_pk_mul_f32 v[70:71], v[70:71], v[112:113] op_sel:[0,1] op_sel_hi:[1,1]
    v_cvt_pk_bf16_f32 v68, v68, v69
    v_cvt_pk_bf16_f32 v69, v70, v71
    ds_write_b64 v157, v[68:69] offset:1920
    v_pk_fma_f32 v[72:73], v[112:113], v[124:125], v[72:73] op_sel:[0,0,0] op_sel_hi:[0,1,1]
    v_pk_fma_f32 v[74:75], v[112:113], v[126:127], v[74:75] op_sel:[0,0,0] op_sel_hi:[0,1,1]
    v_pk_mul_f32 v[72:73], v[72:73], v[112:113] op_sel:[0,1] op_sel_hi:[1,1]
    v_pk_mul_f32 v[74:75], v[74:75], v[112:113] op_sel:[0,1] op_sel_hi:[1,1]
    v_cvt_pk_bf16_f32 v72, v72, v73
    v_cvt_pk_bf16_f32 v73, v74, v75
    ds_write_b64 v158, v[72:73] offset:1920
    v_pk_fma_f32 v[76:77], v[112:113], v[128:129], v[76:77] op_sel:[0,0,0] op_sel_hi:[0,1,1]
    v_pk_fma_f32 v[78:79], v[112:113], v[130:131], v[78:79] op_sel:[0,0,0] op_sel_hi:[0,1,1]
    v_pk_mul_f32 v[76:77], v[76:77], v[112:113] op_sel:[0,1] op_sel_hi:[1,1]
    v_pk_mul_f32 v[78:79], v[78:79], v[112:113] op_sel:[0,1] op_sel_hi:[1,1]
    v_cvt_pk_bf16_f32 v76, v76, v77
    v_cvt_pk_bf16_f32 v77, v78, v79
    ds_write_b64 v159, v[76:77] offset:1920
    v_pk_fma_f32 v[80:81], v[112:113], v[132:133], v[80:81] op_sel:[0,0,0] op_sel_hi:[0,1,1]
    v_pk_fma_f32 v[82:83], v[112:113], v[134:135], v[82:83] op_sel:[0,0,0] op_sel_hi:[0,1,1]
    v_pk_mul_f32 v[80:81], v[80:81], v[112:113] op_sel:[0,1] op_sel_hi:[1,1]
    v_pk_mul_f32 v[82:83], v[82:83], v[112:113] op_sel:[0,1] op_sel_hi:[1,1]
    v_cvt_pk_bf16_f32 v80, v80, v81
    v_cvt_pk_bf16_f32 v81, v82, v83
    ds_write_b64 v160, v[80:81] offset:1920
    s_add_u32 s54, s54, 0
    s_branch L_eEnd_12
L_eK_10:
    v_pk_fma_f32 v[4:5], v[100:101], v[116:117], v[4:5] op_sel:[0,0,0] op_sel_hi:[0,1,1]
    v_pk_fma_f32 v[6:7], v[100:101], v[118:119], v[6:7] op_sel:[0,0,0] op_sel_hi:[0,1,1]
    v_pk_mul_f32 v[4:5], v[4:5], v[100:101] op_sel:[0,1] op_sel_hi:[1,1]
    v_pk_mul_f32 v[6:7], v[6:7], v[100:101] op_sel:[0,1] op_sel_hi:[1,1]
    v_cvt_pk_bf16_f32 v4, v4, v5
    v_cvt_pk_bf16_f32 v5, v6, v7
    ds_write_b64 v156, v[4:5] offset:0
    v_pk_fma_f32 v[8:9], v[100:101], v[120:121], v[8:9] op_sel:[0,0,0] op_sel_hi:[0,1,1]
    v_pk_fma_f32 v[10:11], v[100:101], v[122:123], v[10:11] op_sel:[0,0,0] op_sel_hi:[0,1,1]
    v_pk_mul_f32 v[8:9], v[8:9], v[100:101] op_sel:[0,1] op_sel_hi:[1,1]
    v_pk_mul_f32 v[10:11], v[10:11], v[100:101] op_sel:[0,1] op_sel_hi:[1,1]
    v_cvt_pk_bf16_f32 v8, v8, v9
    v_cvt_pk_bf16_f32 v9, v10, v11
    ds_write_b64 v157, v[8:9] offset:0
    v_pk_fma_f32 v[12:13], v[100:101], v[124:125], v[12:13] op_sel:[0,0,0] op_sel_hi:[0,1,1]
    v_pk_fma_f32 v[14:15], v[100:101], v[126:127], v[14:15] op_sel:[0,0,0] op_sel_hi:[0,1,1]
    v_pk_mul_f32 v[12:13], v[12:13], v[100:101] op_sel:[0,1] op_sel_hi:[1,1]
    v_pk_mul_f32 v[14:15], v[14:15], v[100:101] op_sel:[0,1] op_sel_hi:[1,1]
    v_cvt_pk_bf16_f32 v12, v12, v13
    v_cvt_pk_bf16_f32 v13, v14, v15
    ds_write_b64 v158, v[12:13] offset:0
    v_pk_fma_f32 v[16:17], v[100:101], v[128:129], v[16:17] op_sel:[0,0,0] op_sel_hi:[0,1,1]
    v_pk_fma_f32 v[18:19], v[100:101], v[130:131], v[18:19] op_sel:[0,0,0] op_sel_hi:[0,1,1]
    v_pk_mul_f32 v[16:17], v[16:17], v[100:101] op_sel:[0,1] op_sel_hi:[1,1]
    v_pk_mul_f32 v[18:19], v[18:19], v[100:101] op_sel:[0,1] op_sel_hi:[1,1]
    v_cvt_pk_bf16_f32 v16, v16, v17
    v_cvt_pk_bf16_f32 v17, v18, v19
    ds_write_b64 v159, v[16:17] offset:0
    v_pk_fma_f32 v[20:21], v[100:101], v[132:133], v[20:21] op_sel:[0,0,0] op_sel_hi:[0,1,1]
    v_pk_fma_f32 v[22:23], v[100:101], v[134:135], v[22:23] op_sel:[0,0,0] op_sel_hi:[0,1,1]
    v_pk_mul_f32 v[20:21], v[20:21], v[100:101] op_sel:[0,1] op_sel_hi:[1,1]
    v_pk_mul_f32 v[22:23], v[22:23], v[100:101] op_sel:[0,1] op_sel_hi:[1,1]
    v_cvt_pk_bf16_f32 v20, v20, v21
    v_cvt_pk_bf16_f32 v21, v22, v23
    ds_write_b64 v160, v[20:21] offset:0
    v_pk_fma_f32 v[24:25], v[104:105], v[116:117], v[24:25] op_sel:[0,0,0] op_sel_hi:[0,1,1]
    v_pk_fma_f32 v[26:27], v[104:105], v[118:119], v[26:27] op_sel:[0,0,0] op_sel_hi:[0,1,1]
    v_pk_mul_f32 v[24:25], v[24:25], v[104:105] op_sel:[0,1] op_sel_hi:[1,1]
    v_pk_mul_f32 v[26:27], v[26:27], v[104:105] op_sel:[0,1] op_sel_hi:[1,1]
    v_cvt_pk_bf16_f32 v24, v24, v25
    v_cvt_pk_bf16_f32 v25, v26, v27
    ds_write_b64 v161, v[24:25] offset:0
    v_pk_fma_f32 v[28:29], v[104:105], v[120:121], v[28:29] op_sel:[0,0,0] op_sel_hi:[0,1,1]
    v_pk_fma_f32 v[30:31], v[104:105], v[122:123], v[30:31] op_sel:[0,0,0] op_sel_hi:[0,1,1]
    v_pk_mul_f32 v[28:29], v[28:29], v[104:105] op_sel:[0,1] op_sel_hi:[1,1]
    v_pk_mul_f32 v[30:31], v[30:31], v[104:105] op_sel:[0,1] op_sel_hi:[1,1]
    v_cvt_pk_bf16_f32 v28, v28, v29
    v_cvt_pk_bf16_f32 v29, v30, v31
    ds_write_b64 v162, v[28:29] offset:0
    v_pk_fma_f32 v[32:33], v[104:105], v[124:125], v[32:33] op_sel:[0,0,0] op_sel_hi:[0,1,1]
    v_pk_fma_f32 v[34:35], v[104:105], v[126:127], v[34:35] op_sel:[0,0,0] op_sel_hi:[0,1,1]
    v_pk_mul_f32 v[32:33], v[32:33], v[104:105] op_sel:[0,1] op_sel_hi:[1,1]
    v_pk_mul_f32 v[34:35], v[34:35], v[104:105] op_sel:[0,1] op_sel_hi:[1,1]
    v_cvt_pk_bf16_f32 v32, v32, v33
    v_cvt_pk_bf16_f32 v33, v34, v35
    ds_write_b64 v163, v[32:33] offset:0
    v_pk_fma_f32 v[36:37], v[104:105], v[128:129], v[36:37] op_sel:[0,0,0] op_sel_hi:[0,1,1]
    v_pk_fma_f32 v[38:39], v[104:105], v[130:131], v[38:39] op_sel:[0,0,0] op_sel_hi:[0,1,1]
    v_pk_mul_f32 v[36:37], v[36:37], v[104:105] op_sel:[0,1] op_sel_hi:[1,1]
    v_pk_mul_f32 v[38:39], v[38:39], v[104:105] op_sel:[0,1] op_sel_hi:[1,1]
    v_cvt_pk_bf16_f32 v36, v36, v37
    v_cvt_pk_bf16_f32 v37, v38, v39
    ds_write_b64 v164, v[36:37] offset:0
    v_pk_fma_f32 v[40:41], v[104:105], v[132:133], v[40:41] op_sel:[0,0,0] op_sel_hi:[0,1,1]
    v_pk_fma_f32 v[42:43], v[104:105], v[134:135], v[42:43] op_sel:[0,0,0] op_sel_hi:[0,1,1]
    v_pk_mul_f32 v[40:41], v[40:41], v[104:105] op_sel:[0,1] op_sel_hi:[1,1]
    v_pk_mul_f32 v[42:43], v[42:43], v[104:105] op_sel:[0,1] op_sel_hi:[1,1]
    v_cvt_pk_bf16_f32 v40, v40, v41
    v_cvt_pk_bf16_f32 v41, v42, v43
    ds_write_b64 v165, v[40:41] offset:0
    v_pk_fma_f32 v[44:45], v[108:109], v[116:117], v[44:45] op_sel:[0,0,0] op_sel_hi:[0,1,1]
    v_pk_fma_f32 v[46:47], v[108:109], v[118:119], v[46:47] op_sel:[0,0,0] op_sel_hi:[0,1,1]
    v_pk_mul_f32 v[44:45], v[44:45], v[108:109] op_sel:[0,1] op_sel_hi:[1,1]
    v_pk_mul_f32 v[46:47], v[46:47], v[108:109] op_sel:[0,1] op_sel_hi:[1,1]
    v_cvt_pk_bf16_f32 v44, v44, v45
    v_cvt_pk_bf16_f32 v45, v46, v47
    ds_write_b64 v156, v[44:45] offset:1280
    v_pk_fma_f32 v[48:49], v[108:109], v[120:121], v[48:49] op_sel:[0,0,0] op_sel_hi:[0,1,1]
    v_pk_fma_f32 v[50:51], v[108:109], v[122:123], v[50:51] op_sel:[0,0,0] op_sel_hi:[0,1,1]
    v_pk_mul_f32 v[48:49], v[48:49], v[108:109] op_sel:[0,1] op_sel_hi:[1,1]
    v_pk_mul_f32 v[50:51], v[50:51], v[108:109] op_sel:[0,1] op_sel_hi:[1,1]
    v_cvt_pk_bf16_f32 v48, v48, v49
    v_cvt_pk_bf16_f32 v49, v50, v51
    ds_write_b64 v157, v[48:49] offset:1280
    v_pk_fma_f32 v[52:53], v[108:109], v[124:125], v[52:53] op_sel:[0,0,0] op_sel_hi:[0,1,1]
    v_pk_fma_f32 v[54:55], v[108:109], v[126:127], v[54:55] op_sel:[0,0,0] op_sel_hi:[0,1,1]
    v_pk_mul_f32 v[52:53], v[52:53], v[108:109] op_sel:[0,1] op_sel_hi:[1,1]
    v_pk_mul_f32 v[54:55], v[54:55], v[108:109] op_sel:[0,1] op_sel_hi:[1,1]
    v_cvt_pk_bf16_f32 v52, v52, v53
    v_cvt_pk_bf16_f32 v53, v54, v55
    ds_write_b64 v158, v[52:53] offset:1280
    v_pk_fma_f32 v[56:57], v[108:109], v[128:129], v[56:57] op_sel:[0,0,0] op_sel_hi:[0,1,1]
    v_pk_fma_f32 v[58:59], v[108:109], v[130:131], v[58:59] op_sel:[0,0,0] op_sel_hi:[0,1,1]
    v_pk_mul_f32 v[56:57], v[56:57], v[108:109] op_sel:[0,1] op_sel_hi:[1,1]
    v_pk_mul_f32 v[58:59], v[58:59], v[108:109] op_sel:[0,1] op_sel_hi:[1,1]
    v_cvt_pk_bf16_f32 v56, v56, v57
    v_cvt_pk_bf16_f32 v57, v58, v59
    ds_write_b64 v159, v[56:57] offset:1280
    v_pk_fma_f32 v[60:61], v[108:109], v[132:133], v[60:61] op_sel:[0,0,0] op_sel_hi:[0,1,1]
    v_pk_fma_f32 v[62:63], v[108:109], v[134:135], v[62:63] op_sel:[0,0,0] op_sel_hi:[0,1,1]
    v_pk_mul_f32 v[60:61], v[60:61], v[108:109] op_sel:[0,1] op_sel_hi:[1,1]
    v_pk_mul_f32 v[62:63], v[62:63], v[108:109] op_sel:[0,1] op_sel_hi:[1,1]
    v_cvt_pk_bf16_f32 v60, v60, v61
    v_cvt_pk_bf16_f32 v61, v62, v63
    ds_write_b64 v160, v[60:61] offset:1280
    v_pk_fma_f32 v[64:65], v[112:113], v[116:117], v[64:65] op_sel:[0,0,0] op_sel_hi:[0,1,1]
    v_pk_fma_f32 v[66:67], v[112:113], v[118:119], v[66:67] op_sel:[0,0,0] op_sel_hi:[0,1,1]
    v_pk_mul_f32 v[64:65], v[64:65], v[112:113] op_sel:[0,1] op_sel_hi:[1,1]
    v_pk_mul_f32 v[66:67], v[66:67], v[112:113] op_sel:[0,1] op_sel_hi:[1,1]
    v_cvt_pk_bf16_f32 v64, v64, v65
    v_cvt_pk_bf16_f32 v65, v66, v67
    ds_write_b64 v161, v[64:65] offset:1280
    v_pk_fma_f32 v[68:69], v[112:113], v[120:121], v[68:69] op_sel:[0,0,0] op_sel_hi:[0,1,1]
    v_pk_fma_f32 v[70:71], v[112:113], v[122:123], v[70:71] op_sel:[0,0,0] op_sel_hi:[0,1,1]
    v_pk_mul_f32 v[68:69], v[68:69], v[112:113] op_sel:[0,1] op_sel_hi:[1,1]
    v_pk_mul_f32 v[70:71], v[70:71], v[112:113] op_sel:[0,1] op_sel_hi:[1,1]
    v_cvt_pk_bf16_f32 v68, v68, v69
    v_cvt_pk_bf16_f32 v69, v70, v71
    ds_write_b64 v162, v[68:69] offset:1280
    v_pk_fma_f32 v[72:73], v[112:113], v[124:125], v[72:73] op_sel:[0,0,0] op_sel_hi:[0,1,1]
    v_pk_fma_f32 v[74:75], v[112:113], v[126:127], v[74:75] op_sel:[0,0,0] op_sel_hi:[0,1,1]
    v_pk_mul_f32 v[72:73], v[72:73], v[112:113] op_sel:[0,1] op_sel_hi:[1,1]
    v_pk_mul_f32 v[74:75], v[74:75], v[112:113] op_sel:[0,1] op_sel_hi:[1,1]
    v_cvt_pk_bf16_f32 v72, v72, v73
    v_cvt_pk_bf16_f32 v73, v74, v75
    ds_write_b64 v163, v[72:73] offset:1280
    v_pk_fma_f32 v[76:77], v[112:113], v[128:129], v[76:77] op_sel:[0,0,0] op_sel_hi:[0,1,1]
    v_pk_fma_f32 v[78:79], v[112:113], v[130:131], v[78:79] op_sel:[0,0,0] op_sel_hi:[0,1,1]
    v_pk_mul_f32 v[76:77], v[76:77], v[112:113] op_sel:[0,1] op_sel_hi:[1,1]
    v_pk_mul_f32 v[78:79], v[78:79], v[112:113] op_sel:[0,1] op_sel_hi:[1,1]
    v_cvt_pk_bf16_f32 v76, v76, v77
    v_cvt_pk_bf16_f32 v77, v78, v79
    ds_write_b64 v164, v[76:77] offset:1280
    v_pk_fma_f32 v[80:81], v[112:113], v[132:133], v[80:81] op_sel:[0,0,0] op_sel_hi:[0,1,1]
    v_pk_fma_f32 v[82:83], v[112:113], v[134:135], v[82:83] op_sel:[0,0,0] op_sel_hi:[0,1,1]
    v_pk_mul_f32 v[80:81], v[80:81], v[112:113] op_sel:[0,1] op_sel_hi:[1,1]
    v_pk_mul_f32 v[82:83], v[82:83], v[112:113] op_sel:[0,1] op_sel_hi:[1,1]
    v_cvt_pk_bf16_f32 v80, v80, v81
    v_cvt_pk_bf16_f32 v81, v82, v83
    ds_write_b64 v165, v[80:81] offset:1280
    s_add_u32 s54, s54, 3145728
    s_branch L_eEnd_12
L_eEnd_12:
    s_waitcnt lgkmcnt(0)
    s_barrier
    ds_read_b128 v[4:7], v141 offset:0
    ds_read_b128 v[8:11], v141 offset:8192
    ds_read_b128 v[12:15], v141 offset:16384
    ds_read_b128 v[16:19], v141 offset:24576
    ds_read_b128 v[20:23], v141 offset:32768
    ds_read_b128 v[24:27], v141 offset:40960
    ds_read_b128 v[28:31], v141 offset:49152
    ds_read_b128 v[32:35], v141 offset:57344
    ds_read_b128 v[36:39], v142 offset:0
    ds_read_b128 v[40:43], v142 offset:8192
    s_add_u32 s46, s32, 0
    s_mul_i32 s47, s46, 52429
    s_lshr_b32 s47, s47, 19
    s_mul_i32 s47, s47, 71680
    s_lshl_b32 s46, s46, 10
    s_add_u32 s46, s46, s47
    s_add_u32 s46, s46, s54
    s_waitcnt lgkmcnt(9)
    buffer_store_dwordx4 v[4:7], v140, s[12:15], s46 offen sc0 sc1
    s_add_u32 s46, s32, 8
    s_mul_i32 s47, s46, 52429
    s_lshr_b32 s47, s47, 19
    s_mul_i32 s47, s47, 71680
    s_lshl_b32 s46, s46, 10
    s_add_u32 s46, s46, s47
    s_add_u32 s46, s46, s54
    s_waitcnt lgkmcnt(8)
    buffer_store_dwordx4 v[8:11], v140, s[12:15], s46 offen sc0 sc1
    s_add_u32 s46, s32, 16
    s_mul_i32 s47, s46, 52429
    s_lshr_b32 s47, s47, 19
    s_mul_i32 s47, s47, 71680
    s_lshl_b32 s46, s46, 10
    s_add_u32 s46, s46, s47
    s_add_u32 s46, s46, s54
    s_waitcnt lgkmcnt(7)
    buffer_store_dwordx4 v[12:15], v140, s[12:15], s46 offen sc0 sc1
    s_add_u32 s46, s32, 24
    s_mul_i32 s47, s46, 52429
    s_lshr_b32 s47, s47, 19
    s_mul_i32 s47, s47, 71680
    s_lshl_b32 s46, s46, 10
    s_add_u32 s46, s46, s47
    s_add_u32 s46, s46, s54
    s_waitcnt lgkmcnt(6)
    buffer_store_dwordx4 v[16:19], v140, s[12:15], s46 offen sc0 sc1
    s_add_u32 s46, s32, 32
    s_mul_i32 s47, s46, 52429
    s_lshr_b32 s47, s47, 19
    s_mul_i32 s47, s47, 71680
    s_lshl_b32 s46, s46, 10
    s_add_u32 s46, s46, s47
    s_add_u32 s46, s46, s54
    s_waitcnt lgkmcnt(5)
    buffer_store_dwordx4 v[20:23], v140, s[12:15], s46 offen sc0 sc1
    s_add_u32 s46, s32, 40
    s_mul_i32 s47, s46, 52429
    s_lshr_b32 s47, s47, 19
    s_mul_i32 s47, s47, 71680
    s_lshl_b32 s46, s46, 10
    s_add_u32 s46, s46, s47
    s_add_u32 s46, s46, s54
    s_waitcnt lgkmcnt(4)
    buffer_store_dwordx4 v[24:27], v140, s[12:15], s46 offen sc0 sc1
    s_add_u32 s46, s32, 48
    s_mul_i32 s47, s46, 52429
    s_lshr_b32 s47, s47, 19
    s_mul_i32 s47, s47, 71680
    s_lshl_b32 s46, s46, 10
    s_add_u32 s46, s46, s47
    s_add_u32 s46, s46, s54
    s_waitcnt lgkmcnt(3)
    buffer_store_dwordx4 v[28:31], v140, s[12:15], s46 offen sc0 sc1
    s_add_u32 s46, s32, 56
    s_mul_i32 s47, s46, 52429
    s_lshr_b32 s47, s47, 19
    s_mul_i32 s47, s47, 71680
    s_lshl_b32 s46, s46, 10
    s_add_u32 s46, s46, s47
    s_add_u32 s46, s46, s54
    s_waitcnt lgkmcnt(2)
    buffer_store_dwordx4 v[32:35], v140, s[12:15], s46 offen sc0 sc1
    s_add_u32 s46, s32, 64
    s_mul_i32 s47, s46, 52429
    s_lshr_b32 s47, s47, 19
    s_mul_i32 s47, s47, 71680
    s_lshl_b32 s46, s46, 10
    s_add_u32 s46, s46, s47
    s_add_u32 s46, s46, s54
    s_waitcnt lgkmcnt(1)
    buffer_store_dwordx4 v[36:39], v140, s[12:15], s46 offen sc0 sc1
    s_add_u32 s46, s32, 72
    s_mul_i32 s47, s46, 52429
    s_lshr_b32 s47, s47, 19
    s_mul_i32 s47, s47, 71680
    s_lshl_b32 s46, s46, 10
    s_add_u32 s46, s46, s47
    s_add_u32 s46, s46, s54
    s_waitcnt lgkmcnt(0)
    buffer_store_dwordx4 v[40:43], v140, s[12:15], s46 offen sc0 sc1
    s_waitcnt vmcnt(0)
    s_barrier
    s_cmp_lg_u32 s32, 0
    s_cbranch_scc1 L_nosig_13
    s_and_b32 s52, s36, 3
    s_lshl_b32 s53, s51, 3
    s_add_u32 s53, s53, s35
    s_lshl_b32 s46, s52, 5
    s_add_u32 s46, s46, s53
    s_lshl_b32 s46, s46, 2
    s_add_u32 s46, s46, 26411008
    s_mov_b64 exec, 1
    v_mov_b32 v156, 1
    buffer_store_dword v156, off, s[12:15], s46 sc0 sc1
    s_mov_b64 exec, -1
L_nosig_13:
    s_branch L_k12_ph2
L_k1_Qld:
    s_setprio 0
    s_mov_b32 s49, 122880
    v_lshrrev_b32 v157, 4, v155
    v_lshrrev_b32 v156, 3, v155
    v_mul_u32_u24 v156, 1280, v156
    v_and_b32 v158, 7, v155
    v_xor_b32 v158, v158, v157
    v_lshl_add_u32 v100, v158, 4, v156
    v_xor_b32 v101, 64, v100
    s_lshl_b32 s46, s35, 8
    s_lshl_b32 s47, s33, 5
    s_add_u32 s46, s46, s47
    s_mul_i32 s42, s46, 1280
    s_lshl_b32 s44, s33, 12
    s_mov_b32 s41, 0
    s_mov_b32 s43, 0
    s_add_u32 s46, s44, s41
    s_add_u32 s47, s42, s43
    s_add_u32 m0, s46, 0
    s_add_u32 s52, s47, 0
    buffer_load_dwordx4 v100, s[4:7], s52 offen lds
    s_add_u32 m0, s46, 1024
    s_add_u32 s52, s47, 10240
    buffer_load_dwordx4 v101, s[4:7], s52 offen lds
    s_add_u32 m0, s46, 2048
    s_add_u32 s52, s47, 20480
    buffer_load_dwordx4 v100, s[4:7], s52 offen lds
    s_add_u32 m0, s46, 3072
    s_add_u32 s52, s47, 30720
    buffer_load_dwordx4 v101, s[4:7], s52 offen lds
    s_add_u32 s46, s44, s41
    s_add_u32 s47, s42, s43
    s_add_u32 m0, s46, 16384
    s_add_u32 s52, s47, 163840
    buffer_load_dwordx4 v100, s[4:7], s52 offen lds
    s_add_u32 m0, s46, 17408
    s_add_u32 s52, s47, 174080
    buffer_load_dwordx4 v101, s[4:7], s52 offen lds
    s_add_u32 m0, s46, 18432
    s_add_u32 s52, s47, 184320
    buffer_load_dwordx4 v100, s[4:7], s52 offen lds
    s_add_u32 m0, s46, 19456
    s_add_u32 s52, s47, 194560
    buffer_load_dwordx4 v101, s[4:7], s52 offen lds
    s_add_u32 s43, s43, 128
    s_cmp_ge_u32 s43, 1280
    s_cselect_b32 s43, 0x40000000, s43
    s_add_u32 s41, s41, 32768
    s_cmp_eq_u32 s41, 98304
    s_cselect_b32 s41, 0, s41
    s_mul_i32 s53, s33, 3
    s_mov_b32 s54, 0
    s_lshl_b32 s40, s53, 10
    s_add_u32 s40, s40, s54
    s_add_u32 s40, s40, 98304
    s_lshl_b32 s53, s53, 6
    s_mul_i32 s54, s36, 320
    v_add_u32 v156, s53, v155
    v_mul_u32_u24 v158, 52429, v156
    v_lshrrev_b32 v158, 20, v158
    v_mul_u32_u24 v159, 20, v158
    v_sub_u32 v159, v156, v159
    v_lshrrev_b32 v160, 3, v158
    v_and_b32 v160, 1, v160
    v_lshlrev_b32 v160, 1, v160
    v_xor_b32 v159, v159, v160
    v_mul_u32_u24 v158, 3840, v158
    v_lshl_add_u32 v158, v159, 4, v158
    v_add_u32 v102, s54, v158
    v_cmp_le_u32 vcc, 640, v156
    v_mov_b32 v161, 0x40000000
    s_nop 0
    v_cndmask_b32 v102, v102, v161, vcc
    v_add_u32 v156, s53, v155
    v_add_u32 v156, 64, v156
    v_mul_u32_u24 v158, 52429, v156
    v_lshrrev_b32 v158, 20, v158
    v_mul_u32_u24 v159, 20, v158
    v_sub_u32 v159, v156, v159
    v_lshrrev_b32 v160, 3, v158
    v_and_b32 v160, 1, v160
    v_lshlrev_b32 v160, 1, v160
    v_xor_b32 v159, v159, v160
    v_mul_u32_u24 v158, 3840, v158
    v_lshl_add_u32 v158, v159, 4, v158
    v_add_u32 v103, s54, v158
    v_cmp_le_u32 vcc, 640, v156
    v_mov_b32 v161, 0x40000000
    s_nop 0
    v_cndmask_b32 v103, v103, v161, vcc
    v_add_u32 v156, s53, v155
    v_add_u32 v156, 128, v156
    v_mul_u32_u24 v158, 52429, v156
    v_lshrrev_b32 v158, 20, v158
    v_mul_u32_u24 v159, 20, v158
    v_sub_u32 v159, v156, v159
    v_lshrrev_b32 v160, 3, v158
    v_and_b32 v160, 1, v160
    v_lshlrev_b32 v160, 1, v160
    v_xor_b32 v159, v159, v160
    v_mul_u32_u24 v158, 3840, v158
    v_lshl_add_u32 v158, v159, 4, v158
    v_add_u32 v104, s54, v158
    v_cmp_le_u32 vcc, 640, v156
    v_mov_b32 v161, 0x40000000
    s_nop 0
    v_cndmask_b32 v104, v104, v161, vcc
    s_mov_b32 s39, 0
    s_mov_b32 s56, 0
    s_add_u32 s46, s40, s56
    s_add_u32 m0, s46, 0
    s_nop 0
    buffer_load_dwordx4 v102, s[8:11], s39 offen lds
    s_add_u32 m0, s46, 1024
    s_nop 0
    buffer_load_dwordx4 v103, s[8:11], s39 offen lds
    s_add_u32 m0, s46, 2048
    s_nop 0
    buffer_load_dwordx4 v104, s[8:11], s39 offen lds
    s_add_u32 s39, s39, s49
    s_add_u32 s56, s56, 12288
    s_cmp_eq_u32 s56, 61440
    s_cselect_b32 s56, 0, s56
    s_add_u32 s46, s40, s56
    s_add_u32 m0, s46, 0
    s_nop 0
    buffer_load_dwordx4 v102, s[8:11], s39 offen lds
    s_add_u32 m0, s46, 1024
    s_nop 0
    buffer_load_dwordx4 v103, s[8:11], s39 offen lds
    s_add_u32 m0, s46, 2048
    s_nop 0
    buffer_load_dwordx4 v104, s[8:11], s39 offen lds
    s_add_u32 s39, s39, s49
    s_add_u32 s56, s56, 12288
    s_cmp_eq_u32 s56, 61440
    s_cselect_b32 s56, 0, s56
    s_add_u32 s46, s44, s41
    s_add_u32 s47, s42, s43
    s_add_u32 m0, s46, 0
    s_add_u32 s52, s47, 0
    buffer_load_dwordx4 v100, s[4:7], s52 offen lds
    s_add_u32 m0, s46, 1024
    s_add_u32 s52, s47, 10240
    buffer_load_dwordx4 v101, s[4:7], s52 offen lds
    s_add_u32 m0, s46, 2048
    s_add_u32 s52, s47, 20480
    buffer_load_dwordx4 v100, s[4:7], s52 offen lds
    s_add_u32 m0, s46, 3072
    s_add_u32 s52, s47, 30720
    buffer_load_dwordx4 v101, s[4:7], s52 offen lds
    s_add_u32 s46, s44, s41
    s_add_u32 s47, s42, s43
    s_add_u32 m0, s46, 16384
    s_add_u32 s52, s47, 163840
    buffer_load_dwordx4 v100, s[4:7], s52 offen lds
    s_add_u32 m0, s46, 17408
    s_add_u32 s52, s47, 174080
    buffer_load_dwordx4 v101, s[4:7], s52 offen lds
    s_add_u32 m0, s46, 18432
    s_add_u32 s52, s47, 184320
    buffer_load_dwordx4 v100, s[4:7], s52 offen lds
    s_add_u32 m0, s46, 19456
    s_add_u32 s52, s47, 194560
    buffer_load_dwordx4 v101, s[4:7], s52 offen lds
    s_add_u32 s43, s43, 128
    s_cmp_ge_u32 s43, 1280
    s_cselect_b32 s43, 0x40000000, s43
    s_add_u32 s41, s41, 32768
    s_cmp_eq_u32 s41, 98304
    s_cselect_b32 s41, 0, s41
    s_add_u32 s46, s40, s56
    s_add_u32 m0, s46, 0
    s_nop 0
    buffer_load_dwordx4 v102, s[8:11], s39 offen lds
    s_add_u32 m0, s46, 1024
    s_nop 0
    buffer_load_dwordx4 v103, s[8:11], s39 offen lds
    s_add_u32 m0, s46, 2048
    s_nop 0
    buffer_load_dwordx4 v104, s[8:11], s39 offen lds
    s_add_u32 s39, s39, s49
    s_add_u32 s56, s56, 12288
    s_cmp_eq_u32 s56, 61440
    s_cselect_b32 s56, 0, s56
    s_add_u32 s46, s40, s56
    s_add_u32 m0, s46, 0
    s_nop 0
    buffer_load_dwordx4 v102, s[8:11], s39 offen lds
    s_add_u32 m0, s46, 1024
    s_nop 0
    buffer_load_dwordx4 v103, s[8:11], s39 offen lds
    s_add_u32 m0, s46, 2048
    s_nop 0
    buffer_load_dwordx4 v104, s[8:11], s39 offen lds
    s_add_u32 s39, s39, s49
    s_add_u32 s56, s56, 12288
    s_cmp_eq_u32 s56, 61440
    s_cselect_b32 s56, 0, s56
    s_add_u32 s46, s44, s41
    s_add_u32 s47, s42, s43
    s_add_u32 m0, s46, 0
    s_add_u32 s52, s47, 0
    buffer_load_dwordx4 v100, s[4:7], s52 offen lds
    s_add_u32 m0, s46, 1024
    s_add_u32 s52, s47, 10240
    buffer_load_dwordx4 v101, s[4:7], s52 offen lds
    s_add_u32 m0, s46, 2048
    s_add_u32 s52, s47, 20480
    buffer_load_dwordx4 v100, s[4:7], s52 offen lds
    s_add_u32 m0, s46, 3072
    s_add_u32 s52, s47, 30720
    buffer_load_dwordx4 v101, s[4:7], s52 offen lds
    s_waitcnt vmcnt(21)
    s_barrier
    s_add_u32 s46, s44, s41
    s_add_u32 s47, s42, s43
    s_add_u32 m0, s46, 16384
    s_add_u32 s52, s47, 163840
    buffer_load_dwordx4 v100, s[4:7], s52 offen lds
    s_add_u32 m0, s46, 17408
    s_add_u32 s52, s47, 174080
    buffer_load_dwordx4 v101, s[4:7], s52 offen lds
    s_add_u32 m0, s46, 18432
    s_add_u32 s52, s47, 184320
    buffer_load_dwordx4 v100, s[4:7], s52 offen lds
    s_add_u32 m0, s46, 19456
    s_add_u32 s52, s47, 194560
    buffer_load_dwordx4 v101, s[4:7], s52 offen lds
    s_add_u32 s43, s43, 128
    s_cmp_ge_u32 s43, 1280
    s_cselect_b32 s43, 0x40000000, s43
    s_add_u32 s41, s41, 32768
    s_cmp_eq_u32 s41, 98304
    s_cselect_b32 s41, 0, s41
    s_add_u32 s46, s40, s56
    s_add_u32 m0, s46, 0
    s_nop 0
    buffer_load_dwordx4 v102, s[8:11], s39 offen lds
    s_add_u32 m0, s46, 1024
    s_nop 0
    buffer_load_dwordx4 v103, s[8:11], s39 offen lds
    s_add_u32 m0, s46, 2048
    s_nop 0
    buffer_load_dwordx4 v104, s[8:11], s39 offen lds
    s_add_u32 s39, s39, s49
    s_add_u32 s56, s56, 12288
    s_cmp_eq_u32 s56, 61440
    s_cselect_b32 s56, 0, s56
    s_mov_b32 s37, 0
    s_mov_b32 s57, 0
    v_and_b32 v156, 15, v155
    v_lshrrev_b32 v157, 4, v155
    v_lshrrev_b32 v158, 2, v156
    v_lshl_add_u32 v158, v157, 3, v158
    v_mul_u32_u24 v158, 320, v158
    v_and_b32 v159, 3, v155
    v_lshl_add_u32 v158, v159, 3, v158
    v_and_b32 v159, 1, v157
    s_mov_b32 s53, 0
    s_mul_i32 s54, s33, 3
    s_add_u32 s53, s53, 98304
    s_add_u32 s46, s54, 0
    s_min_u32 s46, s46, 9
    v_xor_b32 v160, s46, v159
    v_lshl_add_u32 v160, v160, 5, v158
    v_add_u32 v28, s53, v160
    s_add_u32 s46, s54, 1
    s_min_u32 s46, s46, 9
    v_xor_b32 v160, s46, v159
    v_lshl_add_u32 v160, v160, 5, v158
    v_add_u32 v29, s53, v160
    s_add_u32 s46, s54, 2
    s_min_u32 s46, s46, 9
    v_xor_b32 v160, s46, v159
    v_lshl_add_u32 v160, v160, 5, v158
    v_add_u32 v30, s53, v160
    v_mov_b32 v4, 0
    v_mov_b32 v5, 0
    v_mov_b32 v6, 0
    v_mov_b32 v7, 0
    v_mov_b32 v8, 0
    v_mov_b32 v9, 0
    v_mov_b32 v10, 0
    v_mov_b32 v11, 0
    v_mov_b32 v12, 0
    v_mov_b32 v13, 0
    v_mov_b32 v14, 0
    v_mov_b32 v15, 0
    v_mov_b32 v36, 0x3f803f80
    v_mov_b32 v37, 0x3f803f80
    v_mov_b32 v38, 0x3f803f80
    v_mov_b32 v39, 0x3f803f80
    s_mov_b32 s38, 0
L_k1q_ld:
    s_waitcnt vmcnt(17)
    s_barrier
    s_add_u32 s46, s44, s41
    s_add_u32 s47, s42, s43
    s_add_u32 m0, s46, 0
    s_add_u32 s52, s47, 0
    buffer_load_dwordx4 v100, s[4:7], s52 offen lds
    s_add_u32 m0, s46, 1024
    s_add_u32 s52, s47, 10240
    buffer_load_dwordx4 v101, s[4:7], s52 offen lds
    s_add_u32 m0, s46, 2048
    s_add_u32 s52, s47, 20480
    buffer_load_dwordx4 v100, s[4:7], s52 offen lds
    s_add_u32 m0, s46, 3072
    s_add_u32 s52, s47, 30720
    buffer_load_dwordx4 v101, s[4:7], s52 offen lds
    s_add_u32 s46, s40, s56
    s_add_u32 m0, s46, 0
    s_nop 0
    buffer_load_dwordx4 v102, s[8:11], s39 offen lds
    s_add_u32 m0, s46, 1024
    s_nop 0
    buffer_load_dwordx4 v103, s[8:11], s39 offen lds
    s_add_u32 m0, s46, 2048
    s_nop 0
    buffer_load_dwordx4 v104, s[8:11], s39 offen lds
    s_add_u32 s39, s39, s49
    s_add_u32 s56, s56, 12288
    s_cmp_eq_u32 s56, 61440
    s_cselect_b32 s56, 0, s56
    s_cmp_lg_u32 s37, 3
    s_cbranch_scc1 L_wh_14
    s_cmp_lg_u32 s33, 0
    s_cbranch_scc1 L_wh_14
    buffer_load_dword v120, off, s[60:63], 0 sc1
L_wh_14:
    s_waitcnt vmcnt(21)
    s_barrier
    s_add_u32 s46, s44, s41
    s_add_u32 s47, s42, s43
    s_add_u32 m0, s46, 16384
    s_add_u32 s52, s47, 163840
    buffer_load_dwordx4 v100, s[4:7], s52 offen lds
    s_add_u32 m0, s46, 17408
    s_add_u32 s52, s47, 174080
    buffer_load_dwordx4 v101, s[4:7], s52 offen lds
    s_add_u32 m0, s46, 18432
    s_add_u32 s52, s47, 184320
    buffer_load_dwordx4 v100, s[4:7], s52 offen lds
    s_add_u32 m0, s46, 19456
    s_add_u32 s52, s47, 194560
    buffer_load_dwordx4 v101, s[4:7], s52 offen lds
    s_add_u32 s43, s43, 128
    s_cmp_ge_u32 s43, 1280
    s_cselect_b32 s43, 0x40000000, s43
    s_add_u32 s41, s41, 32768
    s_cmp_eq_u32 s41, 98304
    s_cselect_b32 s41, 0, s41
    s_add_u32 s46, s40, s56
    s_add_u32 m0, s46, 0
    s_nop 0
    buffer_load_dwordx4 v102, s[8:11], s39 offen lds
    s_add_u32 m0, s46, 1024
    s_nop 0
    buffer_load_dwordx4 v103, s[8:11], s39 offen lds
    s_add_u32 m0, s46, 2048
    s_nop 0
    buffer_load_dwordx4 v104, s[8:11], s39 offen lds
    s_add_u32 s39, s39, s49
    s_add_u32 s56, s56, 12288
    s_cmp_eq_u32 s56, 61440
    s_cselect_b32 s56, 0, s56
    s_waitcnt vmcnt(17)
    s_barrier
    s_add_u32 s46, s44, s41
    s_add_u32 s47, s42, s43
    s_add_u32 m0, s46, 0
    s_add_u32 s52, s47, 0
    buffer_load_dwordx4 v100, s[4:7], s52 offen lds
    s_add_u32 m0, s46, 1024
    s_add_u32 s52, s47, 10240
    buffer_load_dwordx4 v101, s[4:7], s52 offen lds
    s_add_u32 m0, s46, 2048
    s_add_u32 s52, s47, 20480
    buffer_load_dwordx4 v100, s[4:7], s52 offen lds
    s_add_u32 m0, s46, 3072
    s_add_u32 s52, s47, 30720
    buffer_load_dwordx4 v101, s[4:7], s52 offen lds
    s_add_u32 s46, s40, s56
    s_add_u32 m0, s46, 0
    s_nop 0
    buffer_load_dwordx4 v102, s[8:11], s39 offen lds
    s_add_u32 m0, s46, 1024
    s_nop 0
    buffer_load_dwordx4 v103, s[8:11], s39 offen lds
    s_add_u32 m0, s46, 2048
    s_nop 0
    buffer_load_dwordx4 v104, s[8:11], s39 offen lds
    s_add_u32 s39, s39, s49
    s_add_u32 s56, s56, 12288
    s_cmp_eq_u32 s56, 61440
    s_cselect_b32 s56, 0, s56
    s_waitcnt vmcnt(21)
    s_barrier
    s_add_u32 s46, s44, s41
    s_add_u32 s47, s42, s43
    s_add_u32 m0, s46, 16384
    s_add_u32 s52, s47, 163840
    buffer_load_dwordx4 v100, s[4:7], s52 offen lds
    s_add_u32 m0, s46, 17408
    s_add_u32 s52, s47, 174080
    buffer_load_dwordx4 v101, s[4:7], s52 offen lds
    s_add_u32 m0, s46, 18432
    s_add_u32 s52, s47, 184320
    buffer_load_dwordx4 v100, s[4:7], s52 offen lds
    s_add_u32 m0, s46, 19456
    s_add_u32 s52, s47, 194560
    buffer_load_dwordx4 v101, s[4:7], s52 offen lds
    s_add_u32 s43, s43, 128
    s_cmp_ge_u32 s43, 1280
    s_cselect_b32 s43, 0x40000000, s43
    s_add_u32 s41, s41, 32768
    s_cmp_eq_u32 s41, 98304
    s_cselect_b32 s41, 0, s41
    s_add_u32 s46, s40, s56
    s_add_u32 m0, s46, 0
    s_nop 0
    buffer_load_dwordx4 v102, s[8:11], s39 offen lds
    s_add_u32 m0, s46, 1024
    s_nop 0
    buffer_load_dwordx4 v103, s[8:11], s39 offen lds
    s_add_u32 m0, s46, 2048
    s_nop 0
    buffer_load_dwordx4 v104, s[8:11], s39 offen lds
    s_add_u32 s39, s39, s49
    s_add_u32 s56, s56, 12288
    s_cmp_eq_u32 s56, 61440
    s_cselect_b32 s56, 0, s56
    s_add_u32 s37, s37, 1
    s_cmp_lt_u32 s37, 4
    s_cbranch_scc1 L_k1q_ld
    s_cmp_lg_u32 s37, 4
    s_cbranch_scc1 L_wh_15
    s_cmp_lg_u32 s33, 0
    s_cbranch_scc1 L_wh_15
    s_waitcnt vmcnt(21)
    v_readfirstlane_b32 s46, v120
    s_nop 0
    s_cmp_lt_u32 s46, 16
    s_cbranch_scc1 L_wh_15
    s_mov_b32 s57, 1
    v_lshlrev_b32 v156, 4, v155
    s_lshl_b32 s46, s35, 11
    s_add_u32 s46, s46, 26214400
    buffer_load_dwordx4 v[108:111], v156, s[12:15], s46 offen sc1
    buffer_load_dwordx4 v[112:115], v156, s[12:15], s46 offen offset:1024 sc1
    s_mul_i32 s46, s36, 640
    s_add_u32 s46, s46, 26247168
    buffer_load_dwordx4 v[116:119], v156, s[12:15], s46 offen sc1
    s_add_u32 s46, s46, 21504
    buffer_load_dwordx4 v[124:127], v156, s[12:15], s46 offen sc1
    s_add_u32 s46, s46, 21504
    buffer_load_dwordx4 v[128:131], v156, s[12:15], s46 offen sc1
    s_add_u32 s46, s46, 21504
    buffer_load_dwordx4 v[132:135], v156, s[12:15], s46 offen sc1
L_wh_15:
    s_waitcnt vmcnt(17)
    s_barrier
    s_waitcnt vmcnt(14)
    s_barrier
    s_waitcnt vmcnt(7)
    s_barrier
    s_cmp_lg_u32 s37, 4
    s_cbranch_scc1 L_wh_16
    s_cmp_lg_u32 s33, 0
    s_cbranch_scc1 L_wh_16
    s_cmp_eq_u32 s57, 0
    s_cbranch_scc1 L_wh_16
    s_waitcnt vmcnt(0)
    v_lshlrev_b32 v156, 4, v155
    v_add_u32 v156, 159744, v156
    ds_write_b128 v156, v[108:111]
    ds_write_b128 v156, v[112:115] offset:1024
    v_add_f32 v116, v116, v124
    v_add_f32 v117, v117, v125
    v_add_f32 v118, v118, v126
    v_add_f32 v119, v119, v127
    v_add_f32 v128, v128, v132
    v_add_f32 v129, v129, v133
    v_add_f32 v130, v130, v134
    v_add_f32 v131, v131, v135
    v_add_f32 v116, v116, v128
    v_add_f32 v117, v117, v129
    v_add_f32 v118, v118, v130
    v_add_f32 v119, v119, v131
    s_mov_b32 exec_lo, -1
    s_mov_b32 exec_hi, 0x000000ff
    ds_write_b128 v156, v[116:119] offset:2048
    s_mov_b64 exec, -1
    s_mov_b32 s57, 2
L_wh_16:
    s_waitcnt vmcnt(7)
    s_barrier
    s_cmp_lg_u32 s33, 0
    s_cbranch_scc1 L_lddone_17
    s_cmp_eq_u32 s57, 2
    s_cbranch_scc1 L_lddone_17
    s_mov_b32 s47, 0
L_poll_18:
    buffer_load_dword v120, off, s[60:63], 0 sc1
    s_waitcnt vmcnt(0)
    v_readfirstlane_b32 s46, v120
    s_add_u32 s47, s47, 1
    s_cmp_ge_u32 s46, 16
    s_cbranch_scc1 L_ok_20
    s_cmp_ge_u32 s47, 40000
    s_cbranch_scc1 L_ok_20
    s_sleep 2
    s_branch L_poll_18
L_ok_20:
    v_lshlrev_b32 v156, 4, v155
    s_lshl_b32 s46, s35, 11
    s_add_u32 s46, s46, 26214400
    buffer_load_dwordx4 v[108:111], v156, s[12:15], s46 offen sc1
    buffer_load_dwordx4 v[112:115], v156, s[12:15], s46 offen offset:1024 sc1
    s_mul_i32 s46, s36, 640
    s_add_u32 s46, s46, 26247168
    buffer_load_dwordx4 v[116:119], v156, s[12:15], s46 offen sc1
    s_add_u32 s46, s46, 21504
    buffer_load_dwordx4 v[124:127], v156, s[12:15], s46 offen sc1
    s_add_u32 s46, s46, 21504
    buffer_load_dwordx4 v[128:131], v156, s[12:15], s46 offen sc1
    s_add_u32 s46, s46, 21504
    buffer_load_dwordx4 v[132:135], v156, s[12:15], s46 offen sc1
L_have_19:
    s_waitcnt vmcnt(0)
    v_lshlrev_b32 v156, 4, v155
    v_add_u32 v156, 159744, v156
    ds_write_b128 v156, v[108:111]
    ds_write_b128 v156, v[112:115] offset:1024
    v_add_f32 v116, v116, v124
    v_add_f32 v117, v117, v125
    v_add_f32 v118, v118, v126
    v_add_f32 v119, v119, v127
    v_add_f32 v128, v128, v132
    v_add_f32 v129, v129, v133
    v_add_f32 v130, v130, v134
    v_add_f32 v131, v131, v135
    v_add_f32 v116, v116, v128
    v_add_f32 v117, v117, v129
    v_add_f32 v118, v118, v130
    v_add_f32 v119, v119, v131
    s_mov_b32 exec_lo, -1
    s_mov_b32 exec_hi, 0x000000ff
    ds_write_b128 v156, v[116:119] offset:2048
    s_mov_b64 exec, -1
L_lddone_17:
    s_waitcnt vmcnt(0) lgkmcnt(0)
    s_setprio 0
    s_barrier
    s_barrier
    s_barrier
    s_mul_i32 s50, s35, 12
    s_add_u32 s50, s50, s36
    s_lshr_b32 s58, s50, 5
    s_add_u32 s58, s58, 12
    s_and_b32 s59, s50, 31
    s_mov_b32 s54, s50
    s_mov_b32 s52, s28
    s_mov_b32 s53, s29
    s_branch L_k12_ph2
L_k1_G:
    s_sub_u32 s36, s36, 12
    s_cmp_lt_u32 s33, 2
    s_cselect_b32 s8, s24, s26
    s_cselect_b32 s9, s25, s27
    s_mov_b32 s10, 2211840
    s_mov_b32 s11, 0x20000
    s_cmp_ge_u32 s32, 8
    s_cbranch_scc1 L_k1_Gld
    v_and_b32 v156, 15, v155
    v_lshrrev_b32 v157, 4, v155
    v_lshrrev_b32 v158, 1, v156
    v_xor_b32 v158, v158, v157
    v_lshlrev_b32 v158, 4, v158
    v_lshl_add_u32 v158, v156, 7, v158
    s_lshl_b32 s46, s33, 13
    v_add_u32 v148, s46, v158
    v_xor_b32 v149, 64, v148
    v_lshrrev_b32 v158, 2, v156
    v_lshl_add_u32 v158, v157, 3, v158
    v_mul_u32_u24 v158, 192, v158
    v_and_b32 v159, 3, v155
    v_lshl_add_u32 v158, v159, 3, v158
    s_mul_i32 s46, s34, 3
    s_lshl_b32 s47, s46, 5
    s_add_u32 s47, s47, 98304
    v_add_u32 v158, s47, v158
    v_and_b32 v159, 1, v157
    v_lshlrev_b32 v159, 5, v159
    v_add_u32 v160, v158, v159
    v_sub_u32 v161, v158, v159
    s_and_b32 s46, s46, 1
    s_cmp_eq_u32 s46, 0
    s_cselect_b64 vcc, -1, 0
    v_cndmask_b32 v151, v161, v160, vcc
    v_cndmask_b32 v152, v160, v161, vcc
    v_mov_b32 v4, 0
    v_mov_b32 v5, 0
    v_mov_b32 v6, 0
    v_mov_b32 v7, 0
    v_mov_b32 v8, 0
    v_mov_b32 v9, 0
    v_mov_b32 v10, 0
    v_mov_b32 v11, 0
    v_mov_b32 v12, 0
    v_mov_b32 v13, 0
    v_mov_b32 v14, 0
    v_mov_b32 v15, 0
    v_mov_b32 v16, 0
    v_mov_b32 v17, 0
    v_mov_b32 v18, 0
    v_mov_b32 v19, 0
    v_mov_b32 v20, 0
    v_mov_b32 v21, 0
    v_mov_b32 v22, 0
    v_mov_b32 v23, 0
    v_mov_b32 v24, 0
    v_mov_b32 v25, 0
    v_mov_b32 v26, 0
    v_mov_b32 v27, 0
    v_mov_b32 v28, 0
    v_mov_b32 v29, 0
    v_mov_b32 v30, 0
    v_mov_b32 v31, 0
    v_mov_b32 v32, 0
    v_mov_b32 v33, 0
    v_mov_b32 v34, 0
    v_mov_b32 v35, 0
    v_mov_b32 v36, 0
    v_mov_b32 v37, 0
    v_mov_b32 v38, 0
    v_mov_b32 v39, 0
    v_mov_b32 v40, 0
    v_mov_b32 v41, 0
    v_mov_b32 v42, 0
    v_mov_b32 v43, 0
    v_mov_b32 v44, 0
    v_mov_b32 v45, 0
    v_mov_b32 v46, 0
    v_mov_b32 v47, 0
    v_mov_b32 v48, 0
    v_mov_b32 v49, 0
    v_mov_b32 v50, 0
    v_mov_b32 v51, 0
    v_mov_b32 v52, 0
    v_mov_b32 v53, 0
    v_mov_b32 v54, 0
    v_mov_b32 v55, 0
    v_mov_b32 v56, 0
    v_mov_b32 v57, 0
    v_mov_b32 v58, 0
    v_mov_b32 v59, 0
    v_mov_b32 v60, 0
    v_mov_b32 v61, 0
    v_mov_b32 v62, 0
    v_mov_b32 v63, 0
    v_mov_b32 v64, 0
    v_mov_b32 v65, 0
    v_mov_b32 v66, 0
    v_mov_b32 v67, 0
    v_mov_b32 v68, 0
    v_mov_b32 v69, 0
    v_mov_b32 v70, 0
    v_mov_b32 v71, 0
    v_mov_b32 v72, 0
    v_mov_b32 v73, 0
    v_mov_b32 v74, 0
    v_mov_b32 v75, 0
    v_mov_b32 v76, 0
    v_mov_b32 v77, 0
    v_mov_b32 v78, 0
    v_mov_b32 v79, 0
    v_mov_b32 v80, 0
    v_mov_b32 v81, 0
    v_mov_b32 v82, 0
    v_mov_b32 v83, 0
    v_mov_b32 v84, 0
    v_mov_b32 v85, 0
    v_mov_b32 v86, 0
    v_mov_b32 v87, 0
    v_mov_b32 v88, 0
    v_mov_b32 v89, 0
    v_mov_b32 v90, 0
    v_mov_b32 v91, 0
    v_mov_b32 v92, 0
    v_mov_b32 v93, 0
    v_mov_b32 v94, 0
    v_mov_b32 v95, 0
    v_mov_b32 v96, 0
    v_mov_b32 v97, 0
    v_mov_b32 v98, 0
    v_mov_b32 v99, 0
    s_barrier
    s_mov_b32 s48, 0
    s_mov_b32 s38, 0
    s_mov_b32 s37, 0
    ds_read_b128 v[100:103], v148 offset:0
    ds_read_b128 v[104:107], v148 offset:2048
    ds_read_b128 v[108:111], v148 offset:4096
    ds_read_b128 v[112:115], v148 offset:6144
    v_mov_b32 v153, v151
    v_mov_b32 v154, v152
    ds_read_b64_tr_b16 v[132:133], v153 offset:0
    ds_read_b64_tr_b16 v[134:135], v153 offset:768
    ds_read_b64_tr_b16 v[136:137], v154 offset:32
    ds_read_b64_tr_b16 v[138:139], v154 offset:800
L_k1g_cl:
    v_add_u32 v150, s48, v149
    ds_read_b64_tr_b16 v[140:141], v153 offset:64
    ds_read_b64_tr_b16 v[142:143], v153 offset:832
    ds_read_b128 v[116:119], v150 offset:0
    ds_read_b128 v[120:123], v150 offset:2048
    s_waitcnt lgkmcnt(6)
    v_mfma_f32_16x16x32_bf16 v[4:7], v[132:135], v[100:103], v[4:7]
    v_mfma_f32_16x16x32_bf16 v[28:31], v[132:135], v[104:107], v[28:31]
    v_mfma_f32_16x16x32_bf16 v[52:55], v[132:135], v[108:111], v[52:55]
    v_mfma_f32_16x16x32_bf16 v[76:79], v[132:135], v[112:115], v[76:79]
    ds_read_b64_tr_b16 v[144:145], v153 offset:6144
    ds_read_b64_tr_b16 v[146:147], v153 offset:6912
    ds_read_b128 v[124:127], v150 offset:4096
    ds_read_b128 v[128:131], v150 offset:6144
    s_waitcnt lgkmcnt(8)
    v_mfma_f32_16x16x32_bf16 v[8:11], v[136:139], v[100:103], v[8:11]
    v_mfma_f32_16x16x32_bf16 v[32:35], v[136:139], v[104:107], v[32:35]
    v_mfma_f32_16x16x32_bf16 v[56:59], v[136:139], v[108:111], v[56:59]
    v_mfma_f32_16x16x32_bf16 v[80:83], v[136:139], v[112:115], v[80:83]
    ds_read_b64_tr_b16 v[132:133], v154 offset:6176
    ds_read_b64_tr_b16 v[134:135], v154 offset:6944
    s_waitcnt lgkmcnt(8)
    v_mfma_f32_16x16x32_bf16 v[12:15], v[140:143], v[100:103], v[12:15]
    v_mfma_f32_16x16x32_bf16 v[36:39], v[140:143], v[104:107], v[36:39]
    v_mfma_f32_16x16x32_bf16 v[60:63], v[140:143], v[108:111], v[60:63]
    v_mfma_f32_16x16x32_bf16 v[84:87], v[140:143], v[112:115], v[84:87]
    ds_read_b64_tr_b16 v[136:137], v153 offset:6208
    ds_read_b64_tr_b16 v[138:139], v153 offset:6976
    s_waitcnt lgkmcnt(6)
    v_mfma_f32_16x16x32_bf16 v[16:19], v[144:147], v[100:103], v[16:19]
    v_mfma_f32_16x16x32_bf16 v[40:43], v[144:147], v[104:107], v[40:43]
    v_mfma_f32_16x16x32_bf16 v[64:67], v[144:147], v[108:111], v[64:67]
    v_mfma_f32_16x16x32_bf16 v[88:91], v[144:147], v[112:115], v[88:91]
    s_waitcnt lgkmcnt(0)
    s_barrier
    s_add_u32 s38, s38, 12288
    s_cmp_eq_u32 s38, 61440
    s_cselect_b32 s38, 0, s38
    v_add_u32 v153, s38, v151
    v_add_u32 v154, s38, v152
    ds_read_b64_tr_b16 v[140:141], v153 offset:0
    ds_read_b64_tr_b16 v[142:143], v153 offset:768
    v_mfma_f32_16x16x32_bf16 v[20:23], v[132:135], v[100:103], v[20:23]
    v_mfma_f32_16x16x32_bf16 v[44:47], v[132:135], v[104:107], v[44:47]
    v_mfma_f32_16x16x32_bf16 v[68:71], v[132:135], v[108:111], v[68:71]
    v_mfma_f32_16x16x32_bf16 v[92:95], v[132:135], v[112:115], v[92:95]
    ds_read_b64_tr_b16 v[144:145], v154 offset:32
    ds_read_b64_tr_b16 v[146:147], v154 offset:800
    v_mfma_f32_16x16x32_bf16 v[24:27], v[136:139], v[100:103], v[24:27]
    v_mfma_f32_16x16x32_bf16 v[48:51], v[136:139], v[104:107], v[48:51]
    v_mfma_f32_16x16x32_bf16 v[72:75], v[136:139], v[108:111], v[72:75]
    v_mfma_f32_16x16x32_bf16 v[96:99], v[136:139], v[112:115], v[96:99]
    s_add_u32 s48, s48, 32768
    s_cmp_eq_u32 s48, 98304
    s_cselect_b32 s48, 0, s48
    v_add_u32 v150, s48, v148
    ds_read_b64_tr_b16 v[132:133], v153 offset:64
    ds_read_b64_tr_b16 v[134:135], v153 offset:832
    ds_read_b128 v[100:103], v150 offset:0
    ds_read_b128 v[104:107], v150 offset:2048
    s_waitcnt lgkmcnt(6)
    v_mfma_f32_16x16x32_bf16 v[4:7], v[140:143], v[116:119], v[4:7]
    v_mfma_f32_16x16x32_bf16 v[28:31], v[140:143], v[120:123], v[28:31]
    v_mfma_f32_16x16x32_bf16 v[52:55], v[140:143], v[124:127], v[52:55]
    v_mfma_f32_16x16x32_bf16 v[76:79], v[140:143], v[128:131], v[76:79]
    ds_read_b64_tr_b16 v[136:137], v153 offset:6144
    ds_read_b64_tr_b16 v[138:139], v153 offset:6912
    ds_read_b128 v[108:111], v150 offset:4096
    ds_read_b128 v[112:115], v150 offset:6144
    s_waitcnt lgkmcnt(8)
    v_mfma_f32_16x16x32_bf16 v[8:11], v[144:147], v[116:119], v[8:11]
    v_mfma_f32_16x16x32_bf16 v[32:35], v[144:147], v[120:123], v[32:35]
    v_mfma_f32_16x16x32_bf16 v[56:59], v[144:147], v[124:127], v[56:59]
    v_mfma_f32_16x16x32_bf16 v[80:83], v[144:147], v[128:131], v[80:83]
    ds_read_b64_tr_b16 v[140:141], v154 offset:6176
    ds_read_b64_tr_b16 v[142:143], v154 offset:6944
    s_waitcnt lgkmcnt(8)
    v_mfma_f32_16x16x32_bf16 v[12:15], v[132:135], v[116:119], v[12:15]
    v_mfma_f32_16x16x32_bf16 v[36:39], v[132:135], v[120:123], v[36:39]
    v_mfma_f32_16x16x32_bf16 v[60:63], v[132:135], v[124:127], v[60:63]
    v_mfma_f32_16x16x32_bf16 v[84:87], v[132:135], v[128:131], v[84:87]
    ds_read_b64_tr_b16 v[144:145], v153 offset:6208
    ds_read_b64_tr_b16 v[146:147], v153 offset:6976
    s_waitcnt lgkmcnt(6)
    v_mfma_f32_16x16x32_bf16 v[16:19], v[136:139], v[116:119], v[16:19]
    v_mfma_f32_16x16x32_bf16 v[40:43], v[136:139], v[120:123], v[40:43]
    v_mfma_f32_16x16x32_bf16 v[64:67], v[136:139], v[124:127], v[64:67]
    v_mfma_f32_16x16x32_bf16 v[88:91], v[136:139], v[128:131], v[88:91]
    s_waitcnt lgkmcnt(0)
    s_barrier
    s_add_u32 s38, s38, 12288
    s_cmp_eq_u32 s38, 61440
    s_cselect_b32 s38, 0, s38
    v_add_u32 v153, s38, v151
    v_add_u32 v154, s38, v152
    ds_read_b64_tr_b16 v[132:133], v153 offset:0
    ds_read_b64_tr_b16 v[134:135], v153 offset:768
    v_mfma_f32_16x16x32_bf16 v[20:23], v[140:143], v[116:119], v[20:23]
    v_mfma_f32_16x16x32_bf16 v[44:47], v[140:143], v[120:123], v[44:47]
    v_mfma_f32_16x16x32_bf16 v[68:71], v[140:143], v[124:127], v[68:71]
    v_mfma_f32_16x16x32_bf16 v[92:95], v[140:143], v[128:131], v[92:95]
    ds_read_b64_tr_b16 v[136:137], v154 offset:32
    ds_read_b64_tr_b16 v[138:139], v154 offset:800
    v_mfma_f32_16x16x32_bf16 v[24:27], v[144:147], v[116:119], v[24:27]
    v_mfma_f32_16x16x32_bf16 v[48:51], v[144:147], v[120:123], v[48:51]
    v_mfma_f32_16x16x32_bf16 v[72:75], v[144:147], v[124:127], v[72:75]
    v_mfma_f32_16x16x32_bf16 v[96:99], v[144:147], v[128:131], v[96:99]
    v_add_u32 v150, s48, v149
    ds_read_b64_tr_b16 v[140:141], v153 offset:64
    ds_read_b64_tr_b16 v[142:143], v153 offset:832
    ds_read_b128 v[116:119], v150 offset:0
    ds_read_b128 v[120:123], v150 offset:2048
    s_waitcnt lgkmcnt(6)
    v_mfma_f32_16x16x32_bf16 v[4:7], v[132:135], v[100:103], v[4:7]
    v_mfma_f32_16x16x32_bf16 v[28:31], v[132:135], v[104:107], v[28:31]
    v_mfma_f32_16x16x32_bf16 v[52:55], v[132:135], v[108:111], v[52:55]
    v_mfma_f32_16x16x32_bf16 v[76:79], v[132:135], v[112:115], v[76:79]
    ds_read_b64_tr_b16 v[144:145], v153 offset:6144
    ds_read_b64_tr_b16 v[146:147], v153 offset:6912
    ds_read_b128 v[124:127], v150 offset:4096
    ds_read_b128 v[128:131], v150 offset:6144
    s_waitcnt lgkmcnt(8)
    v_mfma_f32_16x16x32_bf16 v[8:11], v[136:139], v[100:103], v[8:11]
    v_mfma_f32_16x16x32_bf16 v[32:35], v[136:139], v[104:107], v[32:35]
    v_mfma_f32_16x16x32_bf16 v[56:59], v[136:139], v[108:111], v[56:59]
    v_mfma_f32_16x16x32_bf16 v[80:83], v[136:139], v[112:115], v[80:83]
    ds_read_b64_tr_b16 v[132:133], v154 offset:6176
    ds_read_b64_tr_b16 v[134:135], v154 offset:6944
    s_waitcnt lgkmcnt(8)
    v_mfma_f32_16x16x32_bf16 v[12:15], v[140:143], v[100:103], v[12:15]
    v_mfma_f32_16x16x32_bf16 v[36:39], v[140:143], v[104:107], v[36:39]
    v_mfma_f32_16x16x32_bf16 v[60:63], v[140:143], v[108:111], v[60:63]
    v_mfma_f32_16x16x32_bf16 v[84:87], v[140:143], v[112:115], v[84:87]
    ds_read_b64_tr_b16 v[136:137], v153 offset:6208
    ds_read_b64_tr_b16 v[138:139], v153 offset:6976
    s_waitcnt lgkmcnt(6)
    v_mfma_f32_16x16x32_bf16 v[16:19], v[144:147], v[100:103], v[16:19]
    v_mfma_f32_16x16x32_bf16 v[40:43], v[144:147], v[104:107], v[40:43]
    v_mfma_f32_16x16x32_bf16 v[64:67], v[144:147], v[108:111], v[64:67]
    v_mfma_f32_16x16x32_bf16 v[88:91], v[144:147], v[112:115], v[88:91]
    s_waitcnt lgkmcnt(0)
    s_barrier
    s_add_u32 s38, s38, 12288
    s_cmp_eq_u32 s38, 61440
    s_cselect_b32 s38, 0, s38
    v_add_u32 v153, s38, v151
    v_add_u32 v154, s38, v152
    ds_read_b64_tr_b16 v[140:141], v153 offset:0
    ds_read_b64_tr_b16 v[142:143], v153 offset:768
    v_mfma_f32_16x16x32_bf16 v[20:23], v[132:135], v[100:103], v[20:23]
    v_mfma_f32_16x16x32_bf16 v[44:47], v[132:135], v[104:107], v[44:47]
    v_mfma_f32_16x16x32_bf16 v[68:71], v[132:135], v[108:111], v[68:71]
    v_mfma_f32_16x16x32_bf16 v[92:95], v[132:135], v[112:115], v[92:95]
    ds_read_b64_tr_b16 v[144:145], v154 offset:32
    ds_read_b64_tr_b16 v[146:147], v154 offset:800
    v_mfma_f32_16x16x32_bf16 v[24:27], v[136:139], v[100:103], v[24:27]
    v_mfma_f32_16x16x32_bf16 v[48:51], v[136:139], v[104:107], v[48:51]
    v_mfma_f32_16x16x32_bf16 v[72:75], v[136:139], v[108:111], v[72:75]
    v_mfma_f32_16x16x32_bf16 v[96:99], v[136:139], v[112:115], v[96:99]
    s_add_u32 s48, s48, 32768
    s_cmp_eq_u32 s48, 98304
    s_cselect_b32 s48, 0, s48
    v_add_u32 v150, s48, v148
    ds_read_b64_tr_b16 v[132:133], v153 offset:64
    ds_read_b64_tr_b16 v[134:135], v153 offset:832
    ds_read_b128 v[100:103], v150 offset:0
    ds_read_b128 v[104:107], v150 offset:2048
    s_waitcnt lgkmcnt(6)
    v_mfma_f32_16x16x32_bf16 v[4:7], v[140:143], v[116:119], v[4:7]
    v_mfma_f32_16x16x32_bf16 v[28:31], v[140:143], v[120:123], v[28:31]
    v_mfma_f32_16x16x32_bf16 v[52:55], v[140:143], v[124:127], v[52:55]
    v_mfma_f32_16x16x32_bf16 v[76:79], v[140:143], v[128:131], v[76:79]
    ds_read_b64_tr_b16 v[136:137], v153 offset:6144
    ds_read_b64_tr_b16 v[138:139], v153 offset:6912
    ds_read_b128 v[108:111], v150 offset:4096
    ds_read_b128 v[112:115], v150 offset:6144
    s_waitcnt lgkmcnt(8)
    v_mfma_f32_16x16x32_bf16 v[8:11], v[144:147], v[116:119], v[8:11]
    v_mfma_f32_16x16x32_bf16 v[32:35], v[144:147], v[120:123], v[32:35]
    v_mfma_f32_16x16x32_bf16 v[56:59], v[144:147], v[124:127], v[56:59]
    v_mfma_f32_16x16x32_bf16 v[80:83], v[144:147], v[128:131], v[80:83]
    ds_read_b64_tr_b16 v[140:141], v154 offset:6176
    ds_read_b64_tr_b16 v[142:143], v154 offset:6944
    s_waitcnt lgkmcnt(8)
    v_mfma_f32_16x16x32_bf16 v[12:15], v[132:135], v[116:119], v[12:15]
    v_mfma_f32_16x16x32_bf16 v[36:39], v[132:135], v[120:123], v[36:39]
    v_mfma_f32_16x16x32_bf16 v[60:63], v[132:135], v[124:127], v[60:63]
    v_mfma_f32_16x16x32_bf16 v[84:87], v[132:135], v[128:131], v[84:87]
    ds_read_b64_tr_b16 v[144:145], v153 offset:6208
    ds_read_b64_tr_b16 v[146:147], v153 offset:6976
    s_waitcnt lgkmcnt(6)
    v_mfma_f32_16x16x32_bf16 v[16:19], v[136:139], v[116:119], v[16:19]
    v_mfma_f32_16x16x32_bf16 v[40:43], v[136:139], v[120:123], v[40:43]
    v_mfma_f32_16x16x32_bf16 v[64:67], v[136:139], v[124:127], v[64:67]
    v_mfma_f32_16x16x32_bf16 v[88:91], v[136:139], v[128:131], v[88:91]
    s_waitcnt lgkmcnt(0)
    s_barrier
    s_add_u32 s38, s38, 12288
    s_cmp_eq_u32 s38, 61440
    s_cselect_b32 s38, 0, s38
    v_add_u32 v153, s38, v151
    v_add_u32 v154, s38, v152
    ds_read_b64_tr_b16 v[132:133], v153 offset:0
    ds_read_b64_tr_b16 v[134:135], v153 offset:768
    v_mfma_f32_16x16x32_bf16 v[20:23], v[140:143], v[116:119], v[20:23]
    v_mfma_f32_16x16x32_bf16 v[44:47], v[140:143], v[120:123], v[44:47]
    v_mfma_f32_16x16x32_bf16 v[68:71], v[140:143], v[124:127], v[68:71]
    v_mfma_f32_16x16x32_bf16 v[92:95], v[140:143], v[128:131], v[92:95]
    ds_read_b64_tr_b16 v[136:137], v154 offset:32
    ds_read_b64_tr_b16 v[138:139], v154 offset:800
    v_mfma_f32_16x16x32_bf16 v[24:27], v[144:147], v[116:119], v[24:27]
    v_mfma_f32_16x16x32_bf16 v[48:51], v[144:147], v[120:123], v[48:51]
    v_mfma_f32_16x16x32_bf16 v[72:75], v[144:147], v[124:127], v[72:75]
    v_mfma_f32_16x16x32_bf16 v[96:99], v[144:147], v[128:131], v[96:99]
    s_add_u32 s37, s37, 1
    s_cmp_lt_u32 s37, 5
    s_cbranch_scc1 L_k1g_cl
    s_waitcnt lgkmcnt(0)
    s_barrier
    v_and_b32 v140, 15, v155
    v_lshlrev_b32 v140, 3, v140
    s_lshl_b32 s46, s33, 9
    s_add_u32 s46, s46, 159744
    v_add_u32 v140, s46, v140
    ds_read_b64 v[100:101], v140 offset:0
    ds_read_b64 v[104:105], v140 offset:128
    ds_read_b64 v[108:109], v140 offset:256
    ds_read_b64 v[112:113], v140 offset:384
    v_lshrrev_b32 v141, 4, v155
    v_lshlrev_b32 v141, 4, v141
    s_mul_i32 s46, s34, 192
    s_add_u32 s46, s46, 161792
    v_add_u32 v141, s46, v141
    ds_read_b128 v[116:119], v141 offset:0
    ds_read_b128 v[120:123], v141 offset:64
    ds_read_b128 v[124:127], v141 offset:128
    ds_read_b128 v[128:131], v141 offset:384
    ds_read_b128 v[132:135], v141 offset:448
    ds_read_b128 v[136:139], v141 offset:512
    s_waitcnt lgkmcnt(0)
    v_mul_f32 v102, v101, v101
    v_rcp_f32 v103, v102
    v_mul_f32 v101, 0xc0135761, v101
    v_mul_f32 v102, v102, v101
    v_mul_f32 v102, 0x3d372713, v102
    v_mul_f32 v106, v105, v105
    v_rcp_f32 v107, v106
    v_mul_f32 v105, 0xc0135761, v105
    v_mul_f32 v106, v106, v105
    v_mul_f32 v106, 0x3d372713, v106
    v_mul_f32 v110, v109, v109
    v_rcp_f32 v111, v110
    v_mul_f32 v109, 0xc0135761, v109
    v_mul_f32 v110, v110, v109
    v_mul_f32 v110, 0x3d372713, v110
    v_mul_f32 v114, v113, v113
    v_rcp_f32 v115, v114
    v_mul_f32 v113, 0xc0135761, v113
    v_mul_f32 v114, v114, v113
    v_mul_f32 v114, 0x3d372713, v114
    v_lshlrev_b32 v1, 4, v155
    s_lshl_b32 s46, s35, 3
    s_lshl_b32 s47, s33, 1
    s_add_u32 s46, s46, s47
    s_mul_i32 s52, s46, 108
    s_mul_i32 s46, s36, 6
    s_mul_i32 s47, s34, 3
    s_add_u32 s46, s46, s47
    s_add_u32 s52, s52, s46
    s_lshl_b32 s52, s52, 10
    s_add_u32 s52, s52, 8388608
    s_mul_i32 s46, s33, 12288
    s_mul_i32 s47, s34, 3072
    s_add_u32 s46, s46, s47
    v_add_u32 v2, s46, v1
    v_pk_fma_f32 v[4:5], v[100:101], v[116:117], v[4:5] op_sel:[0,0,0] op_sel_hi:[0,1,1]
    v_pk_fma_f32 v[16:17], v[100:101], v[128:129], v[16:17] op_sel:[0,0,0] op_sel_hi:[0,1,1]
    v_pk_fma_f32 v[6:7], v[100:101], v[118:119], v[6:7] op_sel:[0,0,0] op_sel_hi:[0,1,1]
    v_pk_fma_f32 v[18:19], v[100:101], v[130:131], v[18:19] op_sel:[0,0,0] op_sel_hi:[0,1,1]
    v_pk_mul_f32 v[140:141], v[4:5], v[4:5]
    v_pk_mul_f32 v[144:145], v[6:7], v[6:7]
    v_pk_fma_f32 v[140:141], v[102:103], v[140:141], v[100:101] op_sel:[0,0,1] op_sel_hi:[0,1,1]
    v_pk_fma_f32 v[144:145], v[102:103], v[144:145], v[100:101] op_sel:[0,0,1] op_sel_hi:[0,1,1]
    v_pk_mul_f32 v[140:141], v[140:141], v[4:5]
    v_pk_mul_f32 v[144:145], v[144:145], v[6:7]
    v_exp_f32 v140, v140
    v_exp_f32 v141, v141
    v_exp_f32 v144, v144
    v_exp_f32 v145, v145
    v_pk_mul_f32 v[142:143], v[4:5], v[16:17]
    v_pk_mul_f32 v[146:147], v[6:7], v[18:19]
    v_pk_fma_f32 v[140:141], v[102:103], v[140:141], v[102:103] op_sel:[1,0,1] op_sel_hi:[1,1,1]
    v_pk_fma_f32 v[144:145], v[102:103], v[144:145], v[102:103] op_sel:[1,0,1] op_sel_hi:[1,1,1]
    v_rcp_f32 v140, v140
    v_rcp_f32 v141, v141
    v_rcp_f32 v144, v144
    v_rcp_f32 v145, v145
    s_nop 0
    v_pk_mul_f32 v[140:141], v[140:141], v[142:143]
    v_pk_mul_f32 v[144:145], v[144:145], v[146:147]
    v_cvt_pk_bf16_f32 v148, v140, v141
    v_cvt_pk_bf16_f32 v149, v144, v145
    v_pk_fma_f32 v[28:29], v[104:105], v[116:117], v[28:29] op_sel:[0,0,0] op_sel_hi:[0,1,1]
    v_pk_fma_f32 v[40:41], v[104:105], v[128:129], v[40:41] op_sel:[0,0,0] op_sel_hi:[0,1,1]
    v_pk_fma_f32 v[30:31], v[104:105], v[118:119], v[30:31] op_sel:[0,0,0] op_sel_hi:[0,1,1]
    v_pk_fma_f32 v[42:43], v[104:105], v[130:131], v[42:43] op_sel:[0,0,0] op_sel_hi:[0,1,1]
    v_pk_mul_f32 v[140:141], v[28:29], v[28:29]
    v_pk_mul_f32 v[144:145], v[30:31], v[30:31]
    v_pk_fma_f32 v[140:141], v[106:107], v[140:141], v[104:105] op_sel:[0,0,1] op_sel_hi:[0,1,1]
    v_pk_fma_f32 v[144:145], v[106:107], v[144:145], v[104:105] op_sel:[0,0,1] op_sel_hi:[0,1,1]
    v_pk_mul_f32 v[140:141], v[140:141], v[28:29]
    v_pk_mul_f32 v[144:145], v[144:145], v[30:31]
    v_exp_f32 v140, v140
    v_exp_f32 v141, v141
    v_exp_f32 v144, v144
    v_exp_f32 v145, v145
    v_pk_mul_f32 v[142:143], v[28:29], v[40:41]
    v_pk_mul_f32 v[146:147], v[30:31], v[42:43]
    v_pk_fma_f32 v[140:141], v[106:107], v[140:141], v[106:107] op_sel:[1,0,1] op_sel_hi:[1,1,1]
    v_pk_fma_f32 v[144:145], v[106:107], v[144:145], v[106:107] op_sel:[1,0,1] op_sel_hi:[1,1,1]
    v_rcp_f32 v140, v140
    v_rcp_f32 v141, v141
    v_rcp_f32 v144, v144
    v_rcp_f32 v145, v145
    s_nop 0
    v_pk_mul_f32 v[140:141], v[140:141], v[142:143]
    v_pk_mul_f32 v[144:145], v[144:145], v[146:147]
    v_cvt_pk_bf16_f32 v150, v140, v141
    v_cvt_pk_bf16_f32 v151, v144, v145
    s_add_u32 s46, s52, 0
    s_nop 0
    v_permlane16_swap_b32 v148, v150
    v_permlane16_swap_b32 v149, v151
    ds_write_b128 v2, v[148:151] offset:0
    v_pk_fma_f32 v[52:53], v[108:109], v[116:117], v[52:53] op_sel:[0,0,0] op_sel_hi:[0,1,1]
    v_pk_fma_f32 v[64:65], v[108:109], v[128:129], v[64:65] op_sel:[0,0,0] op_sel_hi:[0,1,1]
    v_pk_fma_f32 v[54:55], v[108:109], v[118:119], v[54:55] op_sel:[0,0,0] op_sel_hi:[0,1,1]
    v_pk_fma_f32 v[66:67], v[108:109], v[130:131], v[66:67] op_sel:[0,0,0] op_sel_hi:[0,1,1]
    v_pk_mul_f32 v[140:141], v[52:53], v[52:53]
    v_pk_mul_f32 v[144:145], v[54:55], v[54:55]
    v_pk_fma_f32 v[140:141], v[110:111], v[140:141], v[108:109] op_sel:[0,0,1] op_sel_hi:[0,1,1]
    v_pk_fma_f32 v[144:145], v[110:111], v[144:145], v[108:109] op_sel:[0,0,1] op_sel_hi:[0,1,1]
    v_pk_mul_f32 v[140:141], v[140:141], v[52:53]
    v_pk_mul_f32 v[144:145], v[144:145], v[54:55]
    v_exp_f32 v140, v140
    v_exp_f32 v141, v141
    v_exp_f32 v144, v144
    v_exp_f32 v145, v145
    v_pk_mul_f32 v[142:143], v[52:53], v[64:65]
    v_pk_mul_f32 v[146:147], v[54:55], v[66:67]
    v_pk_fma_f32 v[140:141], v[110:111], v[140:141], v[110:111] op_sel:[1,0,1] op_sel_hi:[1,1,1]
    v_pk_fma_f32 v[144:145], v[110:111], v[144:145], v[110:111] op_sel:[1,0,1] op_sel_hi:[1,1,1]
    v_rcp_f32 v140, v140
    v_rcp_f32 v141, v141
    v_rcp_f32 v144, v144
    v_rcp_f32 v145, v145
    s_nop 0
    v_pk_mul_f32 v[140:141], v[140:141], v[142:143]
    v_pk_mul_f32 v[144:145], v[144:145], v[146:147]
    v_cvt_pk_bf16_f32 v160, v140, v141
    v_cvt_pk_bf16_f32 v161, v144, v145
    v_pk_fma_f32 v[76:77], v[112:113], v[116:117], v[76:77] op_sel:[0,0,0] op_sel_hi:[0,1,1]
    v_pk_fma_f32 v[88:89], v[112:113], v[128:129], v[88:89] op_sel:[0,0,0] op_sel_hi:[0,1,1]
    v_pk_fma_f32 v[78:79], v[112:113], v[118:119], v[78:79] op_sel:[0,0,0] op_sel_hi:[0,1,1]
    v_pk_fma_f32 v[90:91], v[112:113], v[130:131], v[90:91] op_sel:[0,0,0] op_sel_hi:[0,1,1]
    v_pk_mul_f32 v[140:141], v[76:77], v[76:77]
    v_pk_mul_f32 v[144:145], v[78:79], v[78:79]
    v_pk_fma_f32 v[140:141], v[114:115], v[140:141], v[112:113] op_sel:[0,0,1] op_sel_hi:[0,1,1]
    v_pk_fma_f32 v[144:145], v[114:115], v[144:145], v[112:113] op_sel:[0,0,1] op_sel_hi:[0,1,1]
    v_pk_mul_f32 v[140:141], v[140:141], v[76:77]
    v_pk_mul_f32 v[144:145], v[144:145], v[78:79]
    v_exp_f32 v140, v140
    v_exp_f32 v141, v141
    v_exp_f32 v144, v144
    v_exp_f32 v145, v145
    v_pk_mul_f32 v[142:143], v[76:77], v[88:89]
    v_pk_mul_f32 v[146:147], v[78:79], v[90:91]
    v_pk_fma_f32 v[140:141], v[114:115], v[140:141], v[114:115] op_sel:[1,0,1] op_sel_hi:[1,1,1]
    v_pk_fma_f32 v[144:145], v[114:115], v[144:145], v[114:115] op_sel:[1,0,1] op_sel_hi:[1,1,1]
    v_rcp_f32 v140, v140
    v_rcp_f32 v141, v141
    v_rcp_f32 v144, v144
    v_rcp_f32 v145, v145
    s_nop 0
    v_pk_mul_f32 v[140:141], v[140:141], v[142:143]
    v_pk_mul_f32 v[144:145], v[144:145], v[146:147]
    v_cvt_pk_bf16_f32 v162, v140, v141
    v_cvt_pk_bf16_f32 v163, v144, v145
    s_add_u32 s46, s52, 110592
    s_nop 0
    v_permlane16_swap_b32 v160, v162
    v_permlane16_swap_b32 v161, v163
    ds_write_b128 v2, v[160:163] offset:6144
    v_pk_fma_f32 v[8:9], v[100:101], v[120:121], v[8:9] op_sel:[0,0,0] op_sel_hi:[0,1,1]
    v_pk_fma_f32 v[20:21], v[100:101], v[132:133], v[20:21] op_sel:[0,0,0] op_sel_hi:[0,1,1]
    v_pk_fma_f32 v[10:11], v[100:101], v[122:123], v[10:11] op_sel:[0,0,0] op_sel_hi:[0,1,1]
    v_pk_fma_f32 v[22:23], v[100:101], v[134:135], v[22:23] op_sel:[0,0,0] op_sel_hi:[0,1,1]
    v_pk_mul_f32 v[140:141], v[8:9], v[8:9]
    v_pk_mul_f32 v[144:145], v[10:11], v[10:11]
    v_pk_fma_f32 v[140:141], v[102:103], v[140:141], v[100:101] op_sel:[0,0,1] op_sel_hi:[0,1,1]
    v_pk_fma_f32 v[144:145], v[102:103], v[144:145], v[100:101] op_sel:[0,0,1] op_sel_hi:[0,1,1]
    v_pk_mul_f32 v[140:141], v[140:141], v[8:9]
    v_pk_mul_f32 v[144:145], v[144:145], v[10:11]
    v_exp_f32 v140, v140
    v_exp_f32 v141, v141
    v_exp_f32 v144, v144
    v_exp_f32 v145, v145
    v_pk_mul_f32 v[142:143], v[8:9], v[20:21]
    v_pk_mul_f32 v[146:147], v[10:11], v[22:23]
    v_pk_fma_f32 v[140:141], v[102:103], v[140:141], v[102:103] op_sel:[1,0,1] op_sel_hi:[1,1,1]
    v_pk_fma_f32 v[144:145], v[102:103], v[144:145], v[102:103] op_sel:[1,0,1] op_sel_hi:[1,1,1]
    v_rcp_f32 v140, v140
    v_rcp_f32 v141, v141
    v_rcp_f32 v144, v144
    v_rcp_f32 v145, v145
    s_nop 0
    v_pk_mul_f32 v[140:141], v[140:141], v[142:143]
    v_pk_mul_f32 v[144:145], v[144:145], v[146:147]
    v_cvt_pk_bf16_f32 v164, v140, v141
    v_cvt_pk_bf16_f32 v165, v144, v145
    v_pk_fma_f32 v[32:33], v[104:105], v[120:121], v[32:33] op_sel:[0,0,0] op_sel_hi:[0,1,1]
    v_pk_fma_f32 v[44:45], v[104:105], v[132:133], v[44:45] op_sel:[0,0,0] op_sel_hi:[0,1,1]
    v_pk_fma_f32 v[34:35], v[104:105], v[122:123], v[34:35] op_sel:[0,0,0] op_sel_hi:[0,1,1]
    v_pk_fma_f32 v[46:47], v[104:105], v[134:135], v[46:47] op_sel:[0,0,0] op_sel_hi:[0,1,1]
    v_pk_mul_f32 v[140:141], v[32:33], v[32:33]
    v_pk_mul_f32 v[144:145], v[34:35], v[34:35]
    v_pk_fma_f32 v[140:141], v[106:107], v[140:141], v[104:105] op_sel:[0,0,1] op_sel_hi:[0,1,1]
    v_pk_fma_f32 v[144:145], v[106:107], v[144:145], v[104:105] op_sel:[0,0,1] op_sel_hi:[0,1,1]
    v_pk_mul_f32 v[140:141], v[140:141], v[32:33]
    v_pk_mul_f32 v[144:145], v[144:145], v[34:35]
    v_exp_f32 v140, v140
    v_exp_f32 v141, v141
    v_exp_f32 v144, v144
    v_exp_f32 v145, v145
    v_pk_mul_f32 v[142:143], v[32:33], v[44:45]
    v_pk_mul_f32 v[146:147], v[34:35], v[46:47]
    v_pk_fma_f32 v[140:141], v[106:107], v[140:141], v[106:107] op_sel:[1,0,1] op_sel_hi:[1,1,1]
    v_pk_fma_f32 v[144:145], v[106:107], v[144:145], v[106:107] op_sel:[1,0,1] op_sel_hi:[1,1,1]
    v_rcp_f32 v140, v140
    v_rcp_f32 v141, v141
    v_rcp_f32 v144, v144
    v_rcp_f32 v145, v145
    s_nop 0
    v_pk_mul_f32 v[140:141], v[140:141], v[142:143]
    v_pk_mul_f32 v[144:145], v[144:145], v[146:147]
    v_cvt_pk_bf16_f32 v166, v140, v141
    v_cvt_pk_bf16_f32 v167, v144, v145
    s_add_u32 s46, s52, 1024
    s_nop 0
    v_permlane16_swap_b32 v164, v166
    v_permlane16_swap_b32 v165, v167
    ds_write_b128 v2, v[164:167] offset:1024
    v_pk_fma_f32 v[56:57], v[108:109], v[120:121], v[56:57] op_sel:[0,0,0] op_sel_hi:[0,1,1]
    v_pk_fma_f32 v[68:69], v[108:109], v[132:133], v[68:69] op_sel:[0,0,0] op_sel_hi:[0,1,1]
    v_pk_fma_f32 v[58:59], v[108:109], v[122:123], v[58:59] op_sel:[0,0,0] op_sel_hi:[0,1,1]
    v_pk_fma_f32 v[70:71], v[108:109], v[134:135], v[70:71] op_sel:[0,0,0] op_sel_hi:[0,1,1]
    v_pk_mul_f32 v[140:141], v[56:57], v[56:57]
    v_pk_mul_f32 v[144:145], v[58:59], v[58:59]
    v_pk_fma_f32 v[140:141], v[110:111], v[140:141], v[108:109] op_sel:[0,0,1] op_sel_hi:[0,1,1]
    v_pk_fma_f32 v[144:145], v[110:111], v[144:145], v[108:109] op_sel:[0,0,1] op_sel_hi:[0,1,1]
    v_pk_mul_f32 v[140:141], v[140:141], v[56:57]
    v_pk_mul_f32 v[144:145], v[144:145], v[58:59]
    v_exp_f32 v140, v140
    v_exp_f32 v141, v141
    v_exp_f32 v144, v144
    v_exp_f32 v145, v145
    v_pk_mul_f32 v[142:143], v[56:57], v[68:69]
    v_pk_mul_f32 v[146:147], v[58:59], v[70:71]
    v_pk_fma_f32 v[140:141], v[110:111], v[140:141], v[110:111] op_sel:[1,0,1] op_sel_hi:[1,1,1]
    v_pk_fma_f32 v[144:145], v[110:111], v[144:145], v[110:111] op_sel:[1,0,1] op_sel_hi:[1,1,1]
    v_rcp_f32 v140, v140
    v_rcp_f32 v141, v141
    v_rcp_f32 v144, v144
    v_rcp_f32 v145, v145
    s_nop 0
    v_pk_mul_f32 v[140:141], v[140:141], v[142:143]
    v_pk_mul_f32 v[144:145], v[144:145], v[146:147]
    v_cvt_pk_bf16_f32 v148, v140, v141
    v_cvt_pk_bf16_f32 v149, v144, v145
    v_pk_fma_f32 v[80:81], v[112:113], v[120:121], v[80:81] op_sel:[0,0,0] op_sel_hi:[0,1,1]
    v_pk_fma_f32 v[92:93], v[112:113], v[132:133], v[92:93] op_sel:[0,0,0] op_sel_hi:[0,1,1]
    v_pk_fma_f32 v[82:83], v[112:113], v[122:123], v[82:83] op_sel:[0,0,0] op_sel_hi:[0,1,1]
    v_pk_fma_f32 v[94:95], v[112:113], v[134:135], v[94:95] op_sel:[0,0,0] op_sel_hi:[0,1,1]
    v_pk_mul_f32 v[140:141], v[80:81], v[80:81]
    v_pk_mul_f32 v[144:145], v[82:83], v[82:83]
    v_pk_fma_f32 v[140:141], v[114:115], v[140:141], v[112:113] op_sel:[0,0,1] op_sel_hi:[0,1,1]
    v_pk_fma_f32 v[144:145], v[114:115], v[144:145], v[112:113] op_sel:[0,0,1] op_sel_hi:[0,1,1]
    v_pk_mul_f32 v[140:141], v[140:141], v[80:81]
    v_pk_mul_f32 v[144:145], v[144:145], v[82:83]
    v_exp_f32 v140, v140
    v_exp_f32 v141, v141
    v_exp_f32 v144, v144
    v_exp_f32 v145, v145
    v_pk_mul_f32 v[142:143], v[80:81], v[92:93]
    v_pk_mul_f32 v[146:147], v[82:83], v[94:95]
    v_pk_fma_f32 v[140:141], v[114:115], v[140:141], v[114:115] op_sel:[1,0,1] op_sel_hi:[1,1,1]
    v_pk_fma_f32 v[144:145], v[114:115], v[144:145], v[114:115] op_sel:[1,0,1] op_sel_hi:[1,1,1]
    v_rcp_f32 v140, v140
    v_rcp_f32 v141, v141
    v_rcp_f32 v144, v144
    v_rcp_f32 v145, v145
    s_nop 0
    v_pk_mul_f32 v[140:141], v[140:141], v[142:143]
    v_pk_mul_f32 v[144:145], v[144:145], v[146:147]
    v_cvt_pk_bf16_f32 v150, v140, v141
    v_cvt_pk_bf16_f32 v151, v144, v145
    s_add_u32 s46, s52, 111616
    s_nop 0
    v_permlane16_swap_b32 v148, v150
    v_permlane16_swap_b32 v149, v151
    ds_write_b128 v2, v[148:151] offset:7168
    v_pk_fma_f32 v[12:13], v[100:101], v[124:125], v[12:13] op_sel:[0,0,0] op_sel_hi:[0,1,1]
    v_pk_fma_f32 v[24:25], v[100:101], v[136:137], v[24:25] op_sel:[0,0,0] op_sel_hi:[0,1,1]
    v_pk_fma_f32 v[14:15], v[100:101], v[126:127], v[14:15] op_sel:[0,0,0] op_sel_hi:[0,1,1]
    v_pk_fma_f32 v[26:27], v[100:101], v[138:139], v[26:27] op_sel:[0,0,0] op_sel_hi:[0,1,1]
    v_pk_mul_f32 v[140:141], v[12:13], v[12:13]
    v_pk_mul_f32 v[144:145], v[14:15], v[14:15]
    v_pk_fma_f32 v[140:141], v[102:103], v[140:141], v[100:101] op_sel:[0,0,1] op_sel_hi:[0,1,1]
    v_pk_fma_f32 v[144:145], v[102:103], v[144:145], v[100:101] op_sel:[0,0,1] op_sel_hi:[0,1,1]
    v_pk_mul_f32 v[140:141], v[140:141], v[12:13]
    v_pk_mul_f32 v[144:145], v[144:145], v[14:15]
    v_exp_f32 v140, v140
    v_exp_f32 v141, v141
    v_exp_f32 v144, v144
    v_exp_f32 v145, v145
    v_pk_mul_f32 v[142:143], v[12:13], v[24:25]
    v_pk_mul_f32 v[146:147], v[14:15], v[26:27]
    v_pk_fma_f32 v[140:141], v[102:103], v[140:141], v[102:103] op_sel:[1,0,1] op_sel_hi:[1,1,1]
    v_pk_fma_f32 v[144:145], v[102:103], v[144:145], v[102:103] op_sel:[1,0,1] op_sel_hi:[1,1,1]
    v_rcp_f32 v140, v140
    v_rcp_f32 v141, v141
    v_rcp_f32 v144, v144
    v_rcp_f32 v145, v145
    s_nop 0
    v_pk_mul_f32 v[140:141], v[140:141], v[142:143]
    v_pk_mul_f32 v[144:145], v[144:145], v[146:147]
    v_cvt_pk_bf16_f32 v160, v140, v141
    v_cvt_pk_bf16_f32 v161, v144, v145
    v_pk_fma_f32 v[36:37], v[104:105], v[124:125], v[36:37] op_sel:[0,0,0] op_sel_hi:[0,1,1]
    v_pk_fma_f32 v[48:49], v[104:105], v[136:137], v[48:49] op_sel:[0,0,0] op_sel_hi:[0,1,1]
    v_pk_fma_f32 v[38:39], v[104:105], v[126:127], v[38:39] op_sel:[0,0,0] op_sel_hi:[0,1,1]
    v_pk_fma_f32 v[50:51], v[104:105], v[138:139], v[50:51] op_sel:[0,0,0] op_sel_hi:[0,1,1]
    v_pk_mul_f32 v[140:141], v[36:37], v[36:37]
    v_pk_mul_f32 v[144:145], v[38:39], v[38:39]
    v_pk_fma_f32 v[140:141], v[106:107], v[140:141], v[104:105] op_sel:[0,0,1] op_sel_hi:[0,1,1]
    v_pk_fma_f32 v[144:145], v[106:107], v[144:145], v[104:105] op_sel:[0,0,1] op_sel_hi:[0,1,1]
    v_pk_mul_f32 v[140:141], v[140:141], v[36:37]
    v_pk_mul_f32 v[144:145], v[144:145], v[38:39]
    v_exp_f32 v140, v140
    v_exp_f32 v141, v141
    v_exp_f32 v144, v144
    v_exp_f32 v145, v145
    v_pk_mul_f32 v[142:143], v[36:37], v[48:49]
    v_pk_mul_f32 v[146:147], v[38:39], v[50:51]
    v_pk_fma_f32 v[140:141], v[106:107], v[140:141], v[106:107] op_sel:[1,0,1] op_sel_hi:[1,1,1]
    v_pk_fma_f32 v[144:145], v[106:107], v[144:145], v[106:107] op_sel:[1,0,1] op_sel_hi:[1,1,1]
    v_rcp_f32 v140, v140
    v_rcp_f32 v141, v141
    v_rcp_f32 v144, v144
    v_rcp_f32 v145, v145
    s_nop 0
    v_pk_mul_f32 v[140:141], v[140:141], v[142:143]
    v_pk_mul_f32 v[144:145], v[144:145], v[146:147]
    v_cvt_pk_bf16_f32 v162, v140, v141
    v_cvt_pk_bf16_f32 v163, v144, v145
    s_add_u32 s46, s52, 2048
    s_nop 0
    v_permlane16_swap_b32 v160, v162
    v_permlane16_swap_b32 v161, v163
    ds_write_b128 v2, v[160:163] offset:2048
    v_pk_fma_f32 v[60:61], v[108:109], v[124:125], v[60:61] op_sel:[0,0,0] op_sel_hi:[0,1,1]
    v_pk_fma_f32 v[72:73], v[108:109], v[136:137], v[72:73] op_sel:[0,0,0] op_sel_hi:[0,1,1]
    v_pk_fma_f32 v[62:63], v[108:109], v[126:127], v[62:63] op_sel:[0,0,0] op_sel_hi:[0,1,1]
    v_pk_fma_f32 v[74:75], v[108:109], v[138:139], v[74:75] op_sel:[0,0,0] op_sel_hi:[0,1,1]
    v_pk_mul_f32 v[140:141], v[60:61], v[60:61]
    v_pk_mul_f32 v[144:145], v[62:63], v[62:63]
    v_pk_fma_f32 v[140:141], v[110:111], v[140:141], v[108:109] op_sel:[0,0,1] op_sel_hi:[0,1,1]
    v_pk_fma_f32 v[144:145], v[110:111], v[144:145], v[108:109] op_sel:[0,0,1] op_sel_hi:[0,1,1]
    v_pk_mul_f32 v[140:141], v[140:141], v[60:61]
    v_pk_mul_f32 v[144:145], v[144:145], v[62:63]
    v_exp_f32 v140, v140
    v_exp_f32 v141, v141
    v_exp_f32 v144, v144
    v_exp_f32 v145, v145
    v_pk_mul_f32 v[142:143], v[60:61], v[72:73]
    v_pk_mul_f32 v[146:147], v[62:63], v[74:75]
    v_pk_fma_f32 v[140:141], v[110:111], v[140:141], v[110:111] op_sel:[1,0,1] op_sel_hi:[1,1,1]
    v_pk_fma_f32 v[144:145], v[110:111], v[144:145], v[110:111] op_sel:[1,0,1] op_sel_hi:[1,1,1]
    v_rcp_f32 v140, v140
    v_rcp_f32 v141, v141
    v_rcp_f32 v144, v144
    v_rcp_f32 v145, v145
    s_nop 0
    v_pk_mul_f32 v[140:141], v[140:141], v[142:143]
    v_pk_mul_f32 v[144:145], v[144:145], v[146:147]
    v_cvt_pk_bf16_f32 v164, v140, v141
    v_cvt_pk_bf16_f32 v165, v144, v145
    v_pk_fma_f32 v[84:85], v[112:113], v[124:125], v[84:85] op_sel:[0,0,0] op_sel_hi:[0,1,1]
    v_pk_fma_f32 v[96:97], v[112:113], v[136:137], v[96:97] op_sel:[0,0,0] op_sel_hi:[0,1,1]
    v_pk_fma_f32 v[86:87], v[112:113], v[126:127], v[86:87] op_sel:[0,0,0] op_sel_hi:[0,1,1]
    v_pk_fma_f32 v[98:99], v[112:113], v[138:139], v[98:99] op_sel:[0,0,0] op_sel_hi:[0,1,1]
    v_pk_mul_f32 v[140:141], v[84:85], v[84:85]
    v_pk_mul_f32 v[144:145], v[86:87], v[86:87]
    v_pk_fma_f32 v[140:141], v[114:115], v[140:141], v[112:113] op_sel:[0,0,1] op_sel_hi:[0,1,1]
    v_pk_fma_f32 v[144:145], v[114:115], v[144:145], v[112:113] op_sel:[0,0,1] op_sel_hi:[0,1,1]
    v_pk_mul_f32 v[140:141], v[140:141], v[84:85]
    v_pk_mul_f32 v[144:145], v[144:145], v[86:87]
    v_exp_f32 v140, v140
    v_exp_f32 v141, v141
    v_exp_f32 v144, v144
    v_exp_f32 v145, v145
    v_pk_mul_f32 v[142:143], v[84:85], v[96:97]
    v_pk_mul_f32 v[146:147], v[86:87], v[98:99]
    v_pk_fma_f32 v[140:141], v[114:115], v[140:141], v[114:115] op_sel:[1,0,1] op_sel_hi:[1,1,1]
    v_pk_fma_f32 v[144:145], v[114:115], v[144:145], v[114:115] op_sel:[1,0,1] op_sel_hi:[1,1,1]
    v_rcp_f32 v140, v140
    v_rcp_f32 v141, v141
    v_rcp_f32 v144, v144
    v_rcp_f32 v145, v145
    s_nop 0
    v_pk_mul_f32 v[140:141], v[140:141], v[142:143]
    v_pk_mul_f32 v[144:145], v[144:145], v[146:147]
    v_cvt_pk_bf16_f32 v166, v140, v141
    v_cvt_pk_bf16_f32 v167, v144, v145
    s_add_u32 s46, s52, 112640
    s_nop 0
    v_permlane16_swap_b32 v164, v166
    v_permlane16_swap_b32 v165, v167
    ds_write_b128 v2, v[164:167] offset:8192
    s_waitcnt lgkmcnt(0)
    s_branch L_k12_ph2
L_k1_Gld:
    s_setprio 0
    s_mov_b32 s49, 110592
    v_lshrrev_b32 v157, 4, v155
    v_lshrrev_b32 v156, 3, v155
    v_mul_u32_u24 v156, 1280, v156
    v_and_b32 v158, 7, v155
    v_xor_b32 v158, v158, v157
    v_lshl_add_u32 v100, v158, 4, v156
    v_xor_b32 v101, 64, v100
    s_lshl_b32 s46, s35, 8
    s_lshl_b32 s47, s33, 5
    s_add_u32 s46, s46, s47
    s_mul_i32 s42, s46, 1280
    s_lshl_b32 s44, s33, 12
    s_mov_b32 s41, 0
    s_mov_b32 s43, 0
    s_add_u32 s46, s44, s41
    s_add_u32 s47, s42, s43
    s_add_u32 m0, s46, 0
    s_add_u32 s52, s47, 0
    buffer_load_dwordx4 v100, s[4:7], s52 offen lds
    s_add_u32 m0, s46, 1024
    s_add_u32 s52, s47, 10240
    buffer_load_dwordx4 v101, s[4:7], s52 offen lds
    s_add_u32 m0, s46, 2048
    s_add_u32 s52, s47, 20480
    buffer_load_dwordx4 v100, s[4:7], s52 offen lds
    s_add_u32 m0, s46, 3072
    s_add_u32 s52, s47, 30720
    buffer_load_dwordx4 v101, s[4:7], s52 offen lds
    s_add_u32 s46, s44, s41
    s_add_u32 s47, s42, s43
    s_add_u32 m0, s46, 16384
    s_add_u32 s52, s47, 163840
    buffer_load_dwordx4 v100, s[4:7], s52 offen lds
    s_add_u32 m0, s46, 17408
    s_add_u32 s52, s47, 174080
    buffer_load_dwordx4 v101, s[4:7], s52 offen lds
    s_add_u32 m0, s46, 18432
    s_add_u32 s52, s47, 184320
    buffer_load_dwordx4 v100, s[4:7], s52 offen lds
    s_add_u32 m0, s46, 19456
    s_add_u32 s52, s47, 194560
    buffer_load_dwordx4 v101, s[4:7], s52 offen lds
    s_add_u32 s43, s43, 128
    s_cmp_ge_u32 s43, 1280
    s_cselect_b32 s43, 0x40000000, s43
    s_add_u32 s41, s41, 32768
    s_cmp_eq_u32 s41, 98304
    s_cselect_b32 s41, 0, s41
    s_and_b32 s53, s33, 1
    s_mul_i32 s53, s53, 3
    s_lshr_b32 s54, s33, 1
    s_mul_i32 s54, s54, 6144
    s_lshl_b32 s40, s53, 10
    s_add_u32 s40, s40, s54
    s_add_u32 s40, s40, 98304
    s_lshl_b32 s53, s53, 6
    s_mul_i32 s54, s36, 192
    v_add_u32 v156, s53, v155
    v_mul_u32_u24 v158, 43691, v156
    v_lshrrev_b32 v158, 19, v158
    v_mul_u32_u24 v159, 12, v158
    v_sub_u32 v159, v156, v159
    v_lshrrev_b32 v160, 3, v158
    v_and_b32 v160, 1, v160
    v_lshlrev_b32 v160, 1, v160
    v_xor_b32 v159, v159, v160
    v_mul_u32_u24 v158, 3456, v158
    v_lshl_add_u32 v158, v159, 4, v158
    v_add_u32 v102, s54, v158
    v_add_u32 v156, s53, v155
    v_add_u32 v156, 64, v156
    v_mul_u32_u24 v158, 43691, v156
    v_lshrrev_b32 v158, 19, v158
    v_mul_u32_u24 v159, 12, v158
    v_sub_u32 v159, v156, v159
    v_lshrrev_b32 v160, 3, v158
    v_and_b32 v160, 1, v160
    v_lshlrev_b32 v160, 1, v160
    v_xor_b32 v159, v159, v160
    v_mul_u32_u24 v158, 3456, v158
    v_lshl_add_u32 v158, v159, 4, v158
    v_add_u32 v103, s54, v158
    v_add_u32 v156, s53, v155
    v_add_u32 v156, 128, v156
    v_mul_u32_u24 v158, 43691, v156
    v_lshrrev_b32 v158, 19, v158
    v_mul_u32_u24 v159, 12, v158
    v_sub_u32 v159, v156, v159
    v_lshrrev_b32 v160, 3, v158
    v_and_b32 v160, 1, v160
    v_lshlrev_b32 v160, 1, v160
    v_xor_b32 v159, v159, v160
    v_mul_u32_u24 v158, 3456, v158
    v_lshl_add_u32 v158, v159, 4, v158
    v_add_u32 v104, s54, v158
    s_mov_b32 s39, 0
    s_mov_b32 s56, 0
    s_add_u32 s46, s40, s56
    s_add_u32 m0, s46, 0
    s_nop 0
    buffer_load_dwordx4 v102, s[8:11], s39 offen lds
    s_add_u32 m0, s46, 1024
    s_nop 0
    buffer_load_dwordx4 v103, s[8:11], s39 offen lds
    s_add_u32 m0, s46, 2048
    s_nop 0
    buffer_load_dwordx4 v104, s[8:11], s39 offen lds
    s_add_u32 s39, s39, s49
    s_add_u32 s56, s56, 12288
    s_cmp_eq_u32 s56, 61440
    s_cselect_b32 s56, 0, s56
    s_add_u32 s46, s40, s56
    s_add_u32 m0, s46, 0
    s_nop 0
    buffer_load_dwordx4 v102, s[8:11], s39 offen lds
    s_add_u32 m0, s46, 1024
    s_nop 0
    buffer_load_dwordx4 v103, s[8:11], s39 offen lds
    s_add_u32 m0, s46, 2048
    s_nop 0
    buffer_load_dwordx4 v104, s[8:11], s39 offen lds
    s_add_u32 s39, s39, s49
    s_add_u32 s56, s56, 12288
    s_cmp_eq_u32 s56, 61440
    s_cselect_b32 s56, 0, s56
    s_add_u32 s46, s44, s41
    s_add_u32 s47, s42, s43
    s_add_u32 m0, s46, 0
    s_add_u32 s52, s47, 0
    buffer_load_dwordx4 v100, s[4:7], s52 offen lds
    s_add_u32 m0, s46, 1024
    s_add_u32 s52, s47, 10240
    buffer_load_dwordx4 v101, s[4:7], s52 offen lds
    s_add_u32 m0, s46, 2048
    s_add_u32 s52, s47, 20480
    buffer_load_dwordx4 v100, s[4:7], s52 offen lds
    s_add_u32 m0, s46, 3072
    s_add_u32 s52, s47, 30720
    buffer_load_dwordx4 v101, s[4:7], s52 offen lds
    s_add_u32 s46, s44, s41
    s_add_u32 s47, s42, s43
    s_add_u32 m0, s46, 16384
    s_add_u32 s52, s47, 163840
    buffer_load_dwordx4 v100, s[4:7], s52 offen lds
    s_add_u32 m0, s46, 17408
    s_add_u32 s52, s47, 174080
    buffer_load_dwordx4 v101, s[4:7], s52 offen lds
    s_add_u32 m0, s46, 18432
    s_add_u32 s52, s47, 184320
    buffer_load_dwordx4 v100, s[4:7], s52 offen lds
    s_add_u32 m0, s46, 19456
    s_add_u32 s52, s47, 194560
    buffer_load_dwordx4 v101, s[4:7], s52 offen lds
    s_add_u32 s43, s43, 128
    s_cmp_ge_u32 s43, 1280
    s_cselect_b32 s43, 0x40000000, s43
    s_add_u32 s41, s41, 32768
    s_cmp_eq_u32 s41, 98304
    s_cselect_b32 s41, 0, s41
    s_add_u32 s46, s40, s56
    s_add_u32 m0, s46, 0
    s_nop 0
    buffer_load_dwordx4 v102, s[8:11], s39 offen lds
    s_add_u32 m0, s46, 1024
    s_nop 0
    buffer_load_dwordx4 v103, s[8:11], s39 offen lds
    s_add_u32 m0, s46, 2048
    s_nop 0
    buffer_load_dwordx4 v104, s[8:11], s39 offen lds
    s_add_u32 s39, s39, s49
    s_add_u32 s56, s56, 12288
    s_cmp_eq_u32 s56, 61440
    s_cselect_b32 s56, 0, s56
    s_add_u32 s46, s40, s56
    s_add_u32 m0, s46, 0
    s_nop 0
    buffer_load_dwordx4 v102, s[8:11], s39 offen lds
    s_add_u32 m0, s46, 1024
    s_nop 0
    buffer_load_dwordx4 v103, s[8:11], s39 offen lds
    s_add_u32 m0, s46, 2048
    s_nop 0
    buffer_load_dwordx4 v104, s[8:11], s39 offen lds
    s_add_u32 s39, s39, s49
    s_add_u32 s56, s56, 12288
    s_cmp_eq_u32 s56, 61440
    s_cselect_b32 s56, 0, s56
    s_add_u32 s46, s44, s41
    s_add_u32 s47, s42, s43
    s_add_u32 m0, s46, 0
    s_add_u32 s52, s47, 0
    buffer_load_dwordx4 v100, s[4:7], s52 offen lds
    s_add_u32 m0, s46, 1024
    s_add_u32 s52, s47, 10240
    buffer_load_dwordx4 v101, s[4:7], s52 offen lds
    s_add_u32 m0, s46, 2048
    s_add_u32 s52, s47, 20480
    buffer_load_dwordx4 v100, s[4:7], s52 offen lds
    s_add_u32 m0, s46, 3072
    s_add_u32 s52, s47, 30720
    buffer_load_dwordx4 v101, s[4:7], s52 offen lds
    s_waitcnt vmcnt(21)
    s_barrier
    s_add_u32 s46, s44, s41
    s_add_u32 s47, s42, s43
    s_add_u32 m0, s46, 16384
    s_add_u32 s52, s47, 163840
    buffer_load_dwordx4 v100, s[4:7], s52 offen lds
    s_add_u32 m0, s46, 17408
    s_add_u32 s52, s47, 174080
    buffer_load_dwordx4 v101, s[4:7], s52 offen lds
    s_add_u32 m0, s46, 18432
    s_add_u32 s52, s47, 184320
    buffer_load_dwordx4 v100, s[4:7], s52 offen lds
    s_add_u32 m0, s46, 19456
    s_add_u32 s52, s47, 194560
    buffer_load_dwordx4 v101, s[4:7], s52 offen lds
    s_add_u32 s43, s43, 128
    s_cmp_ge_u32 s43, 1280
    s_cselect_b32 s43, 0x40000000, s43
    s_add_u32 s41, s41, 32768
    s_cmp_eq_u32 s41, 98304
    s_cselect_b32 s41, 0, s41
    s_add_u32 s46, s40, s56
    s_add_u32 m0, s46, 0
    s_nop 0
    buffer_load_dwordx4 v102, s[8:11], s39 offen lds
    s_add_u32 m0, s46, 1024
    s_nop 0
    buffer_load_dwordx4 v103, s[8:11], s39 offen lds
    s_add_u32 m0, s46, 2048
    s_nop 0
    buffer_load_dwordx4 v104, s[8:11], s39 offen lds
    s_add_u32 s39, s39, s49
    s_add_u32 s56, s56, 12288
    s_cmp_eq_u32 s56, 61440
    s_cselect_b32 s56, 0, s56
    s_mov_b32 s37, 0
    s_mov_b32 s57, 0
    v_and_b32 v156, 15, v155
    v_lshrrev_b32 v157, 4, v155
    v_lshrrev_b32 v158, 2, v156
    v_lshl_add_u32 v158, v157, 3, v158
    v_mul_u32_u24 v158, 192, v158
    v_and_b32 v159, 3, v155
    v_lshl_add_u32 v158, v159, 3, v158
    v_and_b32 v159, 1, v157
    s_lshr_b32 s53, s33, 1
    s_mul_i32 s53, s53, 6144
    s_and_b32 s54, s33, 1
    s_mul_i32 s54, s54, 3
    s_add_u32 s53, s53, 98304
    s_add_u32 s46, s54, 0
    v_xor_b32 v160, s46, v159
    v_lshl_add_u32 v160, v160, 5, v158
    v_add_u32 v28, s53, v160
    s_add_u32 s46, s54, 1
    v_xor_b32 v160, s46, v159
    v_lshl_add_u32 v160, v160, 5, v158
    v_add_u32 v29, s53, v160
    s_add_u32 s46, s54, 2
    v_xor_b32 v160, s46, v159
    v_lshl_add_u32 v160, v160, 5, v158
    v_add_u32 v30, s53, v160
    v_mov_b32 v4, 0
    v_mov_b32 v5, 0
    v_mov_b32 v6, 0
    v_mov_b32 v7, 0
    v_mov_b32 v8, 0
    v_mov_b32 v9, 0
    v_mov_b32 v10, 0
    v_mov_b32 v11, 0
    v_mov_b32 v12, 0
    v_mov_b32 v13, 0
    v_mov_b32 v14, 0
    v_mov_b32 v15, 0
    v_mov_b32 v36, 0x3f803f80
    v_mov_b32 v37, 0x3f803f80
    v_mov_b32 v38, 0x3f803f80
    v_mov_b32 v39, 0x3f803f80
    s_mov_b32 s38, 0
    v_add_u32 v32, s38, v28
    v_add_u32 v33, s38, v29
    v_add_u32 v34, s38, v30
    ds_read_b64_tr_b16 v[16:17], v32
    ds_read_b64_tr_b16 v[18:19], v32 offset:768
    ds_read_b64_tr_b16 v[20:21], v33
    ds_read_b64_tr_b16 v[22:23], v33 offset:768
    ds_read_b64_tr_b16 v[24:25], v34
    ds_read_b64_tr_b16 v[26:27], v34 offset:768
    s_add_u32 s38, s38, 12288
    s_cmp_eq_u32 s38, 61440
    s_cselect_b32 s38, 0, s38
    s_waitcnt lgkmcnt(0)
    v_mfma_f32_16x16x32_bf16 v[4:7], v[16:19], v[36:39], v[4:7]
    v_mfma_f32_16x16x32_bf16 v[8:11], v[20:23], v[36:39], v[8:11]
    v_mfma_f32_16x16x32_bf16 v[12:15], v[24:27], v[36:39], v[12:15]
L_k1g_ld:
    s_waitcnt vmcnt(17)
    s_barrier
    v_add_u32 v32, s38, v28
    v_add_u32 v33, s38, v29
    v_add_u32 v34, s38, v30
    ds_read_b64_tr_b16 v[16:17], v32
    ds_read_b64_tr_b16 v[18:19], v32 offset:768
    ds_read_b64_tr_b16 v[20:21], v33
    ds_read_b64_tr_b16 v[22:23], v33 offset:768
    ds_read_b64_tr_b16 v[24:25], v34
    ds_read_b64_tr_b16 v[26:27], v34 offset:768
    s_add_u32 s38, s38, 12288
    s_cmp_eq_u32 s38, 61440
    s_cselect_b32 s38, 0, s38
    s_add_u32 s46, s44, s41
    s_add_u32 s47, s42, s43
    s_add_u32 m0, s46, 0
    s_add_u32 s52, s47, 0
    buffer_load_dwordx4 v100, s[4:7], s52 offen lds
    s_add_u32 m0, s46, 1024
    s_add_u32 s52, s47, 10240
    buffer_load_dwordx4 v101, s[4:7], s52 offen lds
    s_add_u32 m0, s46, 2048
    s_add_u32 s52, s47, 20480
    buffer_load_dwordx4 v100, s[4:7], s52 offen lds
    s_add_u32 m0, s46, 3072
    s_add_u32 s52, s47, 30720
    buffer_load_dwordx4 v101, s[4:7], s52 offen lds
    s_add_u32 s46, s40, s56
    s_add_u32 m0, s46, 0
    s_nop 0
    buffer_load_dwordx4 v102, s[8:11], s39 offen lds
    s_add_u32 m0, s46, 1024
    s_nop 0
    buffer_load_dwordx4 v103, s[8:11], s39 offen lds
    s_add_u32 m0, s46, 2048
    s_nop 0
    buffer_load_dwordx4 v104, s[8:11], s39 offen lds
    s_add_u32 s39, s39, s49
    s_add_u32 s56, s56, 12288
    s_cmp_eq_u32 s56, 61440
    s_cselect_b32 s56, 0, s56
    s_waitcnt lgkmcnt(0)
    v_mfma_f32_16x16x32_bf16 v[4:7], v[16:19], v[36:39], v[4:7]
    v_mfma_f32_16x16x32_bf16 v[8:11], v[20:23], v[36:39], v[8:11]
    v_mfma_f32_16x16x32_bf16 v[12:15], v[24:27], v[36:39], v[12:15]
    s_cmp_lg_u32 s37, 3
    s_cbranch_scc1 L_wh_21
    s_cmp_lg_u32 s33, 0
    s_cbranch_scc1 L_wh_21
    buffer_load_dword v120, off, s[60:63], 0 sc1
L_wh_21:
    s_waitcnt vmcnt(21)
    s_barrier
    v_add_u32 v32, s38, v28
    v_add_u32 v33, s38, v29
    v_add_u32 v34, s38, v30
    ds_read_b64_tr_b16 v[16:17], v32
    ds_read_b64_tr_b16 v[18:19], v32 offset:768
    ds_read_b64_tr_b16 v[20:21], v33
    ds_read_b64_tr_b16 v[22:23], v33 offset:768
    ds_read_b64_tr_b16 v[24:25], v34
    ds_read_b64_tr_b16 v[26:27], v34 offset:768
    s_add_u32 s38, s38, 12288
    s_cmp_eq_u32 s38, 61440
    s_cselect_b32 s38, 0, s38
    s_add_u32 s46, s44, s41
    s_add_u32 s47, s42, s43
    s_add_u32 m0, s46, 16384
    s_add_u32 s52, s47, 163840
    buffer_load_dwordx4 v100, s[4:7], s52 offen lds
    s_add_u32 m0, s46, 17408
    s_add_u32 s52, s47, 174080
    buffer_load_dwordx4 v101, s[4:7], s52 offen lds
    s_add_u32 m0, s46, 18432
    s_add_u32 s52, s47, 184320
    buffer_load_dwordx4 v100, s[4:7], s52 offen lds
    s_add_u32 m0, s46, 19456
    s_add_u32 s52, s47, 194560
    buffer_load_dwordx4 v101, s[4:7], s52 offen lds
    s_add_u32 s43, s43, 128
    s_cmp_ge_u32 s43, 1280
    s_cselect_b32 s43, 0x40000000, s43
    s_add_u32 s41, s41, 32768
    s_cmp_eq_u32 s41, 98304
    s_cselect_b32 s41, 0, s41
    s_add_u32 s46, s40, s56
    s_add_u32 m0, s46, 0
    s_nop 0
    buffer_load_dwordx4 v102, s[8:11], s39 offen lds
    s_add_u32 m0, s46, 1024
    s_nop 0
    buffer_load_dwordx4 v103, s[8:11], s39 offen lds
    s_add_u32 m0, s46, 2048
    s_nop 0
    buffer_load_dwordx4 v104, s[8:11], s39 offen lds
    s_add_u32 s39, s39, s49
    s_add_u32 s56, s56, 12288
    s_cmp_eq_u32 s56, 61440
    s_cselect_b32 s56, 0, s56
    s_waitcnt lgkmcnt(0)
    v_mfma_f32_16x16x32_bf16 v[4:7], v[16:19], v[36:39], v[4:7]
    v_mfma_f32_16x16x32_bf16 v[8:11], v[20:23], v[36:39], v[8:11]
    v_mfma_f32_16x16x32_bf16 v[12:15], v[24:27], v[36:39], v[12:15]
    s_waitcnt vmcnt(17)
    s_barrier
    v_add_u32 v32, s38, v28
    v_add_u32 v33, s38, v29
    v_add_u32 v34, s38, v30
    ds_read_b64_tr_b16 v[16:17], v32
    ds_read_b64_tr_b16 v[18:19], v32 offset:768
    ds_read_b64_tr_b16 v[20:21], v33
    ds_read_b64_tr_b16 v[22:23], v33 offset:768
    ds_read_b64_tr_b16 v[24:25], v34
    ds_read_b64_tr_b16 v[26:27], v34 offset:768
    s_add_u32 s38, s38, 12288
    s_cmp_eq_u32 s38, 61440
    s_cselect_b32 s38, 0, s38
    s_add_u32 s46, s44, s41
    s_add_u32 s47, s42, s43
    s_add_u32 m0, s46, 0
    s_add_u32 s52, s47, 0
    buffer_load_dwordx4 v100, s[4:7], s52 offen lds
    s_add_u32 m0, s46, 1024
    s_add_u32 s52, s47, 10240
    buffer_load_dwordx4 v101, s[4:7], s52 offen lds
    s_add_u32 m0, s46, 2048
    s_add_u32 s52, s47, 20480
    buffer_load_dwordx4 v100, s[4:7], s52 offen lds
    s_add_u32 m0, s46, 3072
    s_add_u32 s52, s47, 30720
    buffer_load_dwordx4 v101, s[4:7], s52 offen lds
    s_add_u32 s46, s40, s56
    s_add_u32 m0, s46, 0
    s_nop 0
    buffer_load_dwordx4 v102, s[8:11], s39 offen lds
    s_add_u32 m0, s46, 1024
    s_nop 0
    buffer_load_dwordx4 v103, s[8:11], s39 offen lds
    s_add_u32 m0, s46, 2048
    s_nop 0
    buffer_load_dwordx4 v104, s[8:11], s39 offen lds
    s_add_u32 s39, s39, s49
    s_add_u32 s56, s56, 12288
    s_cmp_eq_u32 s56, 61440
    s_cselect_b32 s56, 0, s56
    s_waitcnt lgkmcnt(0)
    v_mfma_f32_16x16x32_bf16 v[4:7], v[16:19], v[36:39], v[4:7]
    v_mfma_f32_16x16x32_bf16 v[8:11], v[20:23], v[36:39], v[8:11]
    v_mfma_f32_16x16x32_bf16 v[12:15], v[24:27], v[36:39], v[12:15]
    s_waitcnt vmcnt(21)
    s_barrier
    v_add_u32 v32, s38, v28
    v_add_u32 v33, s38, v29
    v_add_u32 v34, s38, v30
    ds_read_b64_tr_b16 v[16:17], v32
    ds_read_b64_tr_b16 v[18:19], v32 offset:768
    ds_read_b64_tr_b16 v[20:21], v33
    ds_read_b64_tr_b16 v[22:23], v33 offset:768
    ds_read_b64_tr_b16 v[24:25], v34
    ds_read_b64_tr_b16 v[26:27], v34 offset:768
    s_add_u32 s38, s38, 12288
    s_cmp_eq_u32 s38, 61440
    s_cselect_b32 s38, 0, s38
    s_add_u32 s46, s44, s41
    s_add_u32 s47, s42, s43
    s_add_u32 m0, s46, 16384
    s_add_u32 s52, s47, 163840
    buffer_load_dwordx4 v100, s[4:7], s52 offen lds
    s_add_u32 m0, s46, 17408
    s_add_u32 s52, s47, 174080
    buffer_load_dwordx4 v101, s[4:7], s52 offen lds
    s_add_u32 m0, s46, 18432
    s_add_u32 s52, s47, 184320
    buffer_load_dwordx4 v100, s[4:7], s52 offen lds
    s_add_u32 m0, s46, 19456
    s_add_u32 s52, s47, 194560
    buffer_load_dwordx4 v101, s[4:7], s52 offen lds
    s_add_u32 s43, s43, 128
    s_cmp_ge_u32 s43, 1280
    s_cselect_b32 s43, 0x40000000, s43
    s_add_u32 s41, s41, 32768
    s_cmp_eq_u32 s41, 98304
    s_cselect_b32 s41, 0, s41
    s_add_u32 s46, s40, s56
    s_add_u32 m0, s46, 0
    s_nop 0
    buffer_load_dwordx4 v102, s[8:11], s39 offen lds
    s_add_u32 m0, s46, 1024
    s_nop 0
    buffer_load_dwordx4 v103, s[8:11], s39 offen lds
    s_add_u32 m0, s46, 2048
    s_nop 0
    buffer_load_dwordx4 v104, s[8:11], s39 offen lds
    s_add_u32 s39, s39, s49
    s_add_u32 s56, s56, 12288
    s_cmp_eq_u32 s56, 61440
    s_cselect_b32 s56, 0, s56
    s_waitcnt lgkmcnt(0)
    v_mfma_f32_16x16x32_bf16 v[4:7], v[16:19], v[36:39], v[4:7]
    v_mfma_f32_16x16x32_bf16 v[8:11], v[20:23], v[36:39], v[8:11]
    v_mfma_f32_16x16x32_bf16 v[12:15], v[24:27], v[36:39], v[12:15]
    s_add_u32 s37, s37, 1
    s_cmp_lt_u32 s37, 4
    s_cbranch_scc1 L_k1g_ld
    s_cmp_lg_u32 s37, 4
    s_cbranch_scc1 L_wh_22
    s_cmp_lg_u32 s33, 0
    s_cbranch_scc1 L_wh_22
    s_waitcnt vmcnt(21)
    v_readfirstlane_b32 s46, v120
    s_nop 0
    s_cmp_lt_u32 s46, 16
    s_cbranch_scc1 L_wh_22
    s_mov_b32 s57, 1
    v_lshlrev_b32 v156, 4, v155
    s_lshl_b32 s46, s35, 11
    s_add_u32 s46, s46, 26214400
    buffer_load_dwordx4 v[108:111], v156, s[12:15], s46 offen sc1
    buffer_load_dwordx4 v[112:115], v156, s[12:15], s46 offen offset:1024 sc1
L_wh_22:
    s_waitcnt vmcnt(17)
    s_barrier
    v_add_u32 v32, s38, v28
    v_add_u32 v33, s38, v29
    v_add_u32 v34, s38, v30
    ds_read_b64_tr_b16 v[16:17], v32
    ds_read_b64_tr_b16 v[18:19], v32 offset:768
    ds_read_b64_tr_b16 v[20:21], v33
    ds_read_b64_tr_b16 v[22:23], v33 offset:768
    ds_read_b64_tr_b16 v[24:25], v34
    ds_read_b64_tr_b16 v[26:27], v34 offset:768
    s_add_u32 s38, s38, 12288
    s_cmp_eq_u32 s38, 61440
    s_cselect_b32 s38, 0, s38
    s_waitcnt lgkmcnt(0)
    v_mfma_f32_16x16x32_bf16 v[4:7], v[16:19], v[36:39], v[4:7]
    v_mfma_f32_16x16x32_bf16 v[8:11], v[20:23], v[36:39], v[8:11]
    v_mfma_f32_16x16x32_bf16 v[12:15], v[24:27], v[36:39], v[12:15]
    s_waitcnt vmcnt(14)
    s_barrier
    v_add_u32 v32, s38, v28
    v_add_u32 v33, s38, v29
    v_add_u32 v34, s38, v30
    ds_read_b64_tr_b16 v[16:17], v32
    ds_read_b64_tr_b16 v[18:19], v32 offset:768
    ds_read_b64_tr_b16 v[20:21], v33
    ds_read_b64_tr_b16 v[22:23], v33 offset:768
    ds_read_b64_tr_b16 v[24:25], v34
    ds_read_b64_tr_b16 v[26:27], v34 offset:768
    s_add_u32 s38, s38, 12288
    s_cmp_eq_u32 s38, 61440
    s_cselect_b32 s38, 0, s38
    s_waitcnt lgkmcnt(0)
    v_mfma_f32_16x16x32_bf16 v[4:7], v[16:19], v[36:39], v[4:7]
    v_mfma_f32_16x16x32_bf16 v[8:11], v[20:23], v[36:39], v[8:11]
    v_mfma_f32_16x16x32_bf16 v[12:15], v[24:27], v[36:39], v[12:15]
    s_waitcnt vmcnt(7)
    s_barrier
    v_add_u32 v32, s38, v28
    v_add_u32 v33, s38, v29
    v_add_u32 v34, s38, v30
    ds_read_b64_tr_b16 v[16:17], v32
    ds_read_b64_tr_b16 v[18:19], v32 offset:768
    ds_read_b64_tr_b16 v[20:21], v33
    ds_read_b64_tr_b16 v[22:23], v33 offset:768
    ds_read_b64_tr_b16 v[24:25], v34
    ds_read_b64_tr_b16 v[26:27], v34 offset:768
    s_add_u32 s38, s38, 12288
    s_cmp_eq_u32 s38, 61440
    s_cselect_b32 s38, 0, s38
    s_waitcnt lgkmcnt(0)
    v_mfma_f32_16x16x32_bf16 v[4:7], v[16:19], v[36:39], v[4:7]
    v_mfma_f32_16x16x32_bf16 v[8:11], v[20:23], v[36:39], v[8:11]
    v_mfma_f32_16x16x32_bf16 v[12:15], v[24:27], v[36:39], v[12:15]
    s_cmp_lg_u32 s37, 4
    s_cbranch_scc1 L_wh_23
    s_cmp_lg_u32 s33, 0
    s_cbranch_scc1 L_wh_23
    s_cmp_eq_u32 s57, 0
    s_cbranch_scc1 L_wh_23
    s_waitcnt vmcnt(0)
    v_lshlrev_b32 v156, 4, v155
    v_add_u32 v156, 159744, v156
    ds_write_b128 v156, v[108:111]
    ds_write_b128 v156, v[112:115] offset:1024
    s_mov_b32 s57, 2
L_wh_23:
    s_waitcnt vmcnt(7)
    s_barrier
    s_waitcnt lgkmcnt(0)
    v_lshrrev_b32 v156, 4, v155
    v_lshlrev_b32 v156, 4, v156
    s_mul_i32 s46, s33, 192
    s_add_u32 s46, s46, 161792
    v_add_u32 v156, s46, v156
    s_nop 3
    s_mov_b32 exec_lo, 0x00010001
    s_mov_b32 exec_hi, 0x00010001
    ds_write_b128 v156, v[4:7] offset:0
    ds_write_b128 v156, v[8:11] offset:64
    ds_write_b128 v156, v[12:15] offset:128
    s_mov_b64 exec, -1
    s_cmp_lg_u32 s33, 0
    s_cbranch_scc1 L_lddone_24
    s_cmp_eq_u32 s57, 2
    s_cbranch_scc1 L_lddone_24
    s_mov_b32 s47, 0
L_poll_25:
    buffer_load_dword v120, off, s[60:63], 0 sc1
    s_waitcnt vmcnt(0)
    v_readfirstlane_b32 s46, v120
    s_add_u32 s47, s47, 1
    s_cmp_ge_u32 s46, 16
    s_cbranch_scc1 L_ok_27
    s_cmp_ge_u32 s47, 40000
    s_cbranch_scc1 L_ok_27
    s_sleep 2
    s_branch L_poll_25
L_ok_27:
    v_lshlrev_b32 v156, 4, v155
    s_lshl_b32 s46, s35, 11
    s_add_u32 s46, s46, 26214400
    buffer_load_dwordx4 v[108:111], v156, s[12:15], s46 offen sc1
    buffer_load_dwordx4 v[112:115], v156, s[12:15], s46 offen offset:1024 sc1
L_have_26:
    s_waitcnt vmcnt(0)
    v_lshlrev_b32 v156, 4, v155
    v_add_u32 v156, 159744, v156
    ds_write_b128 v156, v[108:111]
    ds_write_b128 v156, v[112:115] offset:1024
L_lddone_24:
    s_waitcnt vmcnt(0) lgkmcnt(0)
    s_setprio 0
    s_barrier
    s_add_u32 s58, s35, 4
    s_mov_b32 s59, s36
    s_mul_i32 s54, s35, 864
    s_mul_i32 s46, s36, 6
    s_add_u32 s54, s54, s46
    s_lshl_b32 s54, s54, 10
    s_add_u32 s54, s54, 8388608
    s_branch L_k12_ph2
L_k1_T:
    s_sub_u32 s53, s53, 2
    s_lshl_b32 s53, s53, 3
    s_add_u32 s36, s53, s35
    s_cmp_ge_u32 s32, 8
    s_cbranch_scc1 L_pidle_28
    v_lshrrev_b32 v156, 4, v155
    v_mul_u32_u24 v156, 1280, v156
    v_and_b32 v157, 15, v155
    v_lshl_add_u32 v156, v157, 4, v156
    s_lshl_b32 s46, s36, 7
    s_lshl_b32 s47, s32, 4
    s_add_u32 s53, s46, s47
    s_mul_i32 s46, s53, 1280
    s_add_u32 s47, s46, 0
    buffer_load_dwordx4 v[4:7], v156, s[4:7], s47 offen offset:0
    buffer_load_dwordx4 v[8:11], v156, s[4:7], s47 offen offset:256
    buffer_load_dwordx4 v[12:15], v156, s[4:7], s47 offen offset:512
    buffer_load_dwordx4 v[16:19], v156, s[4:7], s47 offen offset:768
    buffer_load_dwordx4 v[20:23], v156, s[4:7], s47 offen offset:1024
    s_add_u32 s47, s46, 5120
    buffer_load_dwordx4 v[24:27], v156, s[4:7], s47 offen offset:0
    buffer_load_dwordx4 v[28:31], v156, s[4:7], s47 offen offset:256
    buffer_load_dwordx4 v[32:35], v156, s[4:7], s47 offen offset:512
    buffer_load_dwordx4 v[36:39], v156, s[4:7], s47 offen offset:768
    buffer_load_dwordx4 v[40:43], v156, s[4:7], s47 offen offset:1024
    s_add_u32 s47, s46, 10240
    buffer_load_dwordx4 v[44:47], v156, s[4:7], s47 offen offset:0
    buffer_load_dwordx4 v[48:51], v156, s[4:7], s47 offen offset:256
    buffer_load_dwordx4 v[52:55], v156, s[4:7], s47 offen offset:512
    buffer_load_dwordx4 v[56:59], v156, s[4:7], s47 offen offset:768
    buffer_load_dwordx4 v[60:63], v156, s[4:7], s47 offen offset:1024
    s_add_u32 s47, s46, 15360
    buffer_load_dwordx4 v[64:67], v156, s[4:7], s47 offen offset:0
    buffer_load_dwordx4 v[68:71], v156, s[4:7], s47 offen offset:256
    buffer_load_dwordx4 v[72:75], v156, s[4:7], s47 offen offset:512
    buffer_load_dwordx4 v[76:79], v156, s[4:7], s47 offen offset:768
    buffer_load_dwordx4 v[80:83], v156, s[4:7], s47 offen offset:1024
    s_mov_b32 s45, 0x3f803f80
    s_waitcnt vmcnt(15)
    v_mov_b32 v158, 0
    v_mov_b32 v159, 0
    v_mov_b32 v160, 0
    v_mov_b32 v161, 0
    v_dot2c_f32_bf16 v158, s45, v4
    v_dot2c_f32_bf16 v159, v4, v4
    v_dot2c_f32_bf16 v160, s45, v5
    v_dot2c_f32_bf16 v161, v5, v5
    v_dot2c_f32_bf16 v158, s45, v6
    v_dot2c_f32_bf16 v159, v6, v6
    v_dot2c_f32_bf16 v160, s45, v7
    v_dot2c_f32_bf16 v161, v7, v7
    v_dot2c_f32_bf16 v158, s45, v8
    v_dot2c_f32_bf16 v159, v8, v8
    v_dot2c_f32_bf16 v160, s45, v9
    v_dot2c_f32_bf16 v161, v9, v9
    v_dot2c_f32_bf16 v158, s45, v10
    v_dot2c_f32_bf16 v159, v10, v10
    v_dot2c_f32_bf16 v160, s45, v11
    v_dot2c_f32_bf16 v161, v11, v11
    v_dot2c_f32_bf16 v158, s45, v12
    v_dot2c_f32_bf16 v159, v12, v12
    v_dot2c_f32_bf16 v160, s45, v13
    v_dot2c_f32_bf16 v161, v13, v13
    v_dot2c_f32_bf16 v158, s45, v14
    v_dot2c_f32_bf16 v159, v14, v14
    v_dot2c_f32_bf16 v160, s45, v15
    v_dot2c_f32_bf16 v161, v15, v15
    v_dot2c_f32_bf16 v158, s45, v16
    v_dot2c_f32_bf16 v159, v16, v16
    v_dot2c_f32_bf16 v160, s45, v17
    v_dot2c_f32_bf16 v161, v17, v17
    v_dot2c_f32_bf16 v158, s45, v18
    v_dot2c_f32_bf16 v159, v18, v18
    v_dot2c_f32_bf16 v160, s45, v19
    v_dot2c_f32_bf16 v161, v19, v19
    v_dot2c_f32_bf16 v158, s45, v20
    v_dot2c_f32_bf16 v159, v20, v20
    v_dot2c_f32_bf16 v160, s45, v21
    v_dot2c_f32_bf16 v161, v21, v21
    v_dot2c_f32_bf16 v158, s45, v22
    v_dot2c_f32_bf16 v159, v22, v22
    v_dot2c_f32_bf16 v160, s45, v23
    v_dot2c_f32_bf16 v161, v23, v23
    s_nop 2
    v_add_f32 v158, v158, v160
    v_add_f32 v159, v159, v161
    s_nop 1
    v_add_f32_dpp v158, v158, v158 row_ror:8 row_mask:0xf bank_mask:0xf
    v_add_f32_dpp v159, v159, v159 row_ror:8 row_mask:0xf bank_mask:0xf
    s_nop 1
    v_add_f32_dpp v158, v158, v158 row_ror:4 row_mask:0xf bank_mask:0xf
    v_add_f32_dpp v159, v159, v159 row_ror:4 row_mask:0xf bank_mask:0xf
    s_nop 1
    v_add_f32_dpp v158, v158, v158 row_ror:2 row_mask:0xf bank_mask:0xf
    v_add_f32_dpp v159, v159, v159 row_ror:2 row_mask:0xf bank_mask:0xf
    s_nop 1
    v_add_f32_dpp v158, v158, v158 row_ror:1 row_mask:0xf bank_mask:0xf
    v_add_f32_dpp v159, v159, v159 row_ror:1 row_mask:0xf bank_mask:0xf
    v_mul_f32 v158, 0x3acccccd, v158
    v_mul_f32 v159, 0x3acccccd, v159
    v_fma_f32 v159, -v158, v158, v159
    v_max_f32 v159, 0, v159
    v_add_f32 v159, 0x3727c5ac, v159
    v_rsq_f32 v101, v159
    v_sub_f32 v100, 0, v158
    s_waitcnt vmcnt(10)
    v_mov_b32 v158, 0
    v_mov_b32 v159, 0
    v_mov_b32 v160, 0
    v_mov_b32 v161, 0
    v_dot2c_f32_bf16 v158, s45, v24
    v_dot2c_f32_bf16 v159, v24, v24
    v_dot2c_f32_bf16 v160, s45, v25
    v_dot2c_f32_bf16 v161, v25, v25
    v_dot2c_f32_bf16 v158, s45, v26
    v_dot2c_f32_bf16 v159, v26, v26
    v_dot2c_f32_bf16 v160, s45, v27
    v_dot2c_f32_bf16 v161, v27, v27
    v_dot2c_f32_bf16 v158, s45, v28
    v_dot2c_f32_bf16 v159, v28, v28
    v_dot2c_f32_bf16 v160, s45, v29
    v_dot2c_f32_bf16 v161, v29, v29
    v_dot2c_f32_bf16 v158, s45, v30
    v_dot2c_f32_bf16 v159, v30, v30
    v_dot2c_f32_bf16 v160, s45, v31
    v_dot2c_f32_bf16 v161, v31, v31
    v_dot2c_f32_bf16 v158, s45, v32
    v_dot2c_f32_bf16 v159, v32, v32
    v_dot2c_f32_bf16 v160, s45, v33
    v_dot2c_f32_bf16 v161, v33, v33
    v_dot2c_f32_bf16 v158, s45, v34
    v_dot2c_f32_bf16 v159, v34, v34
    v_dot2c_f32_bf16 v160, s45, v35
    v_dot2c_f32_bf16 v161, v35, v35
    v_dot2c_f32_bf16 v158, s45, v36
    v_dot2c_f32_bf16 v159, v36, v36
    v_dot2c_f32_bf16 v160, s45, v37
    v_dot2c_f32_bf16 v161, v37, v37
    v_dot2c_f32_bf16 v158, s45, v38
    v_dot2c_f32_bf16 v159, v38, v38
    v_dot2c_f32_bf16 v160, s45, v39
    v_dot2c_f32_bf16 v161, v39, v39
    v_dot2c_f32_bf16 v158, s45, v40
    v_dot2c_f32_bf16 v159, v40, v40
    v_dot2c_f32_bf16 v160, s45, v41
    v_dot2c_f32_bf16 v161, v41, v41
    v_dot2c_f32_bf16 v158, s45, v42
    v_dot2c_f32_bf16 v159, v42, v42
    v_dot2c_f32_bf16 v160, s45, v43
    v_dot2c_f32_bf16 v161, v43, v43
    s_nop 2
    v_add_f32 v158, v158, v160
    v_add_f32 v159, v159, v161
    s_nop 1
    v_add_f32_dpp v158, v158, v158 row_ror:8 row_mask:0xf bank_mask:0xf
    v_add_f32_dpp v159, v159, v159 row_ror:8 row_mask:0xf bank_mask:0xf
    s_nop 1
    v_add_f32_dpp v158, v158, v158 row_ror:4 row_mask:0xf bank_mask:0xf
    v_add_f32_dpp v159, v159, v159 row_ror:4 row_mask:0xf bank_mask:0xf
    s_nop 1
    v_add_f32_dpp v158, v158, v158 row_ror:2 row_mask:0xf bank_mask:0xf
    v_add_f32_dpp v159, v159, v159 row_ror:2 row_mask:0xf bank_mask:0xf
    s_nop 1
    v_add_f32_dpp v158, v158, v158 row_ror:1 row_mask:0xf bank_mask:0xf
    v_add_f32_dpp v159, v159, v159 row_ror:1 row_mask:0xf bank_mask:0xf
    v_mul_f32 v158, 0x3acccccd, v158
    v_mul_f32 v159, 0x3acccccd, v159
    v_fma_f32 v159, -v158, v158, v159
    v_max_f32 v159, 0, v159
    v_add_f32 v159, 0x3727c5ac, v159
    v_rsq_f32 v103, v159
    v_sub_f32 v102, 0, v158
    s_waitcnt vmcnt(5)
    v_mov_b32 v158, 0
    v_mov_b32 v159, 0
    v_mov_b32 v160, 0
    v_mov_b32 v161, 0
    v_dot2c_f32_bf16 v158, s45, v44
    v_dot2c_f32_bf16 v159, v44, v44
    v_dot2c_f32_bf16 v160, s45, v45
    v_dot2c_f32_bf16 v161, v45, v45
    v_dot2c_f32_bf16 v158, s45, v46
    v_dot2c_f32_bf16 v159, v46, v46
    v_dot2c_f32_bf16 v160, s45, v47
    v_dot2c_f32_bf16 v161, v47, v47
    v_dot2c_f32_bf16 v158, s45, v48
    v_dot2c_f32_bf16 v159, v48, v48
    v_dot2c_f32_bf16 v160, s45, v49
    v_dot2c_f32_bf16 v161, v49, v49
    v_dot2c_f32_bf16 v158, s45, v50
    v_dot2c_f32_bf16 v159, v50, v50
    v_dot2c_f32_bf16 v160, s45, v51
    v_dot2c_f32_bf16 v161, v51, v51
    v_dot2c_f32_bf16 v158, s45, v52
    v_dot2c_f32_bf16 v159, v52, v52
    v_dot2c_f32_bf16 v160, s45, v53
    v_dot2c_f32_bf16 v161, v53, v53
    v_dot2c_f32_bf16 v158, s45, v54
    v_dot2c_f32_bf16 v159, v54, v54
    v_dot2c_f32_bf16 v160, s45, v55
    v_dot2c_f32_bf16 v161, v55, v55
    v_dot2c_f32_bf16 v158, s45, v56
    v_dot2c_f32_bf16 v159, v56, v56
    v_dot2c_f32_bf16 v160, s45, v57
    v_dot2c_f32_bf16 v161, v57, v57
    v_dot2c_f32_bf16 v158, s45, v58
    v_dot2c_f32_bf16 v159, v58, v58
    v_dot2c_f32_bf16 v160, s45, v59
    v_dot2c_f32_bf16 v161, v59, v59
    v_dot2c_f32_bf16 v158, s45, v60
    v_dot2c_f32_bf16 v159, v60, v60
    v_dot2c_f32_bf16 v160, s45, v61
    v_dot2c_f32_bf16 v161, v61, v61
    v_dot2c_f32_bf16 v158, s45, v62
    v_dot2c_f32_bf16 v159, v62, v62
    v_dot2c_f32_bf16 v160, s45, v63
    v_dot2c_f32_bf16 v161, v63, v63
    s_nop 2
    v_add_f32 v158, v158, v160
    v_add_f32 v159, v159, v161
    s_nop 1
    v_add_f32_dpp v158, v158, v158 row_ror:8 row_mask:0xf bank_mask:0xf
    v_add_f32_dpp v159, v159, v159 row_ror:8 row_mask:0xf bank_mask:0xf
    s_nop 1
    v_add_f32_dpp v158, v158, v158 row_ror:4 row_mask:0xf bank_mask:0xf
    v_add_f32_dpp v159, v159, v159 row_ror:4 row_mask:0xf bank_mask:0xf
    s_nop 1
    v_add_f32_dpp v158, v158, v158 row_ror:2 row_mask:0xf bank_mask:0xf
    v_add_f32_dpp v159, v159, v159 row_ror:2 row_mask:0xf bank_mask:0xf
    s_nop 1
    v_add_f32_dpp v158, v158, v158 row_ror:1 row_mask:0xf bank_mask:0xf
    v_add_f32_dpp v159, v159, v159 row_ror:1 row_mask:0xf bank_mask:0xf
    v_mul_f32 v158, 0x3acccccd, v158
    v_mul_f32 v159, 0x3acccccd, v159
    v_fma_f32 v159, -v158, v158, v159
    v_max_f32 v159, 0, v159
    v_add_f32 v159, 0x3727c5ac, v159
    v_rsq_f32 v105, v159
    v_sub_f32 v104, 0, v158
    s_waitcnt vmcnt(0)
    v_mov_b32 v158, 0
    v_mov_b32 v159, 0
    v_mov_b32 v160, 0
    v_mov_b32 v161, 0
    v_dot2c_f32_bf16 v158, s45, v64
    v_dot2c_f32_bf16 v159, v64, v64
    v_dot2c_f32_bf16 v160, s45, v65
    v_dot2c_f32_bf16 v161, v65, v65
    v_dot2c_f32_bf16 v158, s45, v66
    v_dot2c_f32_bf16 v159, v66, v66
    v_dot2c_f32_bf16 v160, s45, v67
    v_dot2c_f32_bf16 v161, v67, v67
    v_dot2c_f32_bf16 v158, s45, v68
    v_dot2c_f32_bf16 v159, v68, v68
    v_dot2c_f32_bf16 v160, s45, v69
    v_dot2c_f32_bf16 v161, v69, v69
    v_dot2c_f32_bf16 v158, s45, v70
    v_dot2c_f32_bf16 v159, v70, v70
    v_dot2c_f32_bf16 v160, s45, v71
    v_dot2c_f32_bf16 v161, v71, v71
    v_dot2c_f32_bf16 v158, s45, v72
    v_dot2c_f32_bf16 v159, v72, v72
    v_dot2c_f32_bf16 v160, s45, v73
    v_dot2c_f32_bf16 v161, v73, v73
    v_dot2c_f32_bf16 v158, s45, v74
    v_dot2c_f32_bf16 v159, v74, v74
    v_dot2c_f32_bf16 v160, s45, v75
    v_dot2c_f32_bf16 v161, v75, v75
    v_dot2c_f32_bf16 v158, s45, v76
    v_dot2c_f32_bf16 v159, v76, v76
    v_dot2c_f32_bf16 v160, s45, v77
    v_dot2c_f32_bf16 v161, v77, v77
    v_dot2c_f32_bf16 v158, s45, v78
    v_dot2c_f32_bf16 v159, v78, v78
    v_dot2c_f32_bf16 v160, s45, v79
    v_dot2c_f32_bf16 v161, v79, v79
    v_dot2c_f32_bf16 v158, s45, v80
    v_dot2c_f32_bf16 v159, v80, v80
    v_dot2c_f32_bf16 v160, s45, v81
    v_dot2c_f32_bf16 v161, v81, v81
    v_dot2c_f32_bf16 v158, s45, v82
    v_dot2c_f32_bf16 v159, v82, v82
    v_dot2c_f32_bf16 v160, s45, v83
    v_dot2c_f32_bf16 v161, v83, v83
    s_nop 2
    v_add_f32 v158, v158, v160
    v_add_f32 v159, v159, v161
    s_nop 1
    v_add_f32_dpp v158, v158, v158 row_ror:8 row_mask:0xf bank_mask:0xf
    v_add_f32_dpp v159, v159, v159 row_ror:8 row_mask:0xf bank_mask:0xf
    s_nop 1
    v_add_f32_dpp v158, v158, v158 row_ror:4 row_mask:0xf bank_mask:0xf
    v_add_f32_dpp v159, v159, v159 row_ror:4 row_mask:0xf bank_mask:0xf
    s_nop 1
    v_add_f32_dpp v158, v158, v158 row_ror:2 row_mask:0xf bank_mask:0xf
    v_add_f32_dpp v159, v159, v159 row_ror:2 row_mask:0xf bank_mask:0xf
    s_nop 1
    v_add_f32_dpp v158, v158, v158 row_ror:1 row_mask:0xf bank_mask:0xf
    v_add_f32_dpp v159, v159, v159 row_ror:1 row_mask:0xf bank_mask:0xf
    v_mul_f32 v158, 0x3acccccd, v158
    v_mul_f32 v159, 0x3acccccd, v159
    v_fma_f32 v159, -v158, v158, v159
    v_max_f32 v159, 0, v159
    v_add_f32 v159, 0x3727c5ac, v159
    v_rsq_f32 v107, v159
    v_sub_f32 v106, 0, v158
    v_lshrrev_b32 v156, 4, v155
    v_lshlrev_b32 v156, 3, v156
    s_lshl_b32 s46, s53, 3
    s_add_u32 s46, s46, 26214400
    s_mov_b32 exec_lo, 0x00010001
    s_mov_b32 exec_hi, 0x00010001
    buffer_store_dwordx2 v[100:101], v156, s[12:15], s46 offen offset:0 sc0 sc1
    buffer_store_dwordx2 v[102:103], v156, s[12:15], s46 offen offset:32 sc0 sc1
    buffer_store_dwordx2 v[104:105], v156, s[12:15], s46 offen offset:64 sc0 sc1
    buffer_store_dwordx2 v[106:107], v156, s[12:15], s46 offen offset:96 sc0 sc1
    s_mov_b64 exec, -1
    s_branch L_pj_29
L_pidle_28:
    s_lshl_b32 s50, s33, 4
    s_add_u32 s50, s50, s36
L_csl_30:
    s_cmp_ge_u32 s50, 120
    s_cbranch_scc1 L_csd_31
    s_lshr_b32 s52, s50, 2
    s_mov_b32 s64, s18
    s_mov_b32 s65, s19
    s_mov_b32 s66, 2457600
    s_mov_b32 s67, 0x20000
    s_mov_b32 s54, 3840
    s_lshl_b32 s55, s52, 8
    s_lshl_b32 s52, s52, 7
    s_and_b32 s47, s50, 3
    s_mul_i32 s46, s47, 160
    s_mul_i32 s46, s46, s54
    s_add_u32 s52, s52, s46
    s_mul_i32 s47, s47, 21504
    s_add_u32 s55, s55, s47
    s_add_u32 s55, s55, 26247168
    v_lshrrev_b32 v156, 3, v155
    v_mul_lo_u32 v156, v156, s54
    v_and_b32 v157, 7, v155
    v_lshl_add_u32 v156, v157, 4, v156
    s_lshl_b32 s54, s54, 3
    buffer_load_dwordx4 v[4:7], v156, s[64:67], s52 offen
    s_add_u32 s52, s52, s54
    buffer_load_dwordx4 v[8:11], v156, s[64:67], s52 offen
    s_add_u32 s52, s52, s54
    buffer_load_dwordx4 v[12:15], v156, s[64:67], s52 offen
    s_add_u32 s52, s52, s54
    buffer_load_dwordx4 v[16:19], v156, s[64:67], s52 offen
    s_add_u32 s52, s52, s54
    buffer_load_dwordx4 v[20:23], v156, s[64:67], s52 offen
    s_add_u32 s52, s52, s54
    buffer_load_dwordx4 v[24:27], v156, s[64:67], s52 offen
    s_add_u32 s52, s52, s54
    buffer_load_dwordx4 v[28:31], v156, s[64:67], s52 offen
    s_add_u32 s52, s52, s54
    buffer_load_dwordx4 v[32:35], v156, s[64:67], s52 offen
    s_add_u32 s52, s52, s54
    buffer_load_dwordx4 v[36:39], v156, s[64:67], s52 offen
    s_add_u32 s52, s52, s54
    buffer_load_dwordx4 v[40:43], v156, s[64:67], s52 offen
    s_add_u32 s52, s52, s54
    buffer_load_dwordx4 v[44:47], v156, s[64:67], s52 offen
    s_add_u32 s52, s52, s54
    buffer_load_dwordx4 v[48:51], v156, s[64:67], s52 offen
    s_add_u32 s52, s52, s54
    buffer_load_dwordx4 v[52:55], v156, s[64:67], s52 offen
    s_add_u32 s52, s52, s54
    buffer_load_dwordx4 v[56:59], v156, s[64:67], s52 offen
    s_add_u32 s52, s52, s54
    buffer_load_dwordx4 v[60:63], v156, s[64:67], s52 offen
    s_add_u32 s52, s52, s54
    buffer_load_dwordx4 v[64:67], v156, s[64:67], s52 offen
    s_add_u32 s52, s52, s54
    buffer_load_dwordx4 v[68:71], v156, s[64:67], s52 offen
    s_add_u32 s52, s52, s54
    buffer_load_dwordx4 v[72:75], v156, s[64:67], s52 offen
    s_add_u32 s52, s52, s54
    buffer_load_dwordx4 v[76:79], v156, s[64:67], s52 offen
    s_add_u32 s52, s52, s54
    buffer_load_dwordx4 v[80:83], v156, s[64:67], s52 offen
    s_add_u32 s52, s52, s54
    v_mov_b32 v100, 0
    v_mov_b32 v101, 0
    v_mov_b32 v102, 0
    v_mov_b32 v103, 0
    v_mov_b32 v104, 0
    v_mov_b32 v105, 0
    v_mov_b32 v106, 0
    v_mov_b32 v107, 0
    s_mov_b32 s46, 0x00003f80
    s_mov_b32 s47, 0x3f800000
    s_waitcnt vmcnt(15)
    v_dot2c_f32_bf16 v100, s46, v4
    v_dot2c_f32_bf16 v101, s47, v4
    v_dot2c_f32_bf16 v102, s46, v5
    v_dot2c_f32_bf16 v103, s47, v5
    v_dot2c_f32_bf16 v104, s46, v6
    v_dot2c_f32_bf16 v105, s47, v6
    v_dot2c_f32_bf16 v106, s46, v7
    v_dot2c_f32_bf16 v107, s47, v7
    v_dot2c_f32_bf16 v100, s46, v8
    v_dot2c_f32_bf16 v101, s47, v8
    v_dot2c_f32_bf16 v102, s46, v9
    v_dot2c_f32_bf16 v103, s47, v9
    v_dot2c_f32_bf16 v104, s46, v10
    v_dot2c_f32_bf16 v105, s47, v10
    v_dot2c_f32_bf16 v106, s46, v11
    v_dot2c_f32_bf16 v107, s47, v11
    v_dot2c_f32_bf16 v100, s46, v12
    v_dot2c_f32_bf16 v101, s47, v12
    v_dot2c_f32_bf16 v102, s46, v13
    v_dot2c_f32_bf16 v103, s47, v13
    v_dot2c_f32_bf16 v104, s46, v14
    v_dot2c_f32_bf16 v105, s47, v14
    v_dot2c_f32_bf16 v106, s46, v15
    v_dot2c_f32_bf16 v107, s47, v15
    v_dot2c_f32_bf16 v100, s46, v16
    v_dot2c_f32_bf16 v101, s47, v16
    v_dot2c_f32_bf16 v102, s46, v17
    v_dot2c_f32_bf16 v103, s47, v17
    v_dot2c_f32_bf16 v104, s46, v18
    v_dot2c_f32_bf16 v105, s47, v18
    v_dot2c_f32_bf16 v106, s46, v19
    v_dot2c_f32_bf16 v107, s47, v19
    v_dot2c_f32_bf16 v100, s46, v20
    v_dot2c_f32_bf16 v101, s47, v20
    v_dot2c_f32_bf16 v102, s46, v21
    v_dot2c_f32_bf16 v103, s47, v21
    v_dot2c_f32_bf16 v104, s46, v22
    v_dot2c_f32_bf16 v105, s47, v22
    v_dot2c_f32_bf16 v106, s46, v23
    v_dot2c_f32_bf16 v107, s47, v23
    s_waitcnt vmcnt(10)
    v_dot2c_f32_bf16 v100, s46, v24
    v_dot2c_f32_bf16 v101, s47, v24
    v_dot2c_f32_bf16 v102, s46, v25
    v_dot2c_f32_bf16 v103, s47, v25
    v_dot2c_f32_bf16 v104, s46, v26
    v_dot2c_f32_bf16 v105, s47, v26
    v_dot2c_f32_bf16 v106, s46, v27
    v_dot2c_f32_bf16 v107, s47, v27
    v_dot2c_f32_bf16 v100, s46, v28
    v_dot2c_f32_bf16 v101, s47, v28
    v_dot2c_f32_bf16 v102, s46, v29
    v_dot2c_f32_bf16 v103, s47, v29
    v_dot2c_f32_bf16 v104, s46, v30
    v_dot2c_f32_bf16 v105, s47, v30
    v_dot2c_f32_bf16 v106, s46, v31
    v_dot2c_f32_bf16 v107, s47, v31
    v_dot2c_f32_bf16 v100, s46, v32
    v_dot2c_f32_bf16 v101, s47, v32
    v_dot2c_f32_bf16 v102, s46, v33
    v_dot2c_f32_bf16 v103, s47, v33
    v_dot2c_f32_bf16 v104, s46, v34
    v_dot2c_f32_bf16 v105, s47, v34
    v_dot2c_f32_bf16 v106, s46, v35
    v_dot2c_f32_bf16 v107, s47, v35
    v_dot2c_f32_bf16 v100, s46, v36
    v_dot2c_f32_bf16 v101, s47, v36
    v_dot2c_f32_bf16 v102, s46, v37
    v_dot2c_f32_bf16 v103, s47, v37
    v_dot2c_f32_bf16 v104, s46, v38
    v_dot2c_f32_bf16 v105, s47, v38
    v_dot2c_f32_bf16 v106, s46, v39
    v_dot2c_f32_bf16 v107, s47, v39
    v_dot2c_f32_bf16 v100, s46, v40
    v_dot2c_f32_bf16 v101, s47, v40
    v_dot2c_f32_bf16 v102, s46, v41
    v_dot2c_f32_bf16 v103, s47, v41
    v_dot2c_f32_bf16 v104, s46, v42
    v_dot2c_f32_bf16 v105, s47, v42
    v_dot2c_f32_bf16 v106, s46, v43
    v_dot2c_f32_bf16 v107, s47, v43
    s_waitcnt vmcnt(5)
    v_dot2c_f32_bf16 v100, s46, v44
    v_dot2c_f32_bf16 v101, s47, v44
    v_dot2c_f32_bf16 v102, s46, v45
    v_dot2c_f32_bf16 v103, s47, v45
    v_dot2c_f32_bf16 v104, s46, v46
    v_dot2c_f32_bf16 v105, s47, v46
    v_dot2c_f32_bf16 v106, s46, v47
    v_dot2c_f32_bf16 v107, s47, v47
    v_dot2c_f32_bf16 v100, s46, v48
    v_dot2c_f32_bf16 v101, s47, v48
    v_dot2c_f32_bf16 v102, s46, v49
    v_dot2c_f32_bf16 v103, s47, v49
    v_dot2c_f32_bf16 v104, s46, v50
    v_dot2c_f32_bf16 v105, s47, v50
    v_dot2c_f32_bf16 v106, s46, v51
    v_dot2c_f32_bf16 v107, s47, v51
    v_dot2c_f32_bf16 v100, s46, v52
    v_dot2c_f32_bf16 v101, s47, v52
    v_dot2c_f32_bf16 v102, s46, v53
    v_dot2c_f32_bf16 v103, s47, v53
    v_dot2c_f32_bf16 v104, s46, v54
    v_dot2c_f32_bf16 v105, s47, v54
    v_dot2c_f32_bf16 v106, s46, v55
    v_dot2c_f32_bf16 v107, s47, v55
    v_dot2c_f32_bf16 v100, s46, v56
    v_dot2c_f32_bf16 v101, s47, v56
    v_dot2c_f32_bf16 v102, s46, v57
    v_dot2c_f32_bf16 v103, s47, v57
    v_dot2c_f32_bf16 v104, s46, v58
    v_dot2c_f32_bf16 v105, s47, v58
    v_dot2c_f32_bf16 v106, s46, v59
    v_dot2c_f32_bf16 v107, s47, v59
    v_dot2c_f32_bf16 v100, s46, v60
    v_dot2c_f32_bf16 v101, s47, v60
    v_dot2c_f32_bf16 v102, s46, v61
    v_dot2c_f32_bf16 v103, s47, v61
    v_dot2c_f32_bf16 v104, s46, v62
    v_dot2c_f32_bf16 v105, s47, v62
    v_dot2c_f32_bf16 v106, s46, v63
    v_dot2c_f32_bf16 v107, s47, v63
    s_waitcnt vmcnt(0)
    v_dot2c_f32_bf16 v100, s46, v64
    v_dot2c_f32_bf16 v101, s47, v64
    v_dot2c_f32_bf16 v102, s46, v65
    v_dot2c_f32_bf16 v103, s47, v65
    v_dot2c_f32_bf16 v104, s46, v66
    v_dot2c_f32_bf16 v105, s47, v66
    v_dot2c_f32_bf16 v106, s46, v67
    v_dot2c_f32_bf16 v107, s47, v67
    v_dot2c_f32_bf16 v100, s46, v68
    v_dot2c_f32_bf16 v101, s47, v68
    v_dot2c_f32_bf16 v102, s46, v69
    v_dot2c_f32_bf16 v103, s47, v69
    v_dot2c_f32_bf16 v104, s46, v70
    v_dot2c_f32_bf16 v105, s47, v70
    v_dot2c_f32_bf16 v106, s46, v71
    v_dot2c_f32_bf16 v107, s47, v71
    v_dot2c_f32_bf16 v100, s46, v72
    v_dot2c_f32_bf16 v101, s47, v72
    v_dot2c_f32_bf16 v102, s46, v73
    v_dot2c_f32_bf16 v103, s47, v73
    v_dot2c_f32_bf16 v104, s46, v74
    v_dot2c_f32_bf16 v105, s47, v74
    v_dot2c_f32_bf16 v106, s46, v75
    v_dot2c_f32_bf16 v107, s47, v75
    v_dot2c_f32_bf16 v100, s46, v76
    v_dot2c_f32_bf16 v101, s47, v76
    v_dot2c_f32_bf16 v102, s46, v77
    v_dot2c_f32_bf16 v103, s47, v77
    v_dot2c_f32_bf16 v104, s46, v78
    v_dot2c_f32_bf16 v105, s47, v78
    v_dot2c_f32_bf16 v106, s46, v79
    v_dot2c_f32_bf16 v107, s47, v79
    v_dot2c_f32_bf16 v100, s46, v80
    v_dot2c_f32_bf16 v101, s47, v80
    v_dot2c_f32_bf16 v102, s46, v81
    v_dot2c_f32_bf16 v103, s47, v81
    v_dot2c_f32_bf16 v104, s46, v82
    v_dot2c_f32_bf16 v105, s47, v82
    v_dot2c_f32_bf16 v106, s46, v83
    v_dot2c_f32_bf16 v107, s47, v83
    s_nop 2
    v_add_f32_dpp v100, v100, v100 row_ror:8 row_mask:0xf bank_mask:0xf
    v_add_f32_dpp v101, v101, v101 row_ror:8 row_mask:0xf bank_mask:0xf
    v_add_f32_dpp v102, v102, v102 row_ror:8 row_mask:0xf bank_mask:0xf
    v_add_f32_dpp v103, v103, v103 row_ror:8 row_mask:0xf bank_mask:0xf
    v_add_f32_dpp v104, v104, v104 row_ror:8 row_mask:0xf bank_mask:0xf
    v_add_f32_dpp v105, v105, v105 row_ror:8 row_mask:0xf bank_mask:0xf
    v_add_f32_dpp v106, v106, v106 row_ror:8 row_mask:0xf bank_mask:0xf
    v_add_f32_dpp v107, v107, v107 row_ror:8 row_mask:0xf bank_mask:0xf
    v_mov_b32 v108, v100
    v_mov_b32 v109, v101
    v_mov_b32 v110, v102
    v_mov_b32 v111, v103
    v_mov_b32 v112, v104
    v_mov_b32 v113, v105
    v_mov_b32 v114, v106
    v_mov_b32 v115, v107
    s_nop 1
    v_permlane16_swap_b32 v100, v108
    v_permlane16_swap_b32 v101, v109
    v_permlane16_swap_b32 v102, v110
    v_permlane16_swap_b32 v103, v111
    v_permlane16_swap_b32 v104, v112
    v_permlane16_swap_b32 v105, v113
    v_permlane16_swap_b32 v106, v114
    v_permlane16_swap_b32 v107, v115
    s_nop 1
    v_add_f32 v100, v100, v108
    v_add_f32 v101, v101, v109
    v_add_f32 v102, v102, v110
    v_add_f32 v103, v103, v111
    v_add_f32 v104, v104, v112
    v_add_f32 v105, v105, v113
    v_add_f32 v106, v106, v114
    v_add_f32 v107, v107, v115
    v_mov_b32 v108, v100
    v_mov_b32 v109, v101
    v_mov_b32 v110, v102
    v_mov_b32 v111, v103
    v_mov_b32 v112, v104
    v_mov_b32 v113, v105
    v_mov_b32 v114, v106
    v_mov_b32 v115, v107
    s_nop 1
    v_permlane32_swap_b32 v100, v108
    v_permlane32_swap_b32 v101, v109
    v_permlane32_swap_b32 v102, v110
    v_permlane32_swap_b32 v103, v111
    v_permlane32_swap_b32 v104, v112
    v_permlane32_swap_b32 v105, v113
    v_permlane32_swap_b32 v106, v114
    v_permlane32_swap_b32 v107, v115
    s_nop 1
    v_add_f32 v100, v100, v108
    v_add_f32 v101, v101, v109
    v_add_f32 v102, v102, v110
    v_add_f32 v103, v103, v111
    v_add_f32 v104, v104, v112
    v_add_f32 v105, v105, v113
    v_add_f32 v106, v106, v114
    v_add_f32 v107, v107, v115
    v_lshlrev_b32 v156, 5, v155
    s_mov_b64 exec, 0xff
    buffer_store_dwordx4 v[100:103], v156, s[12:15], s55 offen sc0 sc1
    buffer_store_dwordx4 v[104:107], v156, s[12:15], s55 offen offset:16 sc0 sc1
    s_mov_b64 exec, -1
    s_add_u32 s50, s50, 64
    s_branch L_csl_30
L_csd_31:
    s_cmp_lg_u32 s32, 8
    s_cbranch_scc1 L_noclr_32
    s_lshl_b32 s46, s36, 7
    s_add_u32 s46, s46, 26411008
    v_lshlrev_b32 v156, 2, v155
    v_mov_b32 v157, 0
    s_mov_b32 exec_lo, -1
    s_mov_b32 exec_hi, 0
    buffer_store_dword v157, v156, s[12:15], s46 offen sc0 sc1
    s_mov_b64 exec, -1
    s_waitcnt vmcnt(0)
L_noclr_32:
L_pj_29:
    s_waitcnt vmcnt(0)
    s_barrier
    s_cmp_lg_u32 s32, 0
    s_cbranch_scc1 L_nosig_33
    s_mov_b64 exec, 1
    v_mov_b32 v156, 0
    v_mov_b32 v157, 1
    buffer_atomic_add v157, v156, s[60:63], 0 offen sc1
    s_mov_b64 exec, -1
L_nosig_33:
    s_mul_i32 s46, s36, 12
    s_add_u32 s52, s46, s32
    s_add_u32 s52, s52, 200
    v_lshrrev_b32 v156, 3, v155
    v_mul_u32_u24 v156, 1280, v156
    v_bfe_u32 v157, v155, 4, 1
    v_lshlrev_b32 v157, 1, v157
    v_and_b32 v158, 7, v155
    v_xor_b32 v158, v158, v157
    v_lshl_add_u32 v100, v158, 4, v156
    v_xor_b32 v101, 64, v100
    s_lshl_b32 s44, s32, 13
    v_and_b32 v156, 15, v155
    v_lshrrev_b32 v157, 4, v155
    v_lshrrev_b32 v158, 2, v156
    v_lshl_add_u32 v159, v157, 3, v158
    v_lshlrev_b32 v159, 7, v159
    v_and_b32 v160, 3, v155
    v_lshl_add_u32 v159, v160, 3, v159
    v_lshrrev_b32 v158, 1, v158
    v_and_b32 v157, 1, v157
    v_lshl_or_b32 v158, v157, 1, v158
    v_add_u32 v159, s44, v159
    v_xor_b32 v160, 0, v158
    v_lshl_add_u32 v104, v160, 5, v159
    v_xor_b32 v160, 1, v158
    v_lshl_add_u32 v105, v160, 5, v159
    v_xor_b32 v160, 2, v158
    v_lshl_add_u32 v106, v160, 5, v159
    v_xor_b32 v160, 3, v158
    v_lshl_add_u32 v107, v160, 5, v159
    v_and_b32 v156, 15, v155
    v_lshrrev_b32 v157, 4, v155
    v_lshrrev_b32 v158, 2, v156
    v_lshrrev_b32 v160, 1, v157
    v_lshl_add_u32 v159, v160, 3, v158
    v_lshlrev_b32 v159, 7, v159
    v_and_b32 v161, 3, v155
    v_lshl_add_u32 v159, v161, 3, v159
    v_lshrrev_b32 v158, 1, v158
    v_lshl_or_b32 v158, v160, 1, v158
    v_add_u32 v159, s44, v159
    v_and_b32 v157, 1, v157
    v_add_u32 v160, 0, v157
    v_xor_b32 v160, v160, v158
    v_lshl_add_u32 v108, v160, 5, v159
    v_add_u32 v160, 2, v157
    v_xor_b32 v160, v160, v158
    v_lshl_add_u32 v109, v160, 5, v159
    v_lshlrev_b32 v110, 4, v155
    s_cmp_ge_u32 s52, 200
    s_cselect_b32 s8, s28, s20
    s_cselect_b32 s9, s29, s21
    s_mov_b32 s10, 819200
    s_cselect_b32 s10, 2211840, s10
    s_cselect_b32 s54, 200, 0
    s_mov_b32 s11, 0x20000
    s_sub_u32 s53, s52, s54
    s_mul_i32 s46, s53, 52429
    s_lshr_b32 s46, s46, 19
    s_mul_i32 s47, s46, 10
    s_sub_u32 s47, s53, s47
    s_mul_i32 s42, s46, 40960
    s_lshl_b32 s43, s47, 7
    s_add_u32 s42, s42, s43
    s_add_u32 m0, s44, 0
    s_add_u32 s43, s42, 0
    buffer_load_dwordx4 v100, s[8:11], s43 offen lds
    s_add_u32 m0, s44, 1024
    s_add_u32 s43, s42, 10240
    buffer_load_dwordx4 v101, s[8:11], s43 offen lds
    s_add_u32 m0, s44, 2048
    s_add_u32 s43, s42, 20480
    buffer_load_dwordx4 v100, s[8:11], s43 offen lds
    s_add_u32 m0, s44, 3072
    s_add_u32 s43, s42, 30720
    buffer_load_dwordx4 v101, s[8:11], s43 offen lds
    s_add_u32 s50, s52, 192
    s_cmp_ge_u32 s50, 200
    s_cselect_b32 s8, s28, s20
    s_cselect_b32 s9, s29, s21
    s_mov_b32 s10, 819200
    s_cselect_b32 s10, 2211840, s10
    s_cselect_b32 s54, 200, 0
    s_mov_b32 s11, 0x20000
    s_sub_u32 s53, s50, s54
    s_mul_i32 s46, s53, 52429
    s_lshr_b32 s46, s46, 19
    s_mul_i32 s47, s46, 10
    s_sub_u32 s47, s53, s47
    s_mul_i32 s42, s46, 40960
    s_lshl_b32 s43, s47, 7
    s_add_u32 s42, s42, s43
    s_add_u32 m0, s44, 4096
    s_add_u32 s43, s42, 0
    buffer_load_dwordx4 v100, s[8:11], s43 offen lds
    s_add_u32 m0, s44, 5120
    s_add_u32 s43, s42, 10240
    buffer_load_dwordx4 v101, s[8:11], s43 offen lds
    s_add_u32 m0, s44, 6144
    s_add_u32 s43, s42, 20480
    buffer_load_dwordx4 v100, s[8:11], s43 offen lds
    s_add_u32 m0, s44, 7168
    s_add_u32 s43, s42, 30720
    buffer_load_dwordx4 v101, s[8:11], s43 offen lds
    s_waitcnt vmcnt(4)
    s_cmp_ge_u32 s52, 584
    s_cbranch_scc1 L_tsk_34
    s_cmp_ge_u32 s52, 200
    s_cselect_b32 s8, s28, s20
    s_cselect_b32 s9, s29, s21
    s_mov_b32 s10, 819200
    s_cselect_b32 s10, 2211840, s10
    s_cselect_b32 s54, 200, 0
    s_mov_b32 s11, 0x20000
    s_sub_u32 s53, s52, s54
    s_mul_i32 s46, s53, 52429
    s_lshr_b32 s46, s46, 19
    s_mul_i32 s47, s46, 10
    s_sub_u32 s47, s53, s47
    s_cmp_lg_u32 s54, 0
    s_cbranch_scc1 L_tw2_35
    s_lshl_b32 s47, s47, 2
    s_mul_i32 s47, s47, 20
    s_add_u32 s47, s47, s46
    s_lshl_b32 s47, s47, 10
    s_add_u32 s47, s47, 18874368
    ds_read_b64_tr_b16 v[4:5], v104 offset:0
    ds_read_b64_tr_b16 v[6:7], v104 offset:512
    ds_read_b64_tr_b16 v[8:9], v105 offset:0
    ds_read_b64_tr_b16 v[10:11], v105 offset:512
    ds_read_b64_tr_b16 v[12:13], v106 offset:0
    ds_read_b64_tr_b16 v[14:15], v106 offset:512
    ds_read_b64_tr_b16 v[16:17], v107 offset:0
    ds_read_b64_tr_b16 v[18:19], v107 offset:512
    s_waitcnt lgkmcnt(0)
    buffer_store_dwordx4 v[4:7], v110, s[12:15], s47 offen sc0 sc1
    s_add_u32 s47, s47, 20480
    buffer_store_dwordx4 v[8:11], v110, s[12:15], s47 offen sc0 sc1
    s_add_u32 s47, s47, 20480
    buffer_store_dwordx4 v[12:15], v110, s[12:15], s47 offen sc0 sc1
    s_add_u32 s47, s47, 20480
    buffer_store_dwordx4 v[16:19], v110, s[12:15], s47 offen sc0 sc1
    s_add_u32 s47, s47, 20480
    s_branch L_tnx_36
L_tw2_35:
    ds_read_b64_tr_b16 v[4:5], v108 offset:0
    ds_read_b64_tr_b16 v[6:7], v108 offset:512
    ds_read_b64_tr_b16 v[8:9], v108 offset:2048
    ds_read_b64_tr_b16 v[10:11], v108 offset:2560
    ds_read_b64_tr_b16 v[12:13], v109 offset:0
    ds_read_b64_tr_b16 v[14:15], v109 offset:512
    ds_read_b64_tr_b16 v[16:17], v109 offset:2048
    ds_read_b64_tr_b16 v[18:19], v109 offset:2560
    s_lshl_b32 s47, s47, 1
    s_mul_i32 s47, s47, 108
    s_lshl_b32 s46, s46, 1
    s_add_u32 s47, s47, s46
    s_lshl_b32 s47, s47, 10
    s_add_u32 s47, s47, 19922944
    s_waitcnt lgkmcnt(0)
    s_add_u32 s43, s47, 0
    buffer_store_dwordx4 v[4:7], v110, s[12:15], s43 offen offset:0 sc0 sc1
    buffer_store_dwordx4 v[8:11], v110, s[12:15], s43 offen offset:1024 sc0 sc1
    s_add_u32 s43, s47, 110592
    buffer_store_dwordx4 v[12:15], v110, s[12:15], s43 offen offset:0 sc0 sc1
    buffer_store_dwordx4 v[16:19], v110, s[12:15], s43 offen offset:1024 sc0 sc1
L_tnx_36:
L_tsk_34:
    s_mov_b32 s52, s50
    s_add_u32 s50, s52, 192
    s_waitcnt vmcnt(0)
    s_cmp_ge_u32 s52, 584
    s_cbranch_scc1 L_tsk_37
    s_cmp_ge_u32 s52, 200
    s_cselect_b32 s8, s28, s20
    s_cselect_b32 s9, s29, s21
    s_mov_b32 s10, 819200
    s_cselect_b32 s10, 2211840, s10
    s_cselect_b32 s54, 200, 0
    s_mov_b32 s11, 0x20000
    s_sub_u32 s53, s52, s54
    s_mul_i32 s46, s53, 52429
    s_lshr_b32 s46, s46, 19
    s_mul_i32 s47, s46, 10
    s_sub_u32 s47, s53, s47
    s_cmp_lg_u32 s54, 0
    s_cbranch_scc1 L_tw2_38
    s_lshl_b32 s47, s47, 2
    s_mul_i32 s47, s47, 20
    s_add_u32 s47, s47, s46
    s_lshl_b32 s47, s47, 10
    s_add_u32 s47, s47, 18874368
    ds_read_b64_tr_b16 v[4:5], v104 offset:4096
    ds_read_b64_tr_b16 v[6:7], v104 offset:4608
    ds_read_b64_tr_b16 v[8:9], v105 offset:4096
    ds_read_b64_tr_b16 v[10:11], v105 offset:4608
    ds_read_b64_tr_b16 v[12:13], v106 offset:4096
    ds_read_b64_tr_b16 v[14:15], v106 offset:4608
    ds_read_b64_tr_b16 v[16:17], v107 offset:4096
    ds_read_b64_tr_b16 v[18:19], v107 offset:4608
    s_waitcnt lgkmcnt(0)
    buffer_store_dwordx4 v[4:7], v110, s[12:15], s47 offen sc0 sc1
    s_add_u32 s47, s47, 20480
    buffer_store_dwordx4 v[8:11], v110, s[12:15], s47 offen sc0 sc1
    s_add_u32 s47, s47, 20480
    buffer_store_dwordx4 v[12:15], v110, s[12:15], s47 offen sc0 sc1
    s_add_u32 s47, s47, 20480
    buffer_store_dwordx4 v[16:19], v110, s[12:15], s47 offen sc0 sc1
    s_add_u32 s47, s47, 20480
    s_branch L_tnx_39
L_tw2_38:
    ds_read_b64_tr_b16 v[4:5], v108 offset:4096
    ds_read_b64_tr_b16 v[6:7], v108 offset:4608
    ds_read_b64_tr_b16 v[8:9], v108 offset:6144
    ds_read_b64_tr_b16 v[10:11], v108 offset:6656
    ds_read_b64_tr_b16 v[12:13], v109 offset:4096
    ds_read_b64_tr_b16 v[14:15], v109 offset:4608
    ds_read_b64_tr_b16 v[16:17], v109 offset:6144
    ds_read_b64_tr_b16 v[18:19], v109 offset:6656
    s_lshl_b32 s47, s47, 1
    s_mul_i32 s47, s47, 108
    s_lshl_b32 s46, s46, 1
    s_add_u32 s47, s47, s46
    s_lshl_b32 s47, s47, 10
    s_add_u32 s47, s47, 19922944
    s_waitcnt lgkmcnt(0)
    s_add_u32 s43, s47, 0
    buffer_store_dwordx4 v[4:7], v110, s[12:15], s43 offen offset:0 sc0 sc1
    buffer_store_dwordx4 v[8:11], v110, s[12:15], s43 offen offset:1024 sc0 sc1
    s_add_u32 s43, s47, 110592
    buffer_store_dwordx4 v[12:15], v110, s[12:15], s43 offen offset:0 sc0 sc1
    buffer_store_dwordx4 v[16:19], v110, s[12:15], s43 offen offset:1024 sc0 sc1
L_tnx_39:
L_tsk_37:
    s_mov_b32 s52, s50
    s_waitcnt vmcnt(0)
    s_barrier
    s_mov_b32 s58, 0
    s_cmp_lg_u32 s32, 8
    s_cbranch_scc1 L_pw_40
    s_mov_b32 s47, 0
L_cpoll_41:
    buffer_load_dword v156, off, s[60:63], 0 sc1
    s_waitcnt vmcnt(0)
    v_readfirstlane_b32 s46, v156
    s_add_u32 s47, s47, 1
    s_cmp_ge_u32 s46, 16
    s_cbranch_scc1 L_cok_42
    s_cmp_ge_u32 s47, 40000
    s_cbranch_scc1 L_cok_42
    s_sleep 6
    s_branch L_cpoll_41
L_cok_42:
    s_mov_b32 s52, 15
    s_lshl_b32 s46, s52, 5
    s_add_u32 s46, s46, s36
    s_lshl_b32 s46, s46, 2
    s_add_u32 s46, s46, 26411008
    s_mov_b64 exec, 1
    v_mov_b32 v156, 1
    buffer_store_dword v156, off, s[12:15], s46 sc0 sc1
    s_mov_b64 exec, -1
L_pw_40:
    s_branch L_k12_ph2
L_k12_ph2:
    s_mov_b32 s4, s12
    s_mov_b32 s5, s13
    s_mov_b32 s6, 0x2000000
    s_mov_b32 s7, 0x20000
    s_mov_b32 s10, s32
    s_mov_b32 s50, s20
    s_mov_b32 s51, s21
    s_cmp_lg_u32 s32, 8
    s_cbranch_scc1 L_b1_43
    v_mov_b32 v2, 162816
    v_mov_b32 v4, 0
    v_mov_b32 v5, 0
    v_mov_b32 v6, 0
    v_mov_b32 v7, 0
    ds_write_b128 v2, v[4:7]
    ds_write_b128 v2, v[4:7] offset:16
    ds_write_b128 v2, v[4:7] offset:32
    s_and_b32 s8, s2, 7
    s_lshr_b32 s8, s8, 1
    s_lshl_b32 s9, s8, 7
    s_add_u32 s9, s9, 26411008
    s_mov_b32 s11, 0
    v_and_b32 v9, 63, v0
    v_min_u32 v9, 23, v9
    v_lshlrev_b32 v9, 2, v9
L_poll_44:
    buffer_load_dword v8, v9, s[12:15], s9 offen sc1
    s_waitcnt vmcnt(0)
    v_cmp_ne_u32 vcc, 1, v8
    s_add_u32 s11, s11, 1
    s_nop 0
    s_cmp_eq_u64 vcc, 0
    s_cbranch_scc1 L_pollok_45
    s_cmp_ge_u32 s11, 40000
    s_cbranch_scc1 L_pollok_45
    s_sleep 2
    s_branch L_poll_44
L_pollok_45:
    s_waitcnt lgkmcnt(0)
L_b1_43:
    s_cmp_ge_u32 s10, 8
    s_cbranch_scc1 L_k2_gemm
    v_and_b32 v167, 63, v0
    s_and_b32 s21, s2, 7
    s_lshl_b32 s8, s21, 2
    s_bfe_u32 s21, s2, 0x20003
    s_add_u32 s8, s8, s21
    s_lshr_b32 s9, s2, 5
    s_and_b32 s11, s10, 1
    s_lshr_b32 s12, s10, 1
    s_mov_b32 s16, 0x000fffff
    s_mov_b32 s17, 0x000fffff
    s_mov_b32 s22, -1
    s_mov_b32 s23, 0
    s_lshl_b32 s21, s8, 6
    s_lshl_b32 s28, s12, 4
    s_add_u32 s21, s21, s28
    s_mul_i32 s21, s21, 1280
    s_add_u32 s13, s21, 3145728
    s_add_u32 s14, s21, 5767168
    s_add_u32 s30, s13, 20480
    s_add_u32 s31, s14, 20480
    v_lshlrev_b32 v1, 4, v167
    v_and_b32 v164, 31, v167
    v_lshlrev_b32 v2, 3, v164
    v_add_u32 v2, 1024, v2
    v_lshrrev_b32 v165, 5, v167
    v_mul_u32_u24 v3, 320, v165
    v_lshl_add_u32 v3, v164, 4, v3
    v_mul_u32_u24 v100, 40, v164
    v_lshl_add_u32 v101, v165, 4, v100
    s_lshl_b32 s21, s8, 11
    s_lshl_b32 s28, s9, 8
    s_add_u32 s21, s21, s28
    s_lshl_b32 s28, s11, 7
    s_add_u32 s21, s21, s28
    s_mul_i32 s21, s21, 40
    s_add_u32 s21, s21, 0
    v_mov_b32 v72, 0
    v_mov_b32 v73, 0
    v_mov_b32 v80, 0
    v_mov_b32 v81, 0
    v_mov_b32 v88, 0
    v_mov_b32 v89, 0
    v_mov_b32 v96, 0
    v_mov_b32 v97, 0
    v_mov_b32 v136, 0x3f803f80
    v_mov_b32 v137, 0x00003f80
    v_mov_b32 v152, 0x3f803f80
    v_mov_b32 v153, 0x00003f80
    s_waitcnt lgkmcnt(0)
    v_cmp_eq_u32 s[24:25], 20, v164
    v_cmp_eq_u32 vcc, 24, v164
    s_nop 1
    s_or_b64 s[24:25], s[24:25], vcc
    v_mov_b32 v166, 0x3f803f80
    s_nop 0
    v_cndmask_b32 v166, 0, v166, s[24:25]
    s_mov_b32 s18, s13
    s_mov_b32 s19, s14
    v_mov_b32 v140, v166
    v_mov_b32 v141, v166
    v_mov_b32 v142, v166
    v_mov_b32 v143, v166
    v_mov_b32 v144, v166
    v_mov_b32 v145, v166
    v_mov_b32 v146, v166
    v_mov_b32 v147, v166
    v_mov_b32 v156, v166
    v_mov_b32 v157, v166
    v_mov_b32 v158, v166
    v_mov_b32 v159, v166
    v_mov_b32 v160, v166
    v_mov_b32 v161, v166
    v_mov_b32 v162, v166
    v_mov_b32 v163, v166
    s_barrier
    s_cmp_lt_u32 s18, s30
    s_cselect_b32 s29, s18, 0x7ff00000
    buffer_load_dwordx4 v[132:135], v1, s[4:7], s29 offen sc1
    s_mov_b64 exec, s[22:23]
    buffer_load_dwordx2 v[136:137], v2, s[4:7], s29 offen sc1
    s_mov_b64 exec, -1
    s_add_u32 s18, s18, 1280
    s_add_u32 s28, s21, 0
    buffer_load_dwordx4 v[68:71], v101, s[4:7], s28 offen sc1
    s_mov_b64 exec, s[22:23]
    buffer_load_dwordx2 v[72:73], v100, s[4:7], s28 offen offset:32 sc1
    s_mov_b64 exec, -1
    s_add_u32 s28, s21, 1280
    buffer_load_dwordx4 v[76:79], v101, s[4:7], s28 offen sc1
    s_mov_b64 exec, s[22:23]
    buffer_load_dwordx2 v[80:81], v100, s[4:7], s28 offen offset:32 sc1
    s_mov_b64 exec, -1
    s_add_u32 s28, s21, 2560
    buffer_load_dwordx4 v[84:87], v101, s[4:7], s28 offen sc1
    s_mov_b64 exec, s[22:23]
    buffer_load_dwordx2 v[88:89], v100, s[4:7], s28 offen offset:32 sc1
    s_mov_b64 exec, -1
    s_add_u32 s28, s21, 3840
    buffer_load_dwordx4 v[92:95], v101, s[4:7], s28 offen sc1
    s_mov_b64 exec, s[22:23]
    buffer_load_dwordx2 v[96:97], v100, s[4:7], s28 offen offset:32 sc1
    s_mov_b64 exec, -1
    s_cmp_lt_u32 s19, s31
    s_cselect_b32 s29, s19, 0x7ff00000
    s_mov_b64 exec, s[16:17]
    buffer_load_dwordx4 v[140:143], v3, s[4:7], s29 offen sc1
    buffer_load_dwordx4 v[144:147], v3, s[4:7], s29 offen offset:640 sc1
    s_mov_b64 exec, -1
    s_add_u32 s19, s19, 1280
    s_cmp_lt_u32 s18, s30
    s_cselect_b32 s29, s18, 0x7ff00000
    buffer_load_dwordx4 v[148:151], v1, s[4:7], s29 offen sc1
    s_mov_b64 exec, s[22:23]
    buffer_load_dwordx2 v[152:153], v2, s[4:7], s29 offen sc1
    s_mov_b64 exec, -1
    s_add_u32 s18, s18, 1280
    s_mov_b32 s20, 0
    s_waitcnt vmcnt(0)
    s_barrier
    v_mfma_f32_32x32x16_bf16 v[4:19], v[132:135], v[68:71], 0
    v_mfma_f32_32x32x8_bf16 v[4:19], v[136:137], v[72:73], v[4:19]
    v_mfma_f32_32x32x16_bf16 v[20:35], v[132:135], v[76:79], 0
    v_mfma_f32_32x32x8_bf16 v[20:35], v[136:137], v[80:81], v[20:35]
    v_mfma_f32_32x32x16_bf16 v[36:51], v[132:135], v[84:87], 0
    v_mfma_f32_32x32x8_bf16 v[36:51], v[136:137], v[88:89], v[36:51]
    v_mfma_f32_32x32x16_bf16 v[52:67], v[132:135], v[92:95], 0
    v_mfma_f32_32x32x8_bf16 v[52:67], v[136:137], v[96:97], v[52:67]
    s_nop 5
    v_max3_f32 v116, v4, v5, v6
    v_max3_f32 v116, v116, v7, v8
    v_max3_f32 v116, v116, v9, v10
    v_max3_f32 v116, v116, v11, v12
    v_max3_f32 v116, v116, v13, v14
    v_max3_f32 v116, v116, v15, v16
    v_max3_f32 v116, v116, v17, v18
    v_max_f32 v116, v116, v19
    v_max3_f32 v117, v20, v21, v22
    v_max3_f32 v117, v117, v23, v24
    v_max3_f32 v117, v117, v25, v26
    v_max3_f32 v117, v117, v27, v28
    v_max3_f32 v117, v117, v29, v30
    v_max3_f32 v117, v117, v31, v32
    v_max3_f32 v117, v117, v33, v34
    v_max_f32 v117, v117, v35
    v_max3_f32 v118, v36, v37, v38
    v_max3_f32 v118, v118, v39, v40
    v_max3_f32 v118, v118, v41, v42
    v_max3_f32 v118, v118, v43, v44
    v_max3_f32 v118, v118, v45, v46
    v_max3_f32 v118, v118, v47, v48
    v_max3_f32 v118, v118, v49, v50
    v_max_f32 v118, v118, v51
    s_nop 3
    v_max3_f32 v119, v52, v53, v54
    v_max3_f32 v119, v119, v55, v56
    v_max3_f32 v119, v119, v57, v58
    v_max3_f32 v119, v119, v59, v60
    v_max3_f32 v119, v119, v61, v62
    v_max3_f32 v119, v119, v63, v64
    v_max3_f32 v119, v119, v65, v66
    v_max_f32 v119, v119, v67
    v_mov_b32 v100, v116
    v_mov_b32 v101, v116
    v_mov_b32 v102, v117
    v_mov_b32 v103, v117
    v_mov_b32 v104, v118
    v_mov_b32 v105, v118
    v_mov_b32 v106, v119
    v_mov_b32 v107, v119
    s_nop 1
    v_permlane32_swap_b32 v100, v101
    v_permlane32_swap_b32 v102, v103
    v_permlane32_swap_b32 v104, v105
    v_permlane32_swap_b32 v106, v107
    s_nop 1
    v_max_f32 v116, v100, v101
    v_max_f32 v117, v102, v103
    v_max_f32 v118, v104, v105
    v_max_f32 v119, v106, v107
    v_add_f32 v116, 0x42c00000, v116
    v_sub_f32 v100, 0, v116
    v_add_f32 v117, 0x42c00000, v117
    v_sub_f32 v104, 0, v117
    v_add_f32 v118, 0x42c00000, v118
    v_sub_f32 v108, 0, v118
    v_add_f32 v119, 0x42c00000, v119
    v_sub_f32 v112, 0, v119
    v_cvt_pk_bf16_f32 v101, v100, v100
    v_cvt_pk_bf16_f32 v105, v104, v104
    v_cvt_pk_bf16_f32 v109, v108, v108
    v_cvt_pk_bf16_f32 v113, v112, v112
    v_lshlrev_b32 v101, 16, v101
    v_lshlrev_b32 v105, 16, v105
    v_lshlrev_b32 v109, 16, v109
    v_lshlrev_b32 v113, 16, v113
    v_sub_f32 v102, v100, v101
    v_sub_f32 v106, v104, v105
    v_sub_f32 v110, v108, v109
    v_sub_f32 v114, v112, v113
    v_cvt_pk_bf16_f32 v101, v102, v102
    v_cvt_pk_bf16_f32 v105, v106, v106
    v_cvt_pk_bf16_f32 v109, v110, v110
    v_cvt_pk_bf16_f32 v113, v114, v114
    v_lshlrev_b32 v101, 16, v101
    v_lshlrev_b32 v105, 16, v105
    v_lshlrev_b32 v109, 16, v109
    v_lshlrev_b32 v113, 16, v113
    v_sub_f32 v103, v102, v101
    v_cvt_pk_bf16_f32 v102, v100, v102
    v_mov_b32 v101, 0
    v_cvt_pk_bf16_f32 v103, v103, v101
    v_sub_f32 v107, v106, v105
    v_cvt_pk_bf16_f32 v106, v104, v106
    v_mov_b32 v105, 0
    v_cvt_pk_bf16_f32 v107, v107, v105
    v_sub_f32 v111, v110, v109
    v_cvt_pk_bf16_f32 v110, v108, v110
    v_mov_b32 v109, 0
    v_cvt_pk_bf16_f32 v111, v111, v109
    v_sub_f32 v115, v114, v113
    v_cvt_pk_bf16_f32 v114, v112, v114
    v_mov_b32 v113, 0
    v_cvt_pk_bf16_f32 v115, v115, v113
    v_cndmask_b32 v72, v102, v72, s[22:23]
    v_cndmask_b32 v73, v103, v73, s[22:23]
    v_cndmask_b32 v80, v106, v80, s[22:23]
    v_cndmask_b32 v81, v107, v81, s[22:23]
    v_cndmask_b32 v88, v110, v88, s[22:23]
    v_cndmask_b32 v89, v111, v89, s[22:23]
    v_cndmask_b32 v96, v114, v96, s[22:23]
    v_cndmask_b32 v97, v115, v97, s[22:23]
L_k2_main:
    v_mov_b32 v120, 0
    v_mov_b32 v121, 0
    v_mov_b32 v122, 0
    v_mov_b32 v123, 0
    s_nop 1
    v_mfma_f32_32x32x16_bf16 v[4:19], v[132:135], v[120:123], 0
    v_mfma_f32_32x32x16_bf16 v[20:35], v[132:135], v[120:123], 0
    v_mfma_f32_32x32x16_bf16 v[36:51], v[132:135], v[120:123], 0
    v_mfma_f32_32x32x16_bf16 v[52:67], v[132:135], v[120:123], 0
    v_mfma_f32_32x32x16_bf16 v[100:115], v[132:135], v[68:71], 0
    v_mfma_f32_32x32x8_bf16 v[100:115], v[136:137], v[72:73], v[100:115]
    s_nop 11
    s_mov_b32 s15, 0
    s_cmp_lt_u32 s10, 4
    s_cbranch_scc1 L_pz_46
    s_setprio 1
L_pz_46:
L_k2_loop:
    s_cmp_lg_u32 s15, 4
    s_cbranch_scc1 L_pz_47
    s_setprio 0
L_pz_47:
    v_exp_f32 v100, v100
    v_exp_f32 v101, v101
    v_mfma_f32_32x32x16_bf16 v[52:67], v[160:163], v[120:123], v[52:67]
    s_cmp_lt_u32 s19, s31
    s_cselect_b32 s29, s19, 0x7ff00000
    s_mov_b64 exec, s[16:17]
    buffer_load_dwordx4 v[156:159], v3, s[4:7], s29 offen sc1
    buffer_load_dwordx4 v[160:163], v3, s[4:7], s29 offen offset:640 sc1
    s_mov_b64 exec, -1
    s_add_u32 s19, s19, 1280
    v_exp_f32 v102, v102
    v_exp_f32 v103, v103
    v_exp_f32 v104, v104
    v_exp_f32 v105, v105
    v_mfma_f32_32x32x16_bf16 v[116:131], v[132:135], v[76:79], 0
    v_exp_f32 v106, v106
    v_exp_f32 v107, v107
    v_cvt_pk_bf16_f32 v100, v100, v101
    v_cvt_pk_bf16_f32 v101, v102, v103
    v_cvt_pk_bf16_f32 v102, v104, v105
    v_cvt_pk_bf16_f32 v103, v106, v107
    v_mfma_f32_32x32x8_bf16 v[116:131], v[136:137], v[80:81], v[116:131]
    v_exp_f32 v108, v108
    v_exp_f32 v109, v109
    v_exp_f32 v110, v110
    v_exp_f32 v111, v111
    v_exp_f32 v112, v112
    v_exp_f32 v113, v113
    s_waitcnt vmcnt(4)
    v_mfma_f32_32x32x16_bf16 v[4:19], v[140:143], v[100:103], v[4:19]
    v_exp_f32 v114, v114
    v_exp_f32 v115, v115
    v_cvt_pk_bf16_f32 v104, v108, v109
    v_cvt_pk_bf16_f32 v105, v110, v111
    v_cvt_pk_bf16_f32 v106, v112, v113
    v_cvt_pk_bf16_f32 v107, v114, v115
    v_exp_f32 v116, v116
    v_exp_f32 v117, v117
    v_mfma_f32_32x32x16_bf16 v[4:19], v[144:147], v[104:107], v[4:19]
    v_exp_f32 v118, v118
    v_exp_f32 v119, v119
    v_exp_f32 v120, v120
    v_exp_f32 v121, v121
    v_mfma_f32_32x32x16_bf16 v[100:115], v[132:135], v[84:87], 0
    v_exp_f32 v122, v122
    v_exp_f32 v123, v123
    v_cvt_pk_bf16_f32 v116, v116, v117
    v_cvt_pk_bf16_f32 v117, v118, v119
    v_cvt_pk_bf16_f32 v118, v120, v121
    v_cvt_pk_bf16_f32 v119, v122, v123
    v_mfma_f32_32x32x8_bf16 v[100:115], v[136:137], v[88:89], v[100:115]
    v_exp_f32 v124, v124
    v_exp_f32 v125, v125
    v_exp_f32 v126, v126
    v_exp_f32 v127, v127
    v_exp_f32 v128, v128
    v_exp_f32 v129, v129
    v_mfma_f32_32x32x16_bf16 v[20:35], v[140:143], v[116:119], v[20:35]
    v_exp_f32 v130, v130
    v_exp_f32 v131, v131
    v_cvt_pk_bf16_f32 v120, v124, v125
    v_cvt_pk_bf16_f32 v121, v126, v127
    v_cvt_pk_bf16_f32 v122, v128, v129
    v_cvt_pk_bf16_f32 v123, v130, v131
    v_exp_f32 v100, v100
    v_exp_f32 v101, v101
    v_mfma_f32_32x32x16_bf16 v[20:35], v[144:147], v[120:123], v[20:35]
    v_exp_f32 v102, v102
    v_exp_f32 v103, v103
    v_exp_f32 v104, v104
    v_exp_f32 v105, v105
    v_mfma_f32_32x32x16_bf16 v[116:131], v[132:135], v[92:95], 0
    v_exp_f32 v106, v106
    v_exp_f32 v107, v107
    v_cvt_pk_bf16_f32 v100, v100, v101
    v_cvt_pk_bf16_f32 v101, v102, v103
    v_cvt_pk_bf16_f32 v102, v104, v105
    v_cvt_pk_bf16_f32 v103, v106, v107
    v_mfma_f32_32x32x8_bf16 v[116:131], v[136:137], v[96:97], v[116:131]
    s_cmp_lt_u32 s18, s30
    s_cselect_b32 s29, s18, 0x7ff00000
    buffer_load_dwordx4 v[132:135], v1, s[4:7], s29 offen sc1
    s_mov_b64 exec, s[22:23]
    buffer_load_dwordx2 v[136:137], v2, s[4:7], s29 offen sc1
    s_mov_b64 exec, -1
    s_add_u32 s18, s18, 1280
    v_exp_f32 v108, v108
    v_exp_f32 v109, v109
    v_exp_f32 v110, v110
    v_exp_f32 v111, v111
    v_exp_f32 v112, v112
    v_exp_f32 v113, v113
    v_mfma_f32_32x32x16_bf16 v[36:51], v[140:143], v[100:103], v[36:51]
    v_exp_f32 v114, v114
    v_exp_f32 v115, v115
    v_cvt_pk_bf16_f32 v104, v108, v109
    v_cvt_pk_bf16_f32 v105, v110, v111
    v_cvt_pk_bf16_f32 v106, v112, v113
    v_cvt_pk_bf16_f32 v107, v114, v115
    v_exp_f32 v116, v116
    v_exp_f32 v117, v117
    v_mfma_f32_32x32x16_bf16 v[36:51], v[144:147], v[104:107], v[36:51]
    v_exp_f32 v118, v118
    v_exp_f32 v119, v119
    v_exp_f32 v120, v120
    v_exp_f32 v121, v121
    s_waitcnt vmcnt(4)
    v_mfma_f32_32x32x16_bf16 v[100:115], v[148:151], v[68:71], 0
    v_exp_f32 v122, v122
    v_exp_f32 v123, v123
    v_cvt_pk_bf16_f32 v116, v116, v117
    v_cvt_pk_bf16_f32 v117, v118, v119
    v_cvt_pk_bf16_f32 v118, v120, v121
    v_cvt_pk_bf16_f32 v119, v122, v123
    v_mfma_f32_32x32x8_bf16 v[100:115], v[152:153], v[72:73], v[100:115]
    v_exp_f32 v124, v124
    v_exp_f32 v125, v125
    v_exp_f32 v126, v126
    v_exp_f32 v127, v127
    v_exp_f32 v128, v128
    v_exp_f32 v129, v129
    v_mfma_f32_32x32x16_bf16 v[52:67], v[140:143], v[116:119], v[52:67]
    v_exp_f32 v130, v130
    v_exp_f32 v131, v131
    v_cvt_pk_bf16_f32 v120, v124, v125
    v_cvt_pk_bf16_f32 v121, v126, v127
    v_cvt_pk_bf16_f32 v122, v128, v129
    v_cvt_pk_bf16_f32 v123, v130, v131
    v_exp_f32 v100, v100
    v_exp_f32 v101, v101
    v_mfma_f32_32x32x16_bf16 v[52:67], v[144:147], v[120:123], v[52:67]
    s_cmp_lt_u32 s19, s31
    s_cselect_b32 s29, s19, 0x7ff00000
    s_mov_b64 exec, s[16:17]
    buffer_load_dwordx4 v[140:143], v3, s[4:7], s29 offen sc1
    buffer_load_dwordx4 v[144:147], v3, s[4:7], s29 offen offset:640 sc1
    s_mov_b64 exec, -1
    s_add_u32 s19, s19, 1280
    v_exp_f32 v102, v102
    v_exp_f32 v103, v103
    v_exp_f32 v104, v104
    v_exp_f32 v105, v105
    v_mfma_f32_32x32x16_bf16 v[116:131], v[148:151], v[76:79], 0
    v_exp_f32 v106, v106
    v_exp_f32 v107, v107
    v_cvt_pk_bf16_f32 v100, v100, v101
    v_cvt_pk_bf16_f32 v101, v102, v103
    v_cvt_pk_bf16_f32 v102, v104, v105
    v_cvt_pk_bf16_f32 v103, v106, v107
    v_mfma_f32_32x32x8_bf16 v[116:131], v[152:153], v[80:81], v[116:131]
    v_exp_f32 v108, v108
    v_exp_f32 v109, v109
    v_exp_f32 v110, v110
    v_exp_f32 v111, v111
    v_exp_f32 v112, v112
    v_exp_f32 v113, v113
    s_waitcnt vmcnt(4)
    v_mfma_f32_32x32x16_bf16 v[4:19], v[156:159], v[100:103], v[4:19]
    v_exp_f32 v114, v114
    v_exp_f32 v115, v115
    v_cvt_pk_bf16_f32 v104, v108, v109
    v_cvt_pk_bf16_f32 v105, v110, v111
    v_cvt_pk_bf16_f32 v106, v112, v113
    v_cvt_pk_bf16_f32 v107, v114, v115
    v_exp_f32 v116, v116
    v_exp_f32 v117, v117
    v_mfma_f32_32x32x16_bf16 v[4:19], v[160:163], v[104:107], v[4:19]
    v_exp_f32 v118, v118
    v_exp_f32 v119, v119
    v_exp_f32 v120, v120
    v_exp_f32 v121, v121
    v_mfma_f32_32x32x16_bf16 v[100:115], v[148:151], v[84:87], 0
    v_exp_f32 v122, v122
    v_exp_f32 v123, v123
    v_cvt_pk_bf16_f32 v116, v116, v117
    v_cvt_pk_bf16_f32 v117, v118, v119
    v_cvt_pk_bf16_f32 v118, v120, v121
    v_cvt_pk_bf16_f32 v119, v122, v123
    v_mfma_f32_32x32x8_bf16 v[100:115], v[152:153], v[88:89], v[100:115]
    v_exp_f32 v124, v124
    v_exp_f32 v125, v125
    v_exp_f32 v126, v126
    v_exp_f32 v127, v127
    v_exp_f32 v128, v128
    v_exp_f32 v129, v129
    v_mfma_f32_32x32x16_bf16 v[20:35], v[156:159], v[116:119], v[20:35]
    v_exp_f32 v130, v130
    v_exp_f32 v131, v131
    v_cvt_pk_bf16_f32 v120, v124, v125
    v_cvt_pk_bf16_f32 v121, v126, v127
    v_cvt_pk_bf16_f32 v122, v128, v129
    v_cvt_pk_bf16_f32 v123, v130, v131
    v_exp_f32 v100, v100
    v_exp_f32 v101, v101
    v_mfma_f32_32x32x16_bf16 v[20:35], v[160:163], v[120:123], v[20:35]
    v_exp_f32 v102, v102
    v_exp_f32 v103, v103
    v_exp_f32 v104, v104
    v_exp_f32 v105, v105
    v_mfma_f32_32x32x16_bf16 v[116:131], v[148:151], v[92:95], 0
    v_exp_f32 v106, v106
    v_exp_f32 v107, v107
    v_cvt_pk_bf16_f32 v100, v100, v101
    v_cvt_pk_bf16_f32 v101, v102, v103
    v_cvt_pk_bf16_f32 v102, v104, v105
    v_cvt_pk_bf16_f32 v103, v106, v107
    v_mfma_f32_32x32x8_bf16 v[116:131], v[152:153], v[96:97], v[116:131]
    s_cmp_lt_u32 s18, s30
    s_cselect_b32 s29, s18, 0x7ff00000
    buffer_load_dwordx4 v[148:151], v1, s[4:7], s29 offen sc1
    s_mov_b64 exec, s[22:23]
    buffer_load_dwordx2 v[152:153], v2, s[4:7], s29 offen sc1
    s_mov_b64 exec, -1
    s_add_u32 s18, s18, 1280
    v_exp_f32 v108, v108
    v_exp_f32 v109, v109
    v_exp_f32 v110, v110
    v_exp_f32 v111, v111
    v_exp_f32 v112, v112
    v_exp_f32 v113, v113
    v_mfma_f32_32x32x16_bf16 v[36:51], v[156:159], v[100:103], v[36:51]
    v_exp_f32 v114, v114
    v_exp_f32 v115, v115
    v_cvt_pk_bf16_f32 v104, v108, v109
    v_cvt_pk_bf16_f32 v105, v110, v111
    v_cvt_pk_bf16_f32 v106, v112, v113
    v_cvt_pk_bf16_f32 v107, v114, v115
    v_exp_f32 v116, v116
    v_exp_f32 v117, v117
    v_mfma_f32_32x32x16_bf16 v[36:51], v[160:163], v[104:107], v[36:51]
    v_exp_f32 v118, v118
    v_exp_f32 v119, v119
    v_exp_f32 v120, v120
    v_exp_f32 v121, v121
    s_waitcnt vmcnt(4)
    v_mfma_f32_32x32x16_bf16 v[100:115], v[132:135], v[68:71], 0
    v_exp_f32 v122, v122
    v_exp_f32 v123, v123
    v_cvt_pk_bf16_f32 v116, v116, v117
    v_cvt_pk_bf16_f32 v117, v118, v119
    v_cvt_pk_bf16_f32 v118, v120, v121
    v_cvt_pk_bf16_f32 v119, v122, v123
    v_mfma_f32_32x32x8_bf16 v[100:115], v[136:137], v[72:73], v[100:115]
    v_exp_f32 v124, v124
    v_exp_f32 v125, v125
    v_exp_f32 v126, v126
    v_exp_f32 v127, v127
    v_exp_f32 v128, v128
    v_exp_f32 v129, v129
    v_mfma_f32_32x32x16_bf16 v[52:67], v[156:159], v[116:119], v[52:67]
    v_exp_f32 v130, v130
    v_exp_f32 v131, v131
    v_cvt_pk_bf16_f32 v120, v124, v125
    v_cvt_pk_bf16_f32 v121, v126, v127
    v_cvt_pk_bf16_f32 v122, v128, v129
    v_cvt_pk_bf16_f32 v123, v130, v131
    s_add_u32 s15, s15, 1
    s_cmp_lt_u32 s15, 8
    s_cbranch_scc1 L_k2_loop
    s_nop 1
    v_mfma_f32_32x32x16_bf16 v[52:67], v[160:163], v[120:123], v[52:67]
    s_waitcnt vmcnt(0)
    s_nop 11
    s_mov_b64 s[24:25], 0
    v_cndmask_b32 v100, v12, v16, s[22:23]
    v_add_f32 v104, abs(v4), abs(v5)
    v_cndmask_b32 v101, v28, v32, s[22:23]
    v_add_f32 v105, abs(v20), abs(v21)
    v_cndmask_b32 v102, v44, v48, s[22:23]
    v_add_f32 v106, abs(v36), abs(v37)
    v_cndmask_b32 v103, v60, v64, s[22:23]
    v_add_f32 v107, abs(v52), abs(v53)
    v_add_f32 v104, v104, abs(v6)
    v_add_f32 v105, v105, abs(v22)
    v_add_f32 v106, v106, abs(v38)
    v_add_f32 v107, v107, abs(v54)
    v_add_f32 v104, v104, abs(v7)
    v_add_f32 v105, v105, abs(v23)
    v_add_f32 v106, v106, abs(v39)
    v_add_f32 v107, v107, abs(v55)
    v_add_f32 v104, v104, abs(v8)
    v_add_f32 v105, v105, abs(v24)
    v_add_f32 v106, v106, abs(v40)
    v_add_f32 v107, v107, abs(v56)
    v_add_f32 v104, v104, abs(v9)
    v_add_f32 v105, v105, abs(v25)
    v_add_f32 v106, v106, abs(v41)
    v_add_f32 v107, v107, abs(v57)
    v_add_f32 v104, v104, abs(v10)
    v_add_f32 v105, v105, abs(v26)
    v_add_f32 v106, v106, abs(v42)
    v_add_f32 v107, v107, abs(v58)
    v_add_f32 v104, v104, abs(v11)
    v_add_f32 v105, v105, abs(v27)
    v_add_f32 v106, v106, abs(v43)
    v_add_f32 v107, v107, abs(v59)
    v_add_f32 v104, v104, abs(v12)
    v_add_f32 v105, v105, abs(v28)
    v_add_f32 v106, v106, abs(v44)
    v_add_f32 v107, v107, abs(v60)
    v_add_f32 v104, v104, abs(v13)
    v_add_f32 v105, v105, abs(v29)
    v_add_f32 v106, v106, abs(v45)
    v_add_f32 v107, v107, abs(v61)
    v_add_f32 v104, v104, abs(v14)
    v_add_f32 v105, v105, abs(v30)
    v_add_f32 v106, v106, abs(v46)
    v_add_f32 v107, v107, abs(v62)
    v_add_f32 v104, v104, abs(v15)
    v_add_f32 v105, v105, abs(v31)
    v_add_f32 v106, v106, abs(v47)
    v_add_f32 v107, v107, abs(v63)
    v_mov_b32 v108, 0x7e800000
    v_add_f32 v104, v104, v100
    v_add_f32 v105, v105, v101
    v_add_f32 v106, v106, v102
    v_add_f32 v107, v107, v103
    v_cmp_nlt_f32 vcc, v104, v108
    s_nop 1
    s_or_b64 s[24:25], s[24:25], vcc
    v_cmp_nlt_f32 vcc, v105, v108
    s_nop 1
    s_or_b64 s[24:25], s[24:25], vcc
    v_cmp_nlt_f32 vcc, v106, v108
    s_nop 1
    s_or_b64 s[24:25], s[24:25], vcc
    v_cmp_nlt_f32 vcc, v107, v108
    s_nop 1
    s_or_b64 s[24:25], s[24:25], vcc
    s_cmp_eq_u64 s[24:25], 0
    s_cbranch_scc1 L_k2_ok
    s_cmp_lg_u32 s20, 0
    s_cbranch_scc1 L_k2_ok
    s_mov_b32 s20, 1
    v_cndmask_b32 v72, 0, v72, s[22:23]
    v_cndmask_b32 v73, 0, v73, s[22:23]
    v_mov_b32 v4, 0xff800000
    v_cndmask_b32 v80, 0, v80, s[22:23]
    v_cndmask_b32 v81, 0, v81, s[22:23]
    v_mov_b32 v5, 0xff800000
    v_cndmask_b32 v88, 0, v88, s[22:23]
    v_cndmask_b32 v89, 0, v89, s[22:23]
    v_mov_b32 v6, 0xff800000
    v_cndmask_b32 v96, 0, v96, s[22:23]
    v_cndmask_b32 v97, 0, v97, s[22:23]
    v_mov_b32 v7, 0xff800000
    s_mov_b32 s18, s13
    s_mov_b32 s15, 0
L_k2_fb:
    s_cmp_lt_u32 s18, s30
    s_cselect_b32 s29, s18, 0x7ff00000
    buffer_load_dwordx4 v[132:135], v1, s[4:7], s29 offen sc1
    s_mov_b64 exec, s[22:23]
    buffer_load_dwordx2 v[136:137], v2, s[4:7], s29 offen sc1
    s_mov_b64 exec, -1
    s_add_u32 s18, s18, 1280
    s_waitcnt vmcnt(0)
    v_mfma_f32_32x32x16_bf16 v[100:115], v[132:135], v[68:71], 0
    v_mfma_f32_32x32x8_bf16 v[100:115], v[136:137], v[72:73], v[100:115]
    s_nop 11
    v_max3_f32 v4, v4, v100, v101
    v_max3_f32 v4, v4, v102, v103
    v_max3_f32 v4, v4, v104, v105
    v_max3_f32 v4, v4, v106, v107
    v_max3_f32 v4, v4, v108, v109
    v_max3_f32 v4, v4, v110, v111
    v_max3_f32 v4, v4, v112, v113
    v_max3_f32 v4, v4, v114, v115
    v_mfma_f32_32x32x16_bf16 v[100:115], v[132:135], v[76:79], 0
    v_mfma_f32_32x32x8_bf16 v[100:115], v[136:137], v[80:81], v[100:115]
    s_nop 11
    v_max3_f32 v5, v5, v100, v101
    v_max3_f32 v5, v5, v102, v103
    v_max3_f32 v5, v5, v104, v105
    v_max3_f32 v5, v5, v106, v107
    v_max3_f32 v5, v5, v108, v109
    v_max3_f32 v5, v5, v110, v111
    v_max3_f32 v5, v5, v112, v113
    v_max3_f32 v5, v5, v114, v115
    v_mfma_f32_32x32x16_bf16 v[100:115], v[132:135], v[84:87], 0
    v_mfma_f32_32x32x8_bf16 v[100:115], v[136:137], v[88:89], v[100:115]
    s_nop 11
    v_max3_f32 v6, v6, v100, v101
    v_max3_f32 v6, v6, v102, v103
    v_max3_f32 v6, v6, v104, v105
    v_max3_f32 v6, v6, v106, v107
    v_max3_f32 v6, v6, v108, v109
    v_max3_f32 v6, v6, v110, v111
    v_max3_f32 v6, v6, v112, v113
    v_max3_f32 v6, v6, v114, v115
    v_mfma_f32_32x32x16_bf16 v[100:115], v[132:135], v[92:95], 0
    v_mfma_f32_32x32x8_bf16 v[100:115], v[136:137], v[96:97], v[100:115]
    s_nop 11
    v_max3_f32 v7, v7, v100, v101
    v_max3_f32 v7, v7, v102, v103
    v_max3_f32 v7, v7, v104, v105
    v_max3_f32 v7, v7, v106, v107
    v_max3_f32 v7, v7, v108, v109
    v_max3_f32 v7, v7, v110, v111
    v_max3_f32 v7, v7, v112, v113
    v_max3_f32 v7, v7, v114, v115
    s_add_u32 s15, s15, 1
    s_cmp_lt_u32 s15, 16
    s_cbranch_scc1 L_k2_fb
    v_mov_b32 v100, v4
    v_mov_b32 v101, v4
    v_mov_b32 v102, v5
    v_mov_b32 v103, v5
    v_mov_b32 v104, v6
    v_mov_b32 v105, v6
    v_mov_b32 v106, v7
    v_mov_b32 v107, v7
    s_nop 1
    v_permlane32_swap_b32 v100, v101
    v_permlane32_swap_b32 v102, v103
    v_permlane32_swap_b32 v104, v105
    v_permlane32_swap_b32 v106, v107
    s_nop 1
    v_max_f32 v4, v100, v101
    v_max_f32 v5, v102, v103
    v_max_f32 v6, v104, v105
    v_max_f32 v7, v106, v107
    v_sub_f32 v100, 0, v4
    v_sub_f32 v104, 0, v5
    v_sub_f32 v108, 0, v6
    v_sub_f32 v112, 0, v7
    v_cvt_pk_bf16_f32 v101, v100, v100
    v_cvt_pk_bf16_f32 v105, v104, v104
    v_cvt_pk_bf16_f32 v109, v108, v108
    v_cvt_pk_bf16_f32 v113, v112, v112
    v_lshlrev_b32 v101, 16, v101
    v_lshlrev_b32 v105, 16, v105
    v_lshlrev_b32 v109, 16, v109
    v_lshlrev_b32 v113, 16, v113
    v_sub_f32 v102, v100, v101
    v_sub_f32 v106, v104, v105
    v_sub_f32 v110, v108, v109
    v_sub_f32 v114, v112, v113
    v_cvt_pk_bf16_f32 v101, v102, v102
    v_cvt_pk_bf16_f32 v105, v106, v106
    v_cvt_pk_bf16_f32 v109, v110, v110
    v_cvt_pk_bf16_f32 v113, v114, v114
    v_lshlrev_b32 v101, 16, v101
    v_lshlrev_b32 v105, 16, v105
    v_lshlrev_b32 v109, 16, v109
    v_lshlrev_b32 v113, 16, v113
    v_sub_f32 v103, v102, v101
    v_cvt_pk_bf16_f32 v102, v100, v102
    v_mov_b32 v101, 0
    v_cvt_pk_bf16_f32 v103, v103, v101
    v_sub_f32 v107, v106, v105
    v_cvt_pk_bf16_f32 v106, v104, v106
    v_mov_b32 v105, 0
    v_cvt_pk_bf16_f32 v107, v107, v105
    v_sub_f32 v111, v110, v109
    v_cvt_pk_bf16_f32 v110, v108, v110
    v_mov_b32 v109, 0
    v_cvt_pk_bf16_f32 v111, v111, v109
    v_sub_f32 v115, v114, v113
    v_cvt_pk_bf16_f32 v114, v112, v114
    v_mov_b32 v113, 0
    v_cvt_pk_bf16_f32 v115, v115, v113
    v_cndmask_b32 v72, v102, v72, s[22:23]
    v_cndmask_b32 v73, v103, v73, s[22:23]
    v_cndmask_b32 v80, v106, v80, s[22:23]
    v_cndmask_b32 v81, v107, v81, s[22:23]
    v_cndmask_b32 v88, v110, v88, s[22:23]
    v_cndmask_b32 v89, v111, v89, s[22:23]
    v_cndmask_b32 v96, v114, v96, s[22:23]
    v_cndmask_b32 v97, v115, v97, s[22:23]
    s_mov_b32 s18, s13
    s_mov_b32 s19, s14
    s_cmp_lt_u32 s18, s30
    s_cselect_b32 s29, s18, 0x7ff00000
    buffer_load_dwordx4 v[132:135], v1, s[4:7], s29 offen sc1
    s_mov_b64 exec, s[22:23]
    buffer_load_dwordx2 v[136:137], v2, s[4:7], s29 offen sc1
    s_mov_b64 exec, -1
    s_add_u32 s18, s18, 1280
    s_cmp_lt_u32 s19, s31
    s_cselect_b32 s29, s19, 0x7ff00000
    s_mov_b64 exec, s[16:17]
    buffer_load_dwordx4 v[140:143], v3, s[4:7], s29 offen sc1
    buffer_load_dwordx4 v[144:147], v3, s[4:7], s29 offen offset:640 sc1
    s_mov_b64 exec, -1
    s_add_u32 s19, s19, 1280
    s_cmp_lt_u32 s18, s30
    s_cselect_b32 s29, s18, 0x7ff00000
    buffer_load_dwordx4 v[148:151], v1, s[4:7], s29 offen sc1
    s_mov_b64 exec, s[22:23]
    buffer_load_dwordx2 v[152:153], v2, s[4:7], s29 offen sc1
    s_mov_b64 exec, -1
    s_add_u32 s18, s18, 1280
    s_waitcnt vmcnt(4)
    s_branch L_k2_main
L_k2_ok:
    v_and_b32 v112, 31, v0
    v_mul_u32_u24 v112, 96, v112
    v_bfe_u32 v113, v0, 5, 1
    v_lshl_add_u32 v112, v113, 4, v112
    s_lshl_b32 s21, s12, 8
    s_lshl_b32 s28, s11, 7
    s_add_u32 s21, s21, s28
    s_mul_i32 s21, s21, 96
    v_add_u32 v112, s21, v112
    v_rcp_f32 v114, v100
    v_log_f32 v118, v100
    v_rcp_f32 v115, v101
    v_log_f32 v119, v101
    v_rcp_f32 v116, v102
    v_log_f32 v120, v102
    v_rcp_f32 v117, v103
    v_log_f32 v121, v103
    v_lshlrev_b32 v122, 16, v72
    v_and_b32 v123, 0xffff0000, v72
    v_lshlrev_b32 v124, 16, v73
    v_add_f32 v123, v123, v124
    v_add_f32 v122, v122, v123
    v_sub_f32 v118, v118, v122
    v_lshlrev_b32 v122, 16, v80
    v_and_b32 v123, 0xffff0000, v80
    v_lshlrev_b32 v124, 16, v81
    v_add_f32 v123, v123, v124
    v_add_f32 v122, v122, v123
    v_sub_f32 v119, v119, v122
    v_lshlrev_b32 v122, 16, v88
    v_and_b32 v123, 0xffff0000, v88
    v_lshlrev_b32 v124, 16, v89
    v_add_f32 v123, v123, v124
    v_add_f32 v122, v122, v123
    v_sub_f32 v120, v120, v122
    v_lshlrev_b32 v122, 16, v96
    v_and_b32 v123, 0xffff0000, v96
    v_lshlrev_b32 v124, 16, v97
    v_add_f32 v123, v123, v124
    v_add_f32 v122, v122, v123
    v_sub_f32 v121, v121, v122
    v_pk_mul_f32 v[4:5], v[4:5], v[114:115] op_sel:[0,0] op_sel_hi:[1,0]
    v_pk_mul_f32 v[6:7], v[6:7], v[114:115] op_sel:[0,0] op_sel_hi:[1,0]
    v_pk_mul_f32 v[8:9], v[8:9], v[114:115] op_sel:[0,0] op_sel_hi:[1,0]
    v_pk_mul_f32 v[10:11], v[10:11], v[114:115] op_sel:[0,0] op_sel_hi:[1,0]
    v_pk_mul_f32 v[12:13], v[12:13], v[114:115] op_sel:[0,0] op_sel_hi:[1,0]
    v_pk_mul_f32 v[14:15], v[14:15], v[114:115] op_sel:[0,0] op_sel_hi:[1,0]
    ds_write_b128 v112, v[4:7] offset:0
    ds_write_b128 v112, v[8:11] offset:32
    s_mov_b64 exec, s[22:23]
    ds_write_b128 v112, v[12:15] offset:64
    s_not_b64 exec, exec
    ds_write_b32 v112, v118 offset:64
    s_mov_b64 exec, -1
    v_pk_mul_f32 v[20:21], v[20:21], v[114:115] op_sel:[0,1] op_sel_hi:[1,1]
    v_pk_mul_f32 v[22:23], v[22:23], v[114:115] op_sel:[0,1] op_sel_hi:[1,1]
    v_pk_mul_f32 v[24:25], v[24:25], v[114:115] op_sel:[0,1] op_sel_hi:[1,1]
    v_pk_mul_f32 v[26:27], v[26:27], v[114:115] op_sel:[0,1] op_sel_hi:[1,1]
    v_pk_mul_f32 v[28:29], v[28:29], v[114:115] op_sel:[0,1] op_sel_hi:[1,1]
    v_pk_mul_f32 v[30:31], v[30:31], v[114:115] op_sel:[0,1] op_sel_hi:[1,1]
    ds_write_b128 v112, v[20:23] offset:3072
    ds_write_b128 v112, v[24:27] offset:3104
    s_mov_b64 exec, s[22:23]
    ds_write_b128 v112, v[28:31] offset:3136
    s_not_b64 exec, exec
    ds_write_b32 v112, v119 offset:3136
    s_mov_b64 exec, -1
    v_pk_mul_f32 v[36:37], v[36:37], v[116:117] op_sel:[0,0] op_sel_hi:[1,0]
    v_pk_mul_f32 v[38:39], v[38:39], v[116:117] op_sel:[0,0] op_sel_hi:[1,0]
    v_pk_mul_f32 v[40:41], v[40:41], v[116:117] op_sel:[0,0] op_sel_hi:[1,0]
    v_pk_mul_f32 v[42:43], v[42:43], v[116:117] op_sel:[0,0] op_sel_hi:[1,0]
    v_pk_mul_f32 v[44:45], v[44:45], v[116:117] op_sel:[0,0] op_sel_hi:[1,0]
    v_pk_mul_f32 v[46:47], v[46:47], v[116:117] op_sel:[0,0] op_sel_hi:[1,0]
    ds_write_b128 v112, v[36:39] offset:6144
    ds_write_b128 v112, v[40:43] offset:6176
    s_mov_b64 exec, s[22:23]
    ds_write_b128 v112, v[44:47] offset:6208
    s_not_b64 exec, exec
    ds_write_b32 v112, v120 offset:6208
    s_mov_b64 exec, -1
    v_pk_mul_f32 v[52:53], v[52:53], v[116:117] op_sel:[0,1] op_sel_hi:[1,1]
    v_pk_mul_f32 v[54:55], v[54:55], v[116:117] op_sel:[0,1] op_sel_hi:[1,1]
    v_pk_mul_f32 v[56:57], v[56:57], v[116:117] op_sel:[0,1] op_sel_hi:[1,1]
    v_pk_mul_f32 v[58:59], v[58:59], v[116:117] op_sel:[0,1] op_sel_hi:[1,1]
    v_pk_mul_f32 v[60:61], v[60:61], v[116:117] op_sel:[0,1] op_sel_hi:[1,1]
    v_pk_mul_f32 v[62:63], v[62:63], v[116:117] op_sel:[0,1] op_sel_hi:[1,1]
    ds_write_b128 v112, v[52:55] offset:9216
    ds_write_b128 v112, v[56:59] offset:9248
    s_mov_b64 exec, s[22:23]
    ds_write_b128 v112, v[60:63] offset:9280
    s_not_b64 exec, exec
    ds_write_b32 v112, v121 offset:9280
    s_mov_b64 exec, -1
    s_waitcnt lgkmcnt(0)
    s_barrier
    v_lshrrev_b32 v100, 1, v0
    v_and_b32 v101, 1, v0
    v_mul_u32_u24 v102, 96, v100
    v_add_u32 v104, 0, v102
    v_add_u32 v105, 24576, v102
    v_add_u32 v106, 49152, v102
    v_add_u32 v107, 73728, v102
    ds_read_b32 v4, v104 offset:80
    ds_read_b32 v5, v105 offset:80
    ds_read_b32 v6, v106 offset:80
    ds_read_b32 v7, v107 offset:80
    v_mul_u32_u24 v103, 48, v101
    v_add_u32 v104, v104, v103
    v_add_u32 v105, v105, v103
    v_add_u32 v106, v106, v103
    v_add_u32 v107, v107, v103
    ds_read_b128 v[20:23], v104 offset:0
    ds_read_b128 v[24:27], v104 offset:16
    ds_read_b128 v[28:31], v104 offset:32
    ds_read_b128 v[32:35], v105 offset:0
    ds_read_b128 v[36:39], v105 offset:16
    ds_read_b128 v[40:43], v105 offset:32
    ds_read_b128 v[44:47], v106 offset:0
    ds_read_b128 v[48:51], v106 offset:16
    ds_read_b128 v[52:55], v106 offset:32
    ds_read_b128 v[56:59], v107 offset:0
    ds_read_b128 v[60:63], v107 offset:16
    ds_read_b128 v[64:67], v107 offset:32
    s_lshl_b32 s21, s9, 8
    v_add_u32 v100, s21, v100
    v_lshrrev_b32 v102, 4, v100
    v_mul_u32_u24 v102, 20480, v102
    v_and_b32 v103, 15, v100
    v_lshl_add_u32 v102, v103, 4, v102
    s_mul_i32 s21, s8, 5
    v_mul_u32_u24 v103, 3, v101
    v_add_u32 v103, s21, v103
    s_mov_b32 s28, 15728640
    v_add_u32 v104, 0, v103
    v_lshrrev_b32 v105, 1, v104
    v_lshl_add_u32 v105, v105, 8, v102
    v_and_b32 v104, 1, v104
    v_lshl_add_u32 v108, v104, 3, v105
    v_add_u32 v104, 1, v103
    v_lshrrev_b32 v105, 1, v104
    v_lshl_add_u32 v105, v105, 8, v102
    v_and_b32 v104, 1, v104
    v_lshl_add_u32 v109, v104, 3, v105
    v_add_u32 v104, 2, v103
    v_lshrrev_b32 v105, 1, v104
    v_lshl_add_u32 v105, v105, 8, v102
    v_and_b32 v104, 1, v104
    v_lshl_add_u32 v110, v104, 3, v105
    s_waitcnt lgkmcnt(0)
    v_max3_f32 v8, v4, v5, v6
    v_max_f32 v8, v8, v7
    v_sub_f32 v4, v4, v8
    v_sub_f32 v5, v5, v8
    v_sub_f32 v6, v6, v8
    v_sub_f32 v7, v7, v8
    v_exp_f32 v4, v4
    v_exp_f32 v5, v5
    v_exp_f32 v6, v6
    v_exp_f32 v7, v7
    s_nop 0
    v_add_f32 v9, v4, v5
    v_add_f32 v10, v6, v7
    v_add_f32 v9, v9, v10
    v_rcp_f32 v9, v9
    s_nop 0
    v_mul_f32 v4, v4, v9
    v_mul_f32 v5, v5, v9
    v_mul_f32 v6, v6, v9
    v_mul_f32 v7, v7, v9
    v_mul_f32 v20, v20, v4
    v_mul_f32 v21, v21, v4
    v_mul_f32 v22, v22, v4
    v_mul_f32 v23, v23, v4
    v_mul_f32 v24, v24, v4
    v_mul_f32 v25, v25, v4
    v_mul_f32 v26, v26, v4
    v_mul_f32 v27, v27, v4
    v_mul_f32 v28, v28, v4
    v_mul_f32 v29, v29, v4
    v_mul_f32 v30, v30, v4
    v_mul_f32 v31, v31, v4
    v_fmac_f32 v20, v32, v5
    v_fmac_f32 v21, v33, v5
    v_fmac_f32 v22, v34, v5
    v_fmac_f32 v23, v35, v5
    v_fmac_f32 v24, v36, v5
    v_fmac_f32 v25, v37, v5
    v_fmac_f32 v26, v38, v5
    v_fmac_f32 v27, v39, v5
    v_fmac_f32 v28, v40, v5
    v_fmac_f32 v29, v41, v5
    v_fmac_f32 v30, v42, v5
    v_fmac_f32 v31, v43, v5
    v_fmac_f32 v20, v44, v6
    v_fmac_f32 v21, v45, v6
    v_fmac_f32 v22, v46, v6
    v_fmac_f32 v23, v47, v6
    v_fmac_f32 v24, v48, v6
    v_fmac_f32 v25, v49, v6
    v_fmac_f32 v26, v50, v6
    v_fmac_f32 v27, v51, v6
    v_fmac_f32 v28, v52, v6
    v_fmac_f32 v29, v53, v6
    v_fmac_f32 v30, v54, v6
    v_fmac_f32 v31, v55, v6
    v_fmac_f32 v20, v56, v7
    v_fmac_f32 v21, v57, v7
    v_fmac_f32 v22, v58, v7
    v_fmac_f32 v23, v59, v7
    v_fmac_f32 v24, v60, v7
    v_fmac_f32 v25, v61, v7
    v_fmac_f32 v26, v62, v7
    v_fmac_f32 v27, v63, v7
    v_fmac_f32 v28, v64, v7
    v_fmac_f32 v29, v65, v7
    v_fmac_f32 v30, v66, v7
    v_fmac_f32 v31, v67, v7
    v_cvt_pk_bf16_f32 v12, v20, v21
    v_cvt_pk_bf16_f32 v13, v22, v23
    v_cvt_pk_bf16_f32 v14, v24, v25
    v_cvt_pk_bf16_f32 v15, v26, v27
    v_cvt_pk_bf16_f32 v16, v28, v29
    v_cvt_pk_bf16_f32 v17, v30, v31
    buffer_store_dwordx2 v[12:13], v108, s[4:7], s28 offen
    buffer_store_dwordx2 v[14:15], v109, s[4:7], s28 offen
    v_cmp_eq_u32 vcc, 0, v101
    s_nop 0
    s_and_saveexec_b64 s[24:25], vcc
    buffer_store_dwordx2 v[16:17], v110, s[4:7], s28 offen
    s_mov_b64 exec, -1
    s_endpgm
L_k2_gemm:
    s_waitcnt lgkmcnt(0)
    s_barrier
    s_barrier
    s_sub_u32 s11, s10, 8
    s_setprio 3
    s_and_b32 s21, s2, 7
    s_lshl_b32 s8, s21, 3
    s_bfe_u32 s21, s2, 0x30003
    s_add_u32 s8, s8, s21
    s_lshr_b32 s9, s2, 6
    s_mul_i32 s21, s11, 27
    s_mul_i32 s28, s8, 108
    s_add_u32 s28, s28, s21
    s_lshl_b32 s28, s28, 10
    s_add_u32 s32, s28, 8388608
    s_mul_i32 s28, s9, 540
    s_add_u32 s28, s28, s21
    s_lshl_b32 s28, s28, 10
    s_add_u32 s33, s28, 19922944
    s_add_u32 s34, s33, 110592
    s_add_u32 s35, s34, 110592
    s_add_u32 s36, s35, 110592
    s_add_u32 s37, s36, 110592
    v_and_b32 v160, 63, v0
    v_lshlrev_b32 v157, 4, v160
    v_mov_b32 v156, v157
    v_and_b32 v160, 63, v0
    v_lshlrev_b32 v160, 4, v160
    v_add_u32 v161, 98304, v160
    v_mov_b32 v162, 162816
    v_mov_b32 v163, 1
    s_cmp_eq_u32 s58, 0
    s_cbranch_scc1 L_job0_48
    s_cmp_ge_u32 s58, 12
    s_cbranch_scc1 L_jobq_49
    v_and_b32 v84, 63, v0
    v_lshlrev_b32 v84, 4, v84
    s_mul_i32 s21, s11, 12288
    v_add_u32 v85, s21, v84
    ds_read_b128 v[4:7], v85 offset:0
    ds_read_b128 v[8:11], v85 offset:1024
    ds_read_b128 v[12:15], v85 offset:2048
    ds_read_b128 v[16:19], v85 offset:3072
    ds_read_b128 v[20:23], v85 offset:4096
    ds_read_b128 v[24:27], v85 offset:5120
    ds_read_b128 v[28:31], v85 offset:6144
    ds_read_b128 v[32:35], v85 offset:7168
    ds_read_b128 v[36:39], v85 offset:8192
    ds_read_b128 v[40:43], v85 offset:9216
    ds_read_b128 v[44:47], v85 offset:10240
    ds_read_b128 v[48:51], v85 offset:11264
    s_mul_i32 s21, s11, 221184
    s_add_u32 s21, s21, s54
    s_add_u32 s28, s21, 0
    s_waitcnt lgkmcnt(11)
    buffer_store_dwordx4 v[4:7], v84, s[4:7], s28 offen sc0 sc1
    s_add_u32 s28, s21, 1024
    s_waitcnt lgkmcnt(10)
    buffer_store_dwordx4 v[8:11], v84, s[4:7], s28 offen sc0 sc1
    s_add_u32 s28, s21, 2048
    s_waitcnt lgkmcnt(9)
    buffer_store_dwordx4 v[12:15], v84, s[4:7], s28 offen sc0 sc1
    s_add_u32 s28, s21, 3072
    s_waitcnt lgkmcnt(8)
    buffer_store_dwordx4 v[16:19], v84, s[4:7], s28 offen sc0 sc1
    s_add_u32 s28, s21, 4096
    s_waitcnt lgkmcnt(7)
    buffer_store_dwordx4 v[20:23], v84, s[4:7], s28 offen sc0 sc1
    s_add_u32 s28, s21, 5120
    s_waitcnt lgkmcnt(6)
    buffer_store_dwordx4 v[24:27], v84, s[4:7], s28 offen sc0 sc1
    s_add_u32 s28, s21, 110592
    s_waitcnt lgkmcnt(5)
    buffer_store_dwordx4 v[28:31], v84, s[4:7], s28 offen sc0 sc1
    s_add_u32 s28, s21, 111616
    s_waitcnt lgkmcnt(4)
    buffer_store_dwordx4 v[32:35], v84, s[4:7], s28 offen sc0 sc1
    s_add_u32 s28, s21, 112640
    s_waitcnt lgkmcnt(3)
    buffer_store_dwordx4 v[36:39], v84, s[4:7], s28 offen sc0 sc1
    s_add_u32 s28, s21, 113664
    s_waitcnt lgkmcnt(2)
    buffer_store_dwordx4 v[40:43], v84, s[4:7], s28 offen sc0 sc1
    s_add_u32 s28, s21, 114688
    s_waitcnt lgkmcnt(1)
    buffer_store_dwordx4 v[44:47], v84, s[4:7], s28 offen sc0 sc1
    s_add_u32 s28, s21, 115712
    s_waitcnt lgkmcnt(0)
    buffer_store_dwordx4 v[48:51], v84, s[4:7], s28 offen sc0 sc1
    s_branch L_job0_48_rep
L_jobq_49:
    s_mov_b32 s40, s52
    s_mov_b32 s41, s53
    s_mov_b32 s42, 2211840
    s_mov_b32 s43, 0x20000
    s_lshl_b32 s44, s11, 12
    s_mul_i32 s21, s11, 96
    s_add_u32 s21, s21, s54
    s_add_u32 s21, s21, 384
    s_cmp_ge_u32 s21, 540
    s_cbranch_scc1 L_noslab_50
    v_and_b32 v90, 63, v0
    v_lshrrev_b32 v140, 3, v90
    v_mul_u32_u24 v140, 1280, v140
    v_bfe_u32 v141, v90, 4, 1
    v_lshlrev_b32 v141, 1, v141
    v_and_b32 v142, 7, v90
    v_xor_b32 v142, v142, v141
    v_lshl_add_u32 v84, v142, 4, v140
    v_xor_b32 v85, 64, v84
    s_mul_i32 s45, s21, 52429
    s_lshr_b32 s45, s45, 19
    s_mul_i32 s46, s45, 10
    s_sub_u32 s46, s21, s46
    s_mul_i32 s47, s45, 40960
    s_lshl_b32 s48, s46, 7
    s_add_u32 s47, s47, s48
    s_add_u32 m0, s44, 0
    s_add_u32 s48, s47, 0
    buffer_load_dwordx4 v84, s[40:43], s48 offen lds
    s_add_u32 m0, s44, 1024
    s_add_u32 s48, s47, 10240
    buffer_load_dwordx4 v85, s[40:43], s48 offen lds
    s_add_u32 m0, s44, 2048
    s_add_u32 s48, s47, 20480
    buffer_load_dwordx4 v84, s[40:43], s48 offen lds
    s_add_u32 m0, s44, 3072
    s_add_u32 s48, s47, 30720
    buffer_load_dwordx4 v85, s[40:43], s48 offen lds
    v_and_b32 v140, 15, v90
    v_lshrrev_b32 v141, 4, v90
    v_lshrrev_b32 v142, 2, v140
    v_lshrrev_b32 v144, 1, v141
    v_lshl_add_u32 v143, v144, 3, v142
    v_lshlrev_b32 v143, 7, v143
    v_and_b32 v145, 3, v90
    v_lshl_add_u32 v143, v145, 3, v143
    v_lshrrev_b32 v142, 1, v142
    v_lshl_or_b32 v142, v144, 1, v142
    v_add_u32 v143, s44, v143
    v_and_b32 v141, 1, v141
    v_add_u32 v144, 0, v141
    v_xor_b32 v144, v144, v142
    v_lshl_add_u32 v86, v144, 5, v143
    v_add_u32 v144, 2, v141
    v_xor_b32 v144, v144, v142
    v_lshl_add_u32 v87, v144, 5, v143
    v_lshlrev_b32 v90, 4, v90
    s_waitcnt vmcnt(0)
    ds_read_b64_tr_b16 v[92:93], v86 offset:0
    ds_read_b64_tr_b16 v[94:95], v86 offset:512
    ds_read_b64_tr_b16 v[96:97], v86 offset:2048
    ds_read_b64_tr_b16 v[98:99], v86 offset:2560
    ds_read_b64_tr_b16 v[100:101], v87 offset:0
    ds_read_b64_tr_b16 v[102:103], v87 offset:512
    ds_read_b64_tr_b16 v[104:105], v87 offset:2048
    ds_read_b64_tr_b16 v[106:107], v87 offset:2560
    s_lshl_b32 s46, s46, 1
    s_mul_i32 s46, s46, 108
    s_lshl_b32 s45, s45, 1
    s_add_u32 s46, s46, s45
    s_lshl_b32 s46, s46, 10
    s_add_u32 s46, s46, 19922944
    s_waitcnt lgkmcnt(0)
    s_add_u32 s47, s46, 0
    buffer_store_dwordx4 v[92:95], v90, s[4:7], s47 offen offset:0 sc0 sc1
    buffer_store_dwordx4 v[96:99], v90, s[4:7], s47 offen offset:1024 sc0 sc1
    s_add_u32 s47, s46, 110592
    buffer_store_dwordx4 v[100:103], v90, s[4:7], s47 offen offset:0 sc0 sc1
    buffer_store_dwordx4 v[104:107], v90, s[4:7], s47 offen offset:1024 sc0 sc1
L_noslab_50:
L_job0_48_rep:
    s_waitcnt vmcnt(0)
    v_mov_b32 v84, 1
    s_mov_b64 exec, 1
    ds_add_u32 v162, v84 offset:36
    s_mov_b64 exec, -1
L_job0_48:
    s_cmp_lg_u32 s10, 8
    s_cbranch_scc1 L_gothers_51
    s_cmp_eq_u32 s58, 0
    s_cbranch_scc1 L_hsig_53
    s_mov_b32 s28, 0
L_stq_54:
    ds_read_b32 v84, v162 offset:36
    s_waitcnt lgkmcnt(0)
    v_readfirstlane_b32 s21, v84
    s_add_u32 s28, s28, 1
    s_cmp_ge_u32 s21, 4
    s_cbranch_scc1 L_stok_55
    s_cmp_ge_u32 s28, 400000
    s_cbranch_scc1 L_stok_55
    s_sleep 2
    s_branch L_stq_54
L_stok_55:
    s_lshl_b32 s21, s58, 5
    s_add_u32 s21, s21, s59
    s_lshl_b32 s21, s21, 2
    s_add_u32 s21, s21, 26411008
    s_mov_b64 exec, 1
    v_mov_b32 v84, 1
    buffer_store_dword v84, off, s[4:7], s21 sc0 sc1
    s_mov_b64 exec, -1
L_hsig_53:
    s_lshr_b32 s21, s8, 3
    s_add_u32 s21, s21, 4
    s_lshl_b32 s28, s21, 7
    s_add_u32 s28, s28, 26411008
    s_mov_b32 s26, 0
    v_and_b32 v85, 63, v0
    v_min_u32 v85, 17, v85
    v_lshlrev_b32 v85, 2, v85
L_poll_56:
    buffer_load_dword v84, v85, s[4:7], s28 offen sc1
    s_waitcnt vmcnt(0)
    v_cmp_ne_u32 vcc, 1, v84
    s_add_u32 s26, s26, 1
    s_nop 0
    s_cmp_eq_u64 vcc, 0
    s_cbranch_scc1 L_pollok_57
    s_cmp_ge_u32 s26, 40000
    s_cbranch_scc1 L_pollok_57
    s_sleep 6
    s_branch L_poll_56
L_pollok_57:
    s_mov_b32 s21, 15
    s_lshl_b32 s28, s21, 7
    s_add_u32 s28, s28, 26411008
    s_mov_b32 s26, 0
    v_and_b32 v85, 63, v0
    v_min_u32 v85, 15, v85
    v_lshlrev_b32 v85, 2, v85
L_poll_58:
    buffer_load_dword v84, v85, s[4:7], s28 offen sc1
    s_waitcnt vmcnt(0)
    v_cmp_ne_u32 vcc, 1, v84
    s_add_u32 s26, s26, 1
    s_nop 0
    s_cmp_eq_u64 vcc, 0
    s_cbranch_scc1 L_pollok_59
    s_cmp_ge_u32 s26, 40000
    s_cbranch_scc1 L_pollok_59
    s_sleep 6
    s_branch L_poll_58
L_pollok_59:
    s_mov_b32 s21, 12
    s_lshl_b32 s28, s21, 7
    s_add_u32 s28, s28, 26411008
    s_mov_b32 s26, 0
    v_and_b32 v85, 63, v0
    v_min_u32 v85, 31, v85
    v_lshlrev_b32 v85, 2, v85
L_poll_60:
    buffer_load_dword v84, v85, s[4:7], s28 offen sc1
    s_waitcnt vmcnt(0)
    v_cmp_ne_u32 vcc, 1, v84
    s_add_u32 s26, s26, 1
    s_nop 0
    s_cmp_eq_u64 vcc, 0
    s_cbranch_scc1 L_pollok_61
    s_cmp_ge_u32 s26, 40000
    s_cbranch_scc1 L_pollok_61
    s_sleep 6
    s_branch L_poll_60
L_pollok_61:
    s_mov_b32 s21, 13
    s_lshl_b32 s28, s21, 7
    s_add_u32 s28, s28, 26411008
    s_mov_b32 s26, 0
    v_and_b32 v85, 63, v0
    v_min_u32 v85, 31, v85
    v_lshlrev_b32 v85, 2, v85
L_poll_62:
    buffer_load_dword v84, v85, s[4:7], s28 offen sc1
    s_waitcnt vmcnt(0)
    v_cmp_ne_u32 vcc, 1, v84
    s_add_u32 s26, s26, 1
    s_nop 0
    s_cmp_eq_u64 vcc, 0
    s_cbranch_scc1 L_pollok_63
    s_cmp_ge_u32 s26, 40000
    s_cbranch_scc1 L_pollok_63
    s_sleep 6
    s_branch L_poll_62
L_pollok_63:
    s_mov_b32 s21, 14
    s_lshl_b32 s28, s21, 7
    s_add_u32 s28, s28, 26411008
    s_mov_b32 s26, 0
    v_and_b32 v85, 63, v0
    v_min_u32 v85, 31, v85
    v_lshlrev_b32 v85, 2, v85
L_poll_64:
    buffer_load_dword v84, v85, s[4:7], s28 offen sc1
    s_waitcnt vmcnt(0)
    v_cmp_ne_u32 vcc, 1, v84
    s_add_u32 s26, s26, 1
    s_nop 0
    s_cmp_eq_u64 vcc, 0
    s_cbranch_scc1 L_pollok_65
    s_cmp_ge_u32 s26, 40000
    s_cbranch_scc1 L_pollok_65
    s_sleep 6
    s_branch L_poll_64
L_pollok_65:
    ds_write_b32 v162, v163 offset:16
    s_branch L_ggo_52
L_gothers_51:
L_gspin_66:
    ds_read_b32 v84, v162 offset:16
    s_waitcnt lgkmcnt(0)
    v_readfirstlane_b32 s21, v84
    s_nop 0
    s_cmp_eq_u32 s21, 1
    s_cbranch_scc1 L_ggo_52
    s_sleep 4
    s_branch L_gspin_66
L_ggo_52:
    s_setprio 0
    buffer_load_dwordx4 v[84:87], v156, s[4:7], s32 offen sc1
    buffer_load_dwordx4 v[88:91], v156, s[4:7], s33 offen sc1
    buffer_load_dwordx4 v[92:95], v156, s[4:7], s34 offen sc1
    buffer_load_dwordx4 v[96:99], v156, s[4:7], s35 offen sc1
    buffer_load_dwordx4 v[100:103], v156, s[4:7], s36 offen sc1
    buffer_load_dwordx4 v[104:107], v156, s[4:7], s37 offen sc1
    s_add_u32 s32, s32, 1024
    s_add_u32 s33, s33, 1024
    s_add_u32 s34, s34, 1024
    s_add_u32 s35, s35, 1024
    s_add_u32 s36, s36, 1024
    s_add_u32 s37, s37, 1024
    buffer_load_dwordx4 v[108:111], v156, s[4:7], s32 offen sc1
    buffer_load_dwordx4 v[112:115], v156, s[4:7], s33 offen sc1
    buffer_load_dwordx4 v[116:119], v156, s[4:7], s34 offen sc1
    buffer_load_dwordx4 v[120:123], v156, s[4:7], s35 offen sc1
    buffer_load_dwordx4 v[124:127], v156, s[4:7], s36 offen sc1
    buffer_load_dwordx4 v[128:131], v156, s[4:7], s37 offen sc1
    s_add_u32 s32, s32, 1024
    s_add_u32 s33, s33, 1024
    s_add_u32 s34, s34, 1024
    s_add_u32 s35, s35, 1024
    s_add_u32 s36, s36, 1024
    s_add_u32 s37, s37, 1024
    buffer_load_dwordx4 v[132:135], v156, s[4:7], s32 offen sc1
    buffer_load_dwordx4 v[136:139], v156, s[4:7], s33 offen sc1
    buffer_load_dwordx4 v[140:143], v156, s[4:7], s34 offen sc1
    buffer_load_dwordx4 v[144:147], v156, s[4:7], s35 offen sc1
    buffer_load_dwordx4 v[148:151], v156, s[4:7], s36 offen sc1
    buffer_load_dwordx4 v[152:155], v156, s[4:7], s37 offen sc1
    s_add_u32 s32, s32, 1024
    s_add_u32 s33, s33, 1024
    s_add_u32 s34, s34, 1024
    s_add_u32 s35, s35, 1024
    s_add_u32 s36, s36, 1024
    s_add_u32 s37, s37, 1024
    s_waitcnt vmcnt(12)
    v_mfma_f32_32x32x16_bf16 v[4:19], v[88:91], v[84:87], 0
    v_mfma_f32_32x32x16_bf16 v[20:35], v[92:95], v[84:87], 0
    v_mfma_f32_32x32x16_bf16 v[36:51], v[96:99], v[84:87], 0
    v_mfma_f32_32x32x16_bf16 v[52:67], v[100:103], v[84:87], 0
    v_mfma_f32_32x32x16_bf16 v[68:83], v[104:107], v[84:87], 0
    buffer_load_dwordx4 v[84:87], v156, s[4:7], s32 offen sc1
    buffer_load_dwordx4 v[88:91], v156, s[4:7], s33 offen sc1
    buffer_load_dwordx4 v[92:95], v156, s[4:7], s34 offen sc1
    buffer_load_dwordx4 v[96:99], v156, s[4:7], s35 offen sc1
    buffer_load_dwordx4 v[100:103], v156, s[4:7], s36 offen sc1
    buffer_load_dwordx4 v[104:107], v156, s[4:7], s37 offen sc1
    s_add_u32 s32, s32, 1024
    s_add_u32 s33, s33, 1024
    s_add_u32 s34, s34, 1024
    s_add_u32 s35, s35, 1024
    s_add_u32 s36, s36, 1024
    s_add_u32 s37, s37, 1024
    s_waitcnt vmcnt(12)
    v_mfma_f32_32x32x16_bf16 v[4:19], v[112:115], v[108:111], v[4:19]
    v_mfma_f32_32x32x16_bf16 v[20:35], v[116:119], v[108:111], v[20:35]
    v_mfma_f32_32x32x16_bf16 v[36:51], v[120:123], v[108:111], v[36:51]
    v_mfma_f32_32x32x16_bf16 v[52:67], v[124:127], v[108:111], v[52:67]
    v_mfma_f32_32x32x16_bf16 v[68:83], v[128:131], v[108:111], v[68:83]
    buffer_load_dwordx4 v[108:111], v156, s[4:7], s32 offen sc1
    buffer_load_dwordx4 v[112:115], v156, s[4:7], s33 offen sc1
    buffer_load_dwordx4 v[116:119], v156, s[4:7], s34 offen sc1
    buffer_load_dwordx4 v[120:123], v156, s[4:7], s35 offen sc1
    buffer_load_dwordx4 v[124:127], v156, s[4:7], s36 offen sc1
    buffer_load_dwordx4 v[128:131], v156, s[4:7], s37 offen sc1
    s_add_u32 s32, s32, 1024
    s_add_u32 s33, s33, 1024
    s_add_u32 s34, s34, 1024
    s_add_u32 s35, s35, 1024
    s_add_u32 s36, s36, 1024
    s_add_u32 s37, s37, 1024
    s_waitcnt vmcnt(12)
    v_mfma_f32_32x32x16_bf16 v[4:19], v[136:139], v[132:135], v[4:19]
    v_mfma_f32_32x32x16_bf16 v[20:35], v[140:143], v[132:135], v[20:35]
    v_mfma_f32_32x32x16_bf16 v[36:51], v[144:147], v[132:135], v[36:51]
    v_mfma_f32_32x32x16_bf16 v[52:67], v[148:151], v[132:135], v[52:67]
    v_mfma_f32_32x32x16_bf16 v[68:83], v[152:155], v[132:135], v[68:83]
    buffer_load_dwordx4 v[132:135], v156, s[4:7], s32 offen sc1
    buffer_load_dwordx4 v[136:139], v156, s[4:7], s33 offen sc1
    buffer_load_dwordx4 v[140:143], v156, s[4:7], s34 offen sc1
    buffer_load_dwordx4 v[144:147], v156, s[4:7], s35 offen sc1
    buffer_load_dwordx4 v[148:151], v156, s[4:7], s36 offen sc1
    buffer_load_dwordx4 v[152:155], v156, s[4:7], s37 offen sc1
    s_add_u32 s32, s32, 1024
    s_add_u32 s33, s33, 1024
    s_add_u32 s34, s34, 1024
    s_add_u32 s35, s35, 1024
    s_add_u32 s36, s36, 1024
    s_add_u32 s37, s37, 1024
    s_mov_b32 s15, 1
L_k2g_loop:
    s_waitcnt vmcnt(12)
    v_mfma_f32_32x32x16_bf16 v[4:19], v[88:91], v[84:87], v[4:19]
    v_mfma_f32_32x32x16_bf16 v[20:35], v[92:95], v[84:87], v[20:35]
    v_mfma_f32_32x32x16_bf16 v[36:51], v[96:99], v[84:87], v[36:51]
    v_mfma_f32_32x32x16_bf16 v[52:67], v[100:103], v[84:87], v[52:67]
    v_mfma_f32_32x32x16_bf16 v[68:83], v[104:107], v[84:87], v[68:83]
    buffer_load_dwordx4 v[84:87], v156, s[4:7], s32 offen sc1
    buffer_load_dwordx4 v[88:91], v156, s[4:7], s33 offen sc1
    buffer_load_dwordx4 v[92:95], v156, s[4:7], s34 offen sc1
    buffer_load_dwordx4 v[96:99], v156, s[4:7], s35 offen sc1
    buffer_load_dwordx4 v[100:103], v156, s[4:7], s36 offen sc1
    buffer_load_dwordx4 v[104:107], v156, s[4:7], s37 offen sc1
    s_add_u32 s32, s32, 1024
    s_add_u32 s33, s33, 1024
    s_add_u32 s34, s34, 1024
    s_add_u32 s35, s35, 1024
    s_add_u32 s36, s36, 1024
    s_add_u32 s37, s37, 1024
    s_waitcnt vmcnt(12)
    v_mfma_f32_32x32x16_bf16 v[4:19], v[112:115], v[108:111], v[4:19]
    v_mfma_f32_32x32x16_bf16 v[20:35], v[116:119], v[108:111], v[20:35]
    v_mfma_f32_32x32x16_bf16 v[36:51], v[120:123], v[108:111], v[36:51]
    v_mfma_f32_32x32x16_bf16 v[52:67], v[124:127], v[108:111], v[52:67]
    v_mfma_f32_32x32x16_bf16 v[68:83], v[128:131], v[108:111], v[68:83]
    buffer_load_dwordx4 v[108:111], v156, s[4:7], s32 offen sc1
    buffer_load_dwordx4 v[112:115], v156, s[4:7], s33 offen sc1
    buffer_load_dwordx4 v[116:119], v156, s[4:7], s34 offen sc1
    buffer_load_dwordx4 v[120:123], v156, s[4:7], s35 offen sc1
    buffer_load_dwordx4 v[124:127], v156, s[4:7], s36 offen sc1
    buffer_load_dwordx4 v[128:131], v156, s[4:7], s37 offen sc1
    s_add_u32 s32, s32, 1024
    s_add_u32 s33, s33, 1024
    s_add_u32 s34, s34, 1024
    s_add_u32 s35, s35, 1024
    s_add_u32 s36, s36, 1024
    s_add_u32 s37, s37, 1024
    s_waitcnt vmcnt(12)
    v_mfma_f32_32x32x16_bf16 v[4:19], v[136:139], v[132:135], v[4:19]
    v_mfma_f32_32x32x16_bf16 v[20:35], v[140:143], v[132:135], v[20:35]
    v_mfma_f32_32x32x16_bf16 v[36:51], v[144:147], v[132:135], v[36:51]
    v_mfma_f32_32x32x16_bf16 v[52:67], v[148:151], v[132:135], v[52:67]
    v_mfma_f32_32x32x16_bf16 v[68:83], v[152:155], v[132:135], v[68:83]
    buffer_load_dwordx4 v[132:135], v156, s[4:7], s32 offen sc1
    buffer_load_dwordx4 v[136:139], v156, s[4:7], s33 offen sc1
    buffer_load_dwordx4 v[140:143], v156, s[4:7], s34 offen sc1
    buffer_load_dwordx4 v[144:147], v156, s[4:7], s35 offen sc1
    buffer_load_dwordx4 v[148:151], v156, s[4:7], s36 offen sc1
    buffer_load_dwordx4 v[152:155], v156, s[4:7], s37 offen sc1
    s_add_u32 s32, s32, 1024
    s_add_u32 s33, s33, 1024
    s_add_u32 s34, s34, 1024
    s_add_u32 s35, s35, 1024
    s_add_u32 s36, s36, 1024
    s_add_u32 s37, s37, 1024
    s_add_u32 s15, s15, 1
    s_cmp_lt_u32 s15, 8
    s_cbranch_scc1 L_k2g_loop
    s_waitcnt vmcnt(12)
    v_mfma_f32_32x32x16_bf16 v[4:19], v[88:91], v[84:87], v[4:19]
    v_mfma_f32_32x32x16_bf16 v[20:35], v[92:95], v[84:87], v[20:35]
    v_mfma_f32_32x32x16_bf16 v[36:51], v[96:99], v[84:87], v[36:51]
    v_mfma_f32_32x32x16_bf16 v[52:67], v[100:103], v[84:87], v[52:67]
    v_mfma_f32_32x32x16_bf16 v[68:83], v[104:107], v[84:87], v[68:83]
    s_waitcnt vmcnt(6)
    v_mfma_f32_32x32x16_bf16 v[4:19], v[112:115], v[108:111], v[4:19]
    v_mfma_f32_32x32x16_bf16 v[20:35], v[116:119], v[108:111], v[20:35]
    v_mfma_f32_32x32x16_bf16 v[36:51], v[120:123], v[108:111], v[36:51]
    v_mfma_f32_32x32x16_bf16 v[52:67], v[124:127], v[108:111], v[52:67]
    v_mfma_f32_32x32x16_bf16 v[68:83], v[128:131], v[108:111], v[68:83]
    s_waitcnt vmcnt(0)
    v_mfma_f32_32x32x16_bf16 v[4:19], v[136:139], v[132:135], v[4:19]
    v_mfma_f32_32x32x16_bf16 v[20:35], v[140:143], v[132:135], v[20:35]
    v_mfma_f32_32x32x16_bf16 v[36:51], v[144:147], v[132:135], v[36:51]
    v_mfma_f32_32x32x16_bf16 v[52:67], v[148:151], v[132:135], v[52:67]
    v_mfma_f32_32x32x16_bf16 v[68:83], v[152:155], v[132:135], v[68:83]
    s_waitcnt vmcnt(0)
    s_setprio 3
    s_nop 11
    s_cmp_lg_u32 s11, 0
    s_cbranch_scc1 L_k2g_w1
    ds_write_b128 v161, v[24:27] offset:15360
    ds_write_b128 v161, v[28:31] offset:16384
    ds_write_b128 v161, v[32:35] offset:17408
    ds_write_b128 v161, v[36:39] offset:18432
    ds_write_b128 v161, v[40:43] offset:19456
    ds_write_b128 v161, v[44:47] offset:30720
    ds_write_b128 v161, v[48:51] offset:31744
    ds_write_b128 v161, v[52:55] offset:32768
    ds_write_b128 v161, v[56:59] offset:33792
    ds_write_b128 v161, v[60:63] offset:34816
    ds_write_b128 v161, v[64:67] offset:46080
    ds_write_b128 v161, v[68:71] offset:47104
    ds_write_b128 v161, v[72:75] offset:48128
    ds_write_b128 v161, v[76:79] offset:49152
    ds_write_b128 v161, v[80:83] offset:50176
    s_waitcnt lgkmcnt(0)
    ds_write_b32 v162, v163 offset:0
L_gw_67:
    ds_read_b128 v[132:135], v162
    s_waitcnt lgkmcnt(0)
    v_and_b32 v132, v132, v133
    v_and_b32 v134, v134, v135
    v_and_b32 v132, v132, v134
    s_nop 0
    v_readfirstlane_b32 s21, v132
    s_nop 0
    s_cmp_eq_u32 s21, 1
    s_cbranch_scc1 L_gok_68
    s_sleep 4
    s_branch L_gw_67
L_gok_68:
    ds_read_b128 v[84:87], v161 offset:0
    ds_read_b128 v[88:91], v161 offset:1024
    ds_read_b128 v[92:95], v161 offset:2048
    ds_read_b128 v[96:99], v161 offset:3072
    ds_read_b128 v[100:103], v161 offset:4096
    ds_read_b128 v[104:107], v161 offset:5120
    ds_read_b128 v[108:111], v161 offset:6144
    ds_read_b128 v[112:115], v161 offset:7168
    ds_read_b128 v[116:119], v161 offset:8192
    ds_read_b128 v[120:123], v161 offset:9216
    ds_read_b128 v[124:127], v161 offset:10240
    ds_read_b128 v[128:131], v161 offset:11264
    ds_read_b128 v[132:135], v161 offset:12288
    ds_read_b128 v[136:139], v161 offset:13312
    ds_read_b128 v[140:143], v161 offset:14336
    v_bfe_u32 v160, v0, 4, 1
    v_mul_u32_u24 v160, 20480, v160
    v_and_b32 v162, 15, v0
    v_lshl_add_u32 v160, v162, 3, v160
    v_bfe_u32 v162, v0, 5, 1
    v_lshl_add_u32 v160, v162, 7, v160
    s_mul_i32 s21, s8, 40960
    s_mul_i32 s28, s9, 5120
    s_add_u32 s21, s21, s28
    s_add_u32 s21, s21, 23068672
    s_waitcnt lgkmcnt(0)
    v_pk_add_f32 v[4:5], v[4:5], v[84:85]
    v_pk_add_f32 v[6:7], v[6:7], v[86:87]
    v_pk_add_f32 v[8:9], v[8:9], v[88:89]
    v_pk_add_f32 v[10:11], v[10:11], v[90:91]
    v_pk_add_f32 v[12:13], v[12:13], v[92:93]
    v_pk_add_f32 v[14:15], v[14:15], v[94:95]
    v_pk_add_f32 v[16:17], v[16:17], v[96:97]
    v_pk_add_f32 v[18:19], v[18:19], v[98:99]
    v_pk_add_f32 v[20:21], v[20:21], v[100:101]
    v_pk_add_f32 v[22:23], v[22:23], v[102:103]
    v_pk_add_f32 v[4:5], v[4:5], v[104:105]
    v_pk_add_f32 v[6:7], v[6:7], v[106:107]
    v_pk_add_f32 v[8:9], v[8:9], v[108:109]
    v_pk_add_f32 v[10:11], v[10:11], v[110:111]
    v_pk_add_f32 v[12:13], v[12:13], v[112:113]
    v_pk_add_f32 v[14:15], v[14:15], v[114:115]
    v_pk_add_f32 v[16:17], v[16:17], v[116:117]
    v_pk_add_f32 v[18:19], v[18:19], v[118:119]
    v_pk_add_f32 v[20:21], v[20:21], v[120:121]
    v_pk_add_f32 v[22:23], v[22:23], v[122:123]
    v_pk_add_f32 v[4:5], v[4:5], v[124:125]
    v_pk_add_f32 v[6:7], v[6:7], v[126:127]
    v_pk_add_f32 v[8:9], v[8:9], v[128:129]
    v_pk_add_f32 v[10:11], v[10:11], v[130:131]
    v_pk_add_f32 v[12:13], v[12:13], v[132:133]
    v_pk_add_f32 v[14:15], v[14:15], v[134:135]
    v_pk_add_f32 v[16:17], v[16:17], v[136:137]
    v_pk_add_f32 v[18:19], v[18:19], v[138:139]
    v_pk_add_f32 v[20:21], v[20:21], v[140:141]
    v_pk_add_f32 v[22:23], v[22:23], v[142:143]
    v_cvt_pk_bf16_f32 v84, v4, v5
    v_cvt_pk_bf16_f32 v85, v6, v7
    v_cvt_pk_bf16_f32 v86, v8, v9
    v_cvt_pk_bf16_f32 v87, v10, v11
    v_cvt_pk_bf16_f32 v88, v12, v13
    v_cvt_pk_bf16_f32 v89, v14, v15
    v_cvt_pk_bf16_f32 v90, v16, v17
    v_cvt_pk_bf16_f32 v91, v18, v19
    v_cvt_pk_bf16_f32 v92, v20, v21
    v_cvt_pk_bf16_f32 v93, v22, v23
    s_add_u32 s28, s21, 0
    buffer_store_dwordx2 v[84:85], v160, s[4:7], s28 offen sc0 sc1
    s_add_u32 s28, s21, 256
    buffer_store_dwordx2 v[86:87], v160, s[4:7], s28 offen sc0 sc1
    s_add_u32 s28, s21, 512
    buffer_store_dwordx2 v[88:89], v160, s[4:7], s28 offen sc0 sc1
    s_add_u32 s28, s21, 768
    buffer_store_dwordx2 v[90:91], v160, s[4:7], s28 offen sc0 sc1
    s_add_u32 s28, s21, 1024
    buffer_store_dwordx2 v[92:93], v160, s[4:7], s28 offen sc0 sc1
    s_lshl_b32 s21, s2, 2
    s_add_u32 s21, s21, s11
    s_cmp_ge_u32 s21, 200
    s_cbranch_scc1 L_nowo_69
    s_setprio 0
    s_mov_b32 s40, s50
    s_mov_b32 s41, s51
    s_mov_b32 s42, 819200
    s_mov_b32 s43, 0x20000
    s_mul_i32 s44, s11, 15360
    s_add_u32 s44, s44, 98304
    v_and_b32 v90, 63, v0
    v_lshrrev_b32 v140, 3, v90
    v_mul_u32_u24 v140, 1280, v140
    v_bfe_u32 v141, v90, 4, 1
    v_lshlrev_b32 v141, 1, v141
    v_and_b32 v142, 7, v90
    v_xor_b32 v142, v142, v141
    v_lshl_add_u32 v84, v142, 4, v140
    v_xor_b32 v85, 64, v84
    s_mul_i32 s45, s21, 52429
    s_lshr_b32 s45, s45, 19
    s_mul_i32 s46, s45, 10
    s_sub_u32 s46, s21, s46
    s_mul_i32 s47, s45, 40960
    s_lshl_b32 s48, s46, 7
    s_add_u32 s47, s47, s48
    s_add_u32 m0, s44, 0
    s_add_u32 s48, s47, 0
    buffer_load_dwordx4 v84, s[40:43], s48 offen lds
    s_add_u32 m0, s44, 1024
    s_add_u32 s48, s47, 10240
    buffer_load_dwordx4 v85, s[40:43], s48 offen lds
    s_add_u32 m0, s44, 2048
    s_add_u32 s48, s47, 20480
    buffer_load_dwordx4 v84, s[40:43], s48 offen lds
    s_add_u32 m0, s44, 3072
    s_add_u32 s48, s47, 30720
    buffer_load_dwordx4 v85, s[40:43], s48 offen lds
    v_and_b32 v140, 15, v90
    v_lshrrev_b32 v141, 4, v90
    v_lshrrev_b32 v142, 2, v140
    v_lshl_add_u32 v143, v141, 3, v142
    v_lshlrev_b32 v143, 7, v143
    v_and_b32 v144, 3, v90
    v_lshl_add_u32 v143, v144, 3, v143
    v_lshrrev_b32 v142, 1, v142
    v_and_b32 v141, 1, v141
    v_lshl_or_b32 v142, v141, 1, v142
    v_add_u32 v143, s44, v143
    v_xor_b32 v144, 0, v142
    v_lshl_add_u32 v86, v144, 5, v143
    v_xor_b32 v144, 1, v142
    v_lshl_add_u32 v87, v144, 5, v143
    v_xor_b32 v144, 2, v142
    v_lshl_add_u32 v88, v144, 5, v143
    v_xor_b32 v144, 3, v142
    v_lshl_add_u32 v89, v144, 5, v143
    v_lshlrev_b32 v90, 4, v90
    s_waitcnt vmcnt(0)
    s_lshl_b32 s46, s46, 2
    s_mul_i32 s46, s46, 20
    s_add_u32 s46, s46, s45
    s_lshl_b32 s46, s46, 10
    s_add_u32 s46, s46, 18874368
    ds_read_b64_tr_b16 v[92:93], v86
    ds_read_b64_tr_b16 v[94:95], v86 offset:512
    ds_read_b64_tr_b16 v[96:97], v87
    ds_read_b64_tr_b16 v[98:99], v87 offset:512
    ds_read_b64_tr_b16 v[100:101], v88
    ds_read_b64_tr_b16 v[102:103], v88 offset:512
    ds_read_b64_tr_b16 v[104:105], v89
    ds_read_b64_tr_b16 v[106:107], v89 offset:512
    s_waitcnt lgkmcnt(0)
    buffer_store_dwordx4 v[92:95], v90, s[4:7], s46 offen sc0 sc1
    s_add_u32 s46, s46, 20480
    buffer_store_dwordx4 v[96:99], v90, s[4:7], s46 offen sc0 sc1
    s_add_u32 s46, s46, 20480
    buffer_store_dwordx4 v[100:103], v90, s[4:7], s46 offen sc0 sc1
    s_add_u32 s46, s46, 20480
    buffer_store_dwordx4 v[104:107], v90, s[4:7], s46 offen sc0 sc1
    s_add_u32 s46, s46, 20480
L_nowo_69:
    s_waitcnt vmcnt(0) lgkmcnt(0)
    s_endpgm
L_k2g_w1:
    s_cmp_lg_u32 s11, 1
    s_cbranch_scc1 L_k2g_w2
    ds_write_b128 v161, v[4:7] offset:0
    ds_write_b128 v161, v[8:11] offset:1024
    ds_write_b128 v161, v[12:15] offset:2048
    ds_write_b128 v161, v[16:19] offset:3072
    ds_write_b128 v161, v[20:23] offset:4096
    ds_write_b128 v161, v[44:47] offset:35840
    ds_write_b128 v161, v[48:51] offset:36864
    ds_write_b128 v161, v[52:55] offset:37888
    ds_write_b128 v161, v[56:59] offset:38912
    ds_write_b128 v161, v[60:63] offset:39936
    ds_write_b128 v161, v[64:67] offset:51200
    ds_write_b128 v161, v[68:71] offset:52224
    ds_write_b128 v161, v[72:75] offset:53248
    ds_write_b128 v161, v[76:79] offset:54272
    ds_write_b128 v161, v[80:83] offset:55296
    s_waitcnt lgkmcnt(0)
    ds_write_b32 v162, v163 offset:4
L_gw_70:
    ds_read_b128 v[132:135], v162
    s_waitcnt lgkmcnt(0)
    v_and_b32 v132, v132, v133
    v_and_b32 v134, v134, v135
    v_and_b32 v132, v132, v134
    s_nop 0
    v_readfirstlane_b32 s21, v132
    s_nop 0
    s_cmp_eq_u32 s21, 1
    s_cbranch_scc1 L_gok_71
    s_sleep 4
    s_branch L_gw_70
L_gok_71:
    ds_read_b128 v[84:87], v161 offset:15360
    ds_read_b128 v[88:91], v161 offset:16384
    ds_read_b128 v[92:95], v161 offset:17408
    ds_read_b128 v[96:99], v161 offset:18432
    ds_read_b128 v[100:103], v161 offset:19456
    ds_read_b128 v[104:107], v161 offset:20480
    ds_read_b128 v[108:111], v161 offset:21504
    ds_read_b128 v[112:115], v161 offset:22528
    ds_read_b128 v[116:119], v161 offset:23552
    ds_read_b128 v[120:123], v161 offset:24576
    ds_read_b128 v[124:127], v161 offset:25600
    ds_read_b128 v[128:131], v161 offset:26624
    ds_read_b128 v[132:135], v161 offset:27648
    ds_read_b128 v[136:139], v161 offset:28672
    ds_read_b128 v[140:143], v161 offset:29696
    v_bfe_u32 v160, v0, 4, 1
    v_mul_u32_u24 v160, 20480, v160
    v_and_b32 v162, 15, v0
    v_lshl_add_u32 v160, v162, 3, v160
    v_bfe_u32 v162, v0, 5, 1
    v_lshl_add_u32 v160, v162, 7, v160
    s_mul_i32 s21, s8, 40960
    s_mul_i32 s28, s9, 5120
    s_add_u32 s21, s21, s28
    s_add_u32 s21, s21, 23068672
    s_waitcnt lgkmcnt(0)
    v_pk_add_f32 v[24:25], v[24:25], v[84:85]
    v_pk_add_f32 v[26:27], v[26:27], v[86:87]
    v_pk_add_f32 v[28:29], v[28:29], v[88:89]
    v_pk_add_f32 v[30:31], v[30:31], v[90:91]
    v_pk_add_f32 v[32:33], v[32:33], v[92:93]
    v_pk_add_f32 v[34:35], v[34:35], v[94:95]
    v_pk_add_f32 v[36:37], v[36:37], v[96:97]
    v_pk_add_f32 v[38:39], v[38:39], v[98:99]
    v_pk_add_f32 v[40:41], v[40:41], v[100:101]
    v_pk_add_f32 v[42:43], v[42:43], v[102:103]
    v_pk_add_f32 v[24:25], v[24:25], v[104:105]
    v_pk_add_f32 v[26:27], v[26:27], v[106:107]
    v_pk_add_f32 v[28:29], v[28:29], v[108:109]
    v_pk_add_f32 v[30:31], v[30:31], v[110:111]
    v_pk_add_f32 v[32:33], v[32:33], v[112:113]
    v_pk_add_f32 v[34:35], v[34:35], v[114:115]
    v_pk_add_f32 v[36:37], v[36:37], v[116:117]
    v_pk_add_f32 v[38:39], v[38:39], v[118:119]
    v_pk_add_f32 v[40:41], v[40:41], v[120:121]
    v_pk_add_f32 v[42:43], v[42:43], v[122:123]
    v_pk_add_f32 v[24:25], v[24:25], v[124:125]
    v_pk_add_f32 v[26:27], v[26:27], v[126:127]
    v_pk_add_f32 v[28:29], v[28:29], v[128:129]
    v_pk_add_f32 v[30:31], v[30:31], v[130:131]
    v_pk_add_f32 v[32:33], v[32:33], v[132:133]
    v_pk_add_f32 v[34:35], v[34:35], v[134:135]
    v_pk_add_f32 v[36:37], v[36:37], v[136:137]
    v_pk_add_f32 v[38:39], v[38:39], v[138:139]
    v_pk_add_f32 v[40:41], v[40:41], v[140:141]
    v_pk_add_f32 v[42:43], v[42:43], v[142:143]
    v_cvt_pk_bf16_f32 v84, v24, v25
    v_cvt_pk_bf16_f32 v85, v26, v27
    v_cvt_pk_bf16_f32 v86, v28, v29
    v_cvt_pk_bf16_f32 v87, v30, v31
    v_cvt_pk_bf16_f32 v88, v32, v33
    v_cvt_pk_bf16_f32 v89, v34, v35
    v_cvt_pk_bf16_f32 v90, v36, v37
    v_cvt_pk_bf16_f32 v91, v38, v39
    v_cvt_pk_bf16_f32 v92, v40, v41
    v_cvt_pk_bf16_f32 v93, v42, v43
    s_add_u32 s28, s21, 1280
    buffer_store_dwordx2 v[84:85], v160, s[4:7], s28 offen sc0 sc1
    s_add_u32 s28, s21, 1536
    buffer_store_dwordx2 v[86:87], v160, s[4:7], s28 offen sc0 sc1
    s_add_u32 s28, s21, 1792
    buffer_store_dwordx2 v[88:89], v160, s[4:7], s28 offen sc0 sc1
    s_add_u32 s28, s21, 2048
    buffer_store_dwordx2 v[90:91], v160, s[4:7], s28 offen sc0 sc1
    s_add_u32 s28, s21, 2304
    buffer_store_dwordx2 v[92:93], v160, s[4:7], s28 offen sc0 sc1
    s_lshl_b32 s21, s2, 2
    s_add_u32 s21, s21, s11
    s_cmp_ge_u32 s21, 200
    s_cbranch_scc1 L_nowo_72
    s_setprio 0
    s_mov_b32 s40, s50
    s_mov_b32 s41, s51
    s_mov_b32 s42, 819200
    s_mov_b32 s43, 0x20000
    s_mul_i32 s44, s11, 15360
    s_add_u32 s44, s44, 98304
    v_and_b32 v90, 63, v0
    v_lshrrev_b32 v140, 3, v90
    v_mul_u32_u24 v140, 1280, v140
    v_bfe_u32 v141, v90, 4, 1
    v_lshlrev_b32 v141, 1, v141
    v_and_b32 v142, 7, v90
    v_xor_b32 v142, v142, v141
    v_lshl_add_u32 v84, v142, 4, v140
    v_xor_b32 v85, 64, v84
    s_mul_i32 s45, s21, 52429
    s_lshr_b32 s45, s45, 19
    s_mul_i32 s46, s45, 10
    s_sub_u32 s46, s21, s46
    s_mul_i32 s47, s45, 40960
    s_lshl_b32 s48, s46, 7
    s_add_u32 s47, s47, s48
    s_add_u32 m0, s44, 0
    s_add_u32 s48, s47, 0
    buffer_load_dwordx4 v84, s[40:43], s48 offen lds
    s_add_u32 m0, s44, 1024
    s_add_u32 s48, s47, 10240
    buffer_load_dwordx4 v85, s[40:43], s48 offen lds
    s_add_u32 m0, s44, 2048
    s_add_u32 s48, s47, 20480
    buffer_load_dwordx4 v84, s[40:43], s48 offen lds
    s_add_u32 m0, s44, 3072
    s_add_u32 s48, s47, 30720
    buffer_load_dwordx4 v85, s[40:43], s48 offen lds
    v_and_b32 v140, 15, v90
    v_lshrrev_b32 v141, 4, v90
    v_lshrrev_b32 v142, 2, v140
    v_lshl_add_u32 v143, v141, 3, v142
    v_lshlrev_b32 v143, 7, v143
    v_and_b32 v144, 3, v90
    v_lshl_add_u32 v143, v144, 3, v143
    v_lshrrev_b32 v142, 1, v142
    v_and_b32 v141, 1, v141
    v_lshl_or_b32 v142, v141, 1, v142
    v_add_u32 v143, s44, v143
    v_xor_b32 v144, 0, v142
    v_lshl_add_u32 v86, v144, 5, v143
    v_xor_b32 v144, 1, v142
    v_lshl_add_u32 v87, v144, 5, v143
    v_xor_b32 v144, 2, v142
    v_lshl_add_u32 v88, v144, 5, v143
    v_xor_b32 v144, 3, v142
    v_lshl_add_u32 v89, v144, 5, v143
    v_lshlrev_b32 v90, 4, v90
    s_waitcnt vmcnt(0)
    s_lshl_b32 s46, s46, 2
    s_mul_i32 s46, s46, 20
    s_add_u32 s46, s46, s45
    s_lshl_b32 s46, s46, 10
    s_add_u32 s46, s46, 18874368
    ds_read_b64_tr_b16 v[92:93], v86
    ds_read_b64_tr_b16 v[94:95], v86 offset:512
    ds_read_b64_tr_b16 v[96:97], v87
    ds_read_b64_tr_b16 v[98:99], v87 offset:512
    ds_read_b64_tr_b16 v[100:101], v88
    ds_read_b64_tr_b16 v[102:103], v88 offset:512
    ds_read_b64_tr_b16 v[104:105], v89
    ds_read_b64_tr_b16 v[106:107], v89 offset:512
    s_waitcnt lgkmcnt(0)
    buffer_store_dwordx4 v[92:95], v90, s[4:7], s46 offen sc0 sc1
    s_add_u32 s46, s46, 20480
    buffer_store_dwordx4 v[96:99], v90, s[4:7], s46 offen sc0 sc1
    s_add_u32 s46, s46, 20480
    buffer_store_dwordx4 v[100:103], v90, s[4:7], s46 offen sc0 sc1
    s_add_u32 s46, s46, 20480
    buffer_store_dwordx4 v[104:107], v90, s[4:7], s46 offen sc0 sc1
    s_add_u32 s46, s46, 20480
L_nowo_72:
    s_waitcnt vmcnt(0) lgkmcnt(0)
    s_endpgm
L_k2g_w2:
    s_cmp_lg_u32 s11, 2
    s_cbranch_scc1 L_k2g_w3
    ds_write_b128 v161, v[4:7] offset:5120
    ds_write_b128 v161, v[8:11] offset:6144
    ds_write_b128 v161, v[12:15] offset:7168
    ds_write_b128 v161, v[16:19] offset:8192
    ds_write_b128 v161, v[20:23] offset:9216
    ds_write_b128 v161, v[24:27] offset:20480
    ds_write_b128 v161, v[28:31] offset:21504
    ds_write_b128 v161, v[32:35] offset:22528
    ds_write_b128 v161, v[36:39] offset:23552
    ds_write_b128 v161, v[40:43] offset:24576
    ds_write_b128 v161, v[64:67] offset:56320
    ds_write_b128 v161, v[68:71] offset:57344
    ds_write_b128 v161, v[72:75] offset:58368
    ds_write_b128 v161, v[76:79] offset:59392
    ds_write_b128 v161, v[80:83] offset:60416
    s_waitcnt lgkmcnt(0)
    ds_write_b32 v162, v163 offset:8
L_gw_73:
    ds_read_b128 v[132:135], v162
    s_waitcnt lgkmcnt(0)
    v_and_b32 v132, v132, v133
    v_and_b32 v134, v134, v135
    v_and_b32 v132, v132, v134
    s_nop 0
    v_readfirstlane_b32 s21, v132
    s_nop 0
    s_cmp_eq_u32 s21, 1
    s_cbranch_scc1 L_gok_74
    s_sleep 4
    s_branch L_gw_73
L_gok_74:
    ds_read_b128 v[84:87], v161 offset:30720
    ds_read_b128 v[88:91], v161 offset:31744
    ds_read_b128 v[92:95], v161 offset:32768
    ds_read_b128 v[96:99], v161 offset:33792
    ds_read_b128 v[100:103], v161 offset:34816
    ds_read_b128 v[104:107], v161 offset:35840
    ds_read_b128 v[108:111], v161 offset:36864
    ds_read_b128 v[112:115], v161 offset:37888
    ds_read_b128 v[116:119], v161 offset:38912
    ds_read_b128 v[120:123], v161 offset:39936
    ds_read_b128 v[124:127], v161 offset:40960
    ds_read_b128 v[128:131], v161 offset:41984
    ds_read_b128 v[132:135], v161 offset:43008
    ds_read_b128 v[136:139], v161 offset:44032
    ds_read_b128 v[140:143], v161 offset:45056
    v_bfe_u32 v160, v0, 4, 1
    v_mul_u32_u24 v160, 20480, v160
    v_and_b32 v162, 15, v0
    v_lshl_add_u32 v160, v162, 3, v160
    v_bfe_u32 v162, v0, 5, 1
    v_lshl_add_u32 v160, v162, 7, v160
    s_mul_i32 s21, s8, 40960
    s_mul_i32 s28, s9, 5120
    s_add_u32 s21, s21, s28
    s_add_u32 s21, s21, 23068672
    s_waitcnt lgkmcnt(0)
    v_pk_add_f32 v[44:45], v[44:45], v[84:85]
    v_pk_add_f32 v[46:47], v[46:47], v[86:87]
    v_pk_add_f32 v[48:49], v[48:49], v[88:89]
    v_pk_add_f32 v[50:51], v[50:51], v[90:91]
    v_pk_add_f32 v[52:53], v[52:53], v[92:93]
    v_pk_add_f32 v[54:55], v[54:55], v[94:95]
    v_pk_add_f32 v[56:57], v[56:57], v[96:97]
    v_pk_add_f32 v[58:59], v[58:59], v[98:99]
    v_pk_add_f32 v[60:61], v[60:61], v[100:101]
    v_pk_add_f32 v[62:63], v[62:63], v[102:103]
    v_pk_add_f32 v[44:45], v[44:45], v[104:105]
    v_pk_add_f32 v[46:47], v[46:47], v[106:107]
    v_pk_add_f32 v[48:49], v[48:49], v[108:109]
    v_pk_add_f32 v[50:51], v[50:51], v[110:111]
    v_pk_add_f32 v[52:53], v[52:53], v[112:113]
    v_pk_add_f32 v[54:55], v[54:55], v[114:115]
    v_pk_add_f32 v[56:57], v[56:57], v[116:117]
    v_pk_add_f32 v[58:59], v[58:59], v[118:119]
    v_pk_add_f32 v[60:61], v[60:61], v[120:121]
    v_pk_add_f32 v[62:63], v[62:63], v[122:123]
    v_pk_add_f32 v[44:45], v[44:45], v[124:125]
    v_pk_add_f32 v[46:47], v[46:47], v[126:127]
    v_pk_add_f32 v[48:49], v[48:49], v[128:129]
    v_pk_add_f32 v[50:51], v[50:51], v[130:131]
    v_pk_add_f32 v[52:53], v[52:53], v[132:133]
    v_pk_add_f32 v[54:55], v[54:55], v[134:135]
    v_pk_add_f32 v[56:57], v[56:57], v[136:137]
    v_pk_add_f32 v[58:59], v[58:59], v[138:139]
    v_pk_add_f32 v[60:61], v[60:61], v[140:141]
    v_pk_add_f32 v[62:63], v[62:63], v[142:143]
    v_cvt_pk_bf16_f32 v84, v44, v45
    v_cvt_pk_bf16_f32 v85, v46, v47
    v_cvt_pk_bf16_f32 v86, v48, v49
    v_cvt_pk_bf16_f32 v87, v50, v51
    v_cvt_pk_bf16_f32 v88, v52, v53
    v_cvt_pk_bf16_f32 v89, v54, v55
    v_cvt_pk_bf16_f32 v90, v56, v57
    v_cvt_pk_bf16_f32 v91, v58, v59
    v_cvt_pk_bf16_f32 v92, v60, v61
    v_cvt_pk_bf16_f32 v93, v62, v63
    s_add_u32 s28, s21, 2560
    buffer_store_dwordx2 v[84:85], v160, s[4:7], s28 offen sc0 sc1
    s_add_u32 s28, s21, 2816
    buffer_store_dwordx2 v[86:87], v160, s[4:7], s28 offen sc0 sc1
    s_add_u32 s28, s21, 3072
    buffer_store_dwordx2 v[88:89], v160, s[4:7], s28 offen sc0 sc1
    s_add_u32 s28, s21, 3328
    buffer_store_dwordx2 v[90:91], v160, s[4:7], s28 offen sc0 sc1
    s_add_u32 s28, s21, 3584
    buffer_store_dwordx2 v[92:93], v160, s[4:7], s28 offen sc0 sc1
    s_lshl_b32 s21, s2, 2
    s_add_u32 s21, s21, s11
    s_cmp_ge_u32 s21, 200
    s_cbranch_scc1 L_nowo_75
    s_setprio 0
    s_mov_b32 s40, s50
    s_mov_b32 s41, s51
    s_mov_b32 s42, 819200
    s_mov_b32 s43, 0x20000
    s_mul_i32 s44, s11, 15360
    s_add_u32 s44, s44, 98304
    v_and_b32 v90, 63, v0
    v_lshrrev_b32 v140, 3, v90
    v_mul_u32_u24 v140, 1280, v140
    v_bfe_u32 v141, v90, 4, 1
    v_lshlrev_b32 v141, 1, v141
    v_and_b32 v142, 7, v90
    v_xor_b32 v142, v142, v141
    v_lshl_add_u32 v84, v142, 4, v140
    v_xor_b32 v85, 64, v84
    s_mul_i32 s45, s21, 52429
    s_lshr_b32 s45, s45, 19
    s_mul_i32 s46, s45, 10
    s_sub_u32 s46, s21, s46
    s_mul_i32 s47, s45, 40960
    s_lshl_b32 s48, s46, 7
    s_add_u32 s47, s47, s48
    s_add_u32 m0, s44, 0
    s_add_u32 s48, s47, 0
    buffer_load_dwordx4 v84, s[40:43], s48 offen lds
    s_add_u32 m0, s44, 1024
    s_add_u32 s48, s47, 10240
    buffer_load_dwordx4 v85, s[40:43], s48 offen lds
    s_add_u32 m0, s44, 2048
    s_add_u32 s48, s47, 20480
    buffer_load_dwordx4 v84, s[40:43], s48 offen lds
    s_add_u32 m0, s44, 3072
    s_add_u32 s48, s47, 30720
    buffer_load_dwordx4 v85, s[40:43], s48 offen lds
    v_and_b32 v140, 15, v90
    v_lshrrev_b32 v141, 4, v90
    v_lshrrev_b32 v142, 2, v140
    v_lshl_add_u32 v143, v141, 3, v142
    v_lshlrev_b32 v143, 7, v143
    v_and_b32 v144, 3, v90
    v_lshl_add_u32 v143, v144, 3, v143
    v_lshrrev_b32 v142, 1, v142
    v_and_b32 v141, 1, v141
    v_lshl_or_b32 v142, v141, 1, v142
    v_add_u32 v143, s44, v143
    v_xor_b32 v144, 0, v142
    v_lshl_add_u32 v86, v144, 5, v143
    v_xor_b32 v144, 1, v142
    v_lshl_add_u32 v87, v144, 5, v143
    v_xor_b32 v144, 2, v142
    v_lshl_add_u32 v88, v144, 5, v143
    v_xor_b32 v144, 3, v142
    v_lshl_add_u32 v89, v144, 5, v143
    v_lshlrev_b32 v90, 4, v90
    s_waitcnt vmcnt(0)
    s_lshl_b32 s46, s46, 2
    s_mul_i32 s46, s46, 20
    s_add_u32 s46, s46, s45
    s_lshl_b32 s46, s46, 10
    s_add_u32 s46, s46, 18874368
    ds_read_b64_tr_b16 v[92:93], v86
    ds_read_b64_tr_b16 v[94:95], v86 offset:512
    ds_read_b64_tr_b16 v[96:97], v87
    ds_read_b64_tr_b16 v[98:99], v87 offset:512
    ds_read_b64_tr_b16 v[100:101], v88
    ds_read_b64_tr_b16 v[102:103], v88 offset:512
    ds_read_b64_tr_b16 v[104:105], v89
    ds_read_b64_tr_b16 v[106:107], v89 offset:512
    s_waitcnt lgkmcnt(0)
    buffer_store_dwordx4 v[92:95], v90, s[4:7], s46 offen sc0 sc1
    s_add_u32 s46, s46, 20480
    buffer_store_dwordx4 v[96:99], v90, s[4:7], s46 offen sc0 sc1
    s_add_u32 s46, s46, 20480
    buffer_store_dwordx4 v[100:103], v90, s[4:7], s46 offen sc0 sc1
    s_add_u32 s46, s46, 20480
    buffer_store_dwordx4 v[104:107], v90, s[4:7], s46 offen sc0 sc1
    s_add_u32 s46, s46, 20480
L_nowo_75:
    s_waitcnt vmcnt(0) lgkmcnt(0)
    s_endpgm
L_k2g_w3:
    ds_write_b128 v161, v[4:7] offset:10240
    ds_write_b128 v161, v[8:11] offset:11264
    ds_write_b128 v161, v[12:15] offset:12288
    ds_write_b128 v161, v[16:19] offset:13312
    ds_write_b128 v161, v[20:23] offset:14336
    ds_write_b128 v161, v[24:27] offset:25600
    ds_write_b128 v161, v[28:31] offset:26624
    ds_write_b128 v161, v[32:35] offset:27648
    ds_write_b128 v161, v[36:39] offset:28672
    ds_write_b128 v161, v[40:43] offset:29696
    ds_write_b128 v161, v[44:47] offset:40960
    ds_write_b128 v161, v[48:51] offset:41984
    ds_write_b128 v161, v[52:55] offset:43008
    ds_write_b128 v161, v[56:59] offset:44032
    ds_write_b128 v161, v[60:63] offset:45056
    s_waitcnt lgkmcnt(0)
    ds_write_b32 v162, v163 offset:12
L_gw_76:
    ds_read_b128 v[132:135], v162
    s_waitcnt lgkmcnt(0)
    v_and_b32 v132, v132, v133
    v_and_b32 v134, v134, v135
    v_and_b32 v132, v132, v134
    s_nop 0
    v_readfirstlane_b32 s21, v132
    s_nop 0
    s_cmp_eq_u32 s21, 1
    s_cbranch_scc1 L_gok_77
    s_sleep 4
    s_branch L_gw_76
L_gok_77:
    ds_read_b128 v[84:87], v161 offset:46080
    ds_read_b128 v[88:91], v161 offset:47104
    ds_read_b128 v[92:95], v161 offset:48128
    ds_read_b128 v[96:99], v161 offset:49152
    ds_read_b128 v[100:103], v161 offset:50176
    ds_read_b128 v[104:107], v161 offset:51200
    ds_read_b128 v[108:111], v161 offset:52224
    ds_read_b128 v[112:115], v161 offset:53248
    ds_read_b128 v[116:119], v161 offset:54272
    ds_read_b128 v[120:123], v161 offset:55296
    ds_read_b128 v[124:127], v161 offset:56320
    ds_read_b128 v[128:131], v161 offset:57344
    ds_read_b128 v[132:135], v161 offset:58368
    ds_read_b128 v[136:139], v161 offset:59392
    ds_read_b128 v[140:143], v161 offset:60416
    v_bfe_u32 v160, v0, 4, 1
    v_mul_u32_u24 v160, 20480, v160
    v_and_b32 v162, 15, v0
    v_lshl_add_u32 v160, v162, 3, v160
    v_bfe_u32 v162, v0, 5, 1
    v_lshl_add_u32 v160, v162, 7, v160
    s_mul_i32 s21, s8, 40960
    s_mul_i32 s28, s9, 5120
    s_add_u32 s21, s21, s28
    s_add_u32 s21, s21, 23068672
    s_waitcnt lgkmcnt(0)
    v_pk_add_f32 v[64:65], v[64:65], v[84:85]
    v_pk_add_f32 v[66:67], v[66:67], v[86:87]
    v_pk_add_f32 v[68:69], v[68:69], v[88:89]
    v_pk_add_f32 v[70:71], v[70:71], v[90:91]
    v_pk_add_f32 v[72:73], v[72:73], v[92:93]
    v_pk_add_f32 v[74:75], v[74:75], v[94:95]
    v_pk_add_f32 v[76:77], v[76:77], v[96:97]
    v_pk_add_f32 v[78:79], v[78:79], v[98:99]
    v_pk_add_f32 v[80:81], v[80:81], v[100:101]
    v_pk_add_f32 v[82:83], v[82:83], v[102:103]
    v_pk_add_f32 v[64:65], v[64:65], v[104:105]
    v_pk_add_f32 v[66:67], v[66:67], v[106:107]
    v_pk_add_f32 v[68:69], v[68:69], v[108:109]
    v_pk_add_f32 v[70:71], v[70:71], v[110:111]
    v_pk_add_f32 v[72:73], v[72:73], v[112:113]
    v_pk_add_f32 v[74:75], v[74:75], v[114:115]
    v_pk_add_f32 v[76:77], v[76:77], v[116:117]
    v_pk_add_f32 v[78:79], v[78:79], v[118:119]
    v_pk_add_f32 v[80:81], v[80:81], v[120:121]
    v_pk_add_f32 v[82:83], v[82:83], v[122:123]
    v_pk_add_f32 v[64:65], v[64:65], v[124:125]
    v_pk_add_f32 v[66:67], v[66:67], v[126:127]
    v_pk_add_f32 v[68:69], v[68:69], v[128:129]
    v_pk_add_f32 v[70:71], v[70:71], v[130:131]
    v_pk_add_f32 v[72:73], v[72:73], v[132:133]
    v_pk_add_f32 v[74:75], v[74:75], v[134:135]
    v_pk_add_f32 v[76:77], v[76:77], v[136:137]
    v_pk_add_f32 v[78:79], v[78:79], v[138:139]
    v_pk_add_f32 v[80:81], v[80:81], v[140:141]
    v_pk_add_f32 v[82:83], v[82:83], v[142:143]
    v_cvt_pk_bf16_f32 v84, v64, v65
    v_cvt_pk_bf16_f32 v85, v66, v67
    v_cvt_pk_bf16_f32 v86, v68, v69
    v_cvt_pk_bf16_f32 v87, v70, v71
    v_cvt_pk_bf16_f32 v88, v72, v73
    v_cvt_pk_bf16_f32 v89, v74, v75
    v_cvt_pk_bf16_f32 v90, v76, v77
    v_cvt_pk_bf16_f32 v91, v78, v79
    v_cvt_pk_bf16_f32 v92, v80, v81
    v_cvt_pk_bf16_f32 v93, v82, v83
    s_add_u32 s28, s21, 3840
    buffer_store_dwordx2 v[84:85], v160, s[4:7], s28 offen sc0 sc1
    s_add_u32 s28, s21, 4096
    buffer_store_dwordx2 v[86:87], v160, s[4:7], s28 offen sc0 sc1
    s_add_u32 s28, s21, 4352
    buffer_store_dwordx2 v[88:89], v160, s[4:7], s28 offen sc0 sc1
    s_add_u32 s28, s21, 4608
    buffer_store_dwordx2 v[90:91], v160, s[4:7], s28 offen sc0 sc1
    s_add_u32 s28, s21, 4864
    buffer_store_dwordx2 v[92:93], v160, s[4:7], s28 offen sc0 sc1
    s_lshl_b32 s21, s2, 2
    s_add_u32 s21, s21, s11
    s_cmp_ge_u32 s21, 200
    s_cbranch_scc1 L_nowo_78
    s_setprio 0
    s_mov_b32 s40, s50
    s_mov_b32 s41, s51
    s_mov_b32 s42, 819200
    s_mov_b32 s43, 0x20000
    s_mul_i32 s44, s11, 15360
    s_add_u32 s44, s44, 98304
    v_and_b32 v90, 63, v0
    v_lshrrev_b32 v140, 3, v90
    v_mul_u32_u24 v140, 1280, v140
    v_bfe_u32 v141, v90, 4, 1
    v_lshlrev_b32 v141, 1, v141
    v_and_b32 v142, 7, v90
    v_xor_b32 v142, v142, v141
    v_lshl_add_u32 v84, v142, 4, v140
    v_xor_b32 v85, 64, v84
    s_mul_i32 s45, s21, 52429
    s_lshr_b32 s45, s45, 19
    s_mul_i32 s46, s45, 10
    s_sub_u32 s46, s21, s46
    s_mul_i32 s47, s45, 40960
    s_lshl_b32 s48, s46, 7
    s_add_u32 s47, s47, s48
    s_add_u32 m0, s44, 0
    s_add_u32 s48, s47, 0
    buffer_load_dwordx4 v84, s[40:43], s48 offen lds
    s_add_u32 m0, s44, 1024
    s_add_u32 s48, s47, 10240
    buffer_load_dwordx4 v85, s[40:43], s48 offen lds
    s_add_u32 m0, s44, 2048
    s_add_u32 s48, s47, 20480
    buffer_load_dwordx4 v84, s[40:43], s48 offen lds
    s_add_u32 m0, s44, 3072
    s_add_u32 s48, s47, 30720
    buffer_load_dwordx4 v85, s[40:43], s48 offen lds
    v_and_b32 v140, 15, v90
    v_lshrrev_b32 v141, 4, v90
    v_lshrrev_b32 v142, 2, v140
    v_lshl_add_u32 v143, v141, 3, v142
    v_lshlrev_b32 v143, 7, v143
    v_and_b32 v144, 3, v90
    v_lshl_add_u32 v143, v144, 3, v143
    v_lshrrev_b32 v142, 1, v142
    v_and_b32 v141, 1, v141
    v_lshl_or_b32 v142, v141, 1, v142
    v_add_u32 v143, s44, v143
    v_xor_b32 v144, 0, v142
    v_lshl_add_u32 v86, v144, 5, v143
    v_xor_b32 v144, 1, v142
    v_lshl_add_u32 v87, v144, 5, v143
    v_xor_b32 v144, 2, v142
    v_lshl_add_u32 v88, v144, 5, v143
    v_xor_b32 v144, 3, v142
    v_lshl_add_u32 v89, v144, 5, v143
    v_lshlrev_b32 v90, 4, v90
    s_waitcnt vmcnt(0)
    s_lshl_b32 s46, s46, 2
    s_mul_i32 s46, s46, 20
    s_add_u32 s46, s46, s45
    s_lshl_b32 s46, s46, 10
    s_add_u32 s46, s46, 18874368
    ds_read_b64_tr_b16 v[92:93], v86
    ds_read_b64_tr_b16 v[94:95], v86 offset:512
    ds_read_b64_tr_b16 v[96:97], v87
    ds_read_b64_tr_b16 v[98:99], v87 offset:512
    ds_read_b64_tr_b16 v[100:101], v88
    ds_read_b64_tr_b16 v[102:103], v88 offset:512
    ds_read_b64_tr_b16 v[104:105], v89
    ds_read_b64_tr_b16 v[106:107], v89 offset:512
    s_waitcnt lgkmcnt(0)
    buffer_store_dwordx4 v[92:95], v90, s[4:7], s46 offen sc0 sc1
    s_add_u32 s46, s46, 20480
    buffer_store_dwordx4 v[96:99], v90, s[4:7], s46 offen sc0 sc1
    s_add_u32 s46, s46, 20480
    buffer_store_dwordx4 v[100:103], v90, s[4:7], s46 offen sc0 sc1
    s_add_u32 s46, s46, 20480
    buffer_store_dwordx4 v[104:107], v90, s[4:7], s46 offen sc0 sc1
    s_add_u32 s46, s46, 20480
L_nowo_78:
    s_waitcnt vmcnt(0) lgkmcnt(0)
    s_endpgm
L_k12_end:
    s_endpgm
L_k1_codeend:
.globl k3_kernel
.p2align 8
.type k3_kernel,@function
k3_kernel:
    s_cmp_ge_u32 s2, 256
    s_cbranch_scc1 L_k3_end
    s_load_dwordx2 s[4:5], s[0:1], 72
    s_load_dwordx2 s[8:9], s[0:1], 0
    s_load_dwordx2 s[12:13], s[0:1], 56
    v_and_b32 v229, 63, v0
    v_lshrrev_b32 v1, 6, v0
    v_lshlrev_b32 v228, 4, v229
    v_readfirstlane_b32 s16, v1
    s_nop 0
    s_cmp_lg_u32 s16, 3
    s_cbranch_scc1 L_nopf_79
    s_getpc_b64 s[40:41]
L_pc_80:
    s_sub_u32 s40, s40, L_pc_80 - k3_kernel
    s_subb_u32 s41, s41, 0
    v_lshlrev_b32 v2, 7, v229
    v_min_u32 v231, L_k3_codeend - k3_kernel - 4, v2
    global_load_dword v230, v231, s[40:41]
L_nopf_79:
    s_and_b32 s30, s2, 7
    s_lshl_b32 s17, s30, 2
    s_bfe_u32 s30, s2, 0x20003
    s_add_u32 s17, s17, s30
    s_lshr_b32 s18, s2, 5
    s_mov_b32 s6, 0x2000000
    s_mov_b32 s7, 0x20000
    s_mov_b32 s10, 2621440
    s_mov_b32 s11, 0x20000
    s_mov_b32 s14, 2621440
    s_mov_b32 s15, 0x20000
    s_mul_i32 s30, s16, 5
    s_mul_i32 s31, s17, 80
    s_add_u32 s31, s31, s30
    s_lshl_b32 s31, s31, 10
    s_add_u32 s20, s31, 15728640
    s_mul_i32 s31, s18, 100
    s_add_u32 s31, s31, s30
    s_lshl_b32 s31, s31, 10
    s_add_u32 s24, s31, 18874368
    s_add_u32 s21, s20, 20480
    s_add_u32 s22, s21, 20480
    s_add_u32 s23, s22, 20480
    s_add_u32 s25, s24, 20480
    s_add_u32 s26, s25, 20480
    s_add_u32 s27, s26, 20480
    s_add_u32 s28, s27, 20480
    s_waitcnt lgkmcnt(0)
    v_add_u32 v255, 4096, v228
    buffer_load_dwordx4 v[84:87], v228, s[4:7], s20 offen offset:0
    buffer_load_dwordx4 v[88:91], v228, s[4:7], s21 offen offset:0
    buffer_load_dwordx4 v[92:95], v228, s[4:7], s22 offen offset:0
    buffer_load_dwordx4 v[96:99], v228, s[4:7], s23 offen offset:0
    buffer_load_dwordx4 v[100:103], v228, s[4:7], s24 offen offset:0
    buffer_load_dwordx4 v[104:107], v228, s[4:7], s25 offen offset:0
    buffer_load_dwordx4 v[108:111], v228, s[4:7], s26 offen offset:0
    buffer_load_dwordx4 v[112:115], v228, s[4:7], s27 offen offset:0
    buffer_load_dwordx4 v[116:119], v228, s[4:7], s28 offen offset:0
    buffer_load_dwordx4 v[120:123], v228, s[4:7], s20 offen offset:1024
    buffer_load_dwordx4 v[124:127], v228, s[4:7], s21 offen offset:1024
    buffer_load_dwordx4 v[128:131], v228, s[4:7], s22 offen offset:1024
    buffer_load_dwordx4 v[132:135], v228, s[4:7], s23 offen offset:1024
    buffer_load_dwordx4 v[136:139], v228, s[4:7], s24 offen offset:1024
    buffer_load_dwordx4 v[140:143], v228, s[4:7], s25 offen offset:1024
    buffer_load_dwordx4 v[144:147], v228, s[4:7], s26 offen offset:1024
    buffer_load_dwordx4 v[148:151], v228, s[4:7], s27 offen offset:1024
    buffer_load_dwordx4 v[152:155], v228, s[4:7], s28 offen offset:1024
    buffer_load_dwordx4 v[156:159], v228, s[4:7], s20 offen offset:2048
    buffer_load_dwordx4 v[160:163], v228, s[4:7], s21 offen offset:2048
    buffer_load_dwordx4 v[164:167], v228, s[4:7], s22 offen offset:2048
    buffer_load_dwordx4 v[168:171], v228, s[4:7], s23 offen offset:2048
    buffer_load_dwordx4 v[172:175], v228, s[4:7], s24 offen offset:2048
    buffer_load_dwordx4 v[176:179], v228, s[4:7], s25 offen offset:2048
    buffer_load_dwordx4 v[180:183], v228, s[4:7], s26 offen offset:2048
    buffer_load_dwordx4 v[184:187], v228, s[4:7], s27 offen offset:2048
    buffer_load_dwordx4 v[188:191], v228, s[4:7], s28 offen offset:2048
    buffer_load_dwordx4 v[192:195], v228, s[4:7], s20 offen offset:3072
    buffer_load_dwordx4 v[196:199], v228, s[4:7], s21 offen offset:3072
    buffer_load_dwordx4 v[200:203], v228, s[4:7], s22 offen offset:3072
    buffer_load_dwordx4 v[204:207], v228, s[4:7], s23 offen offset:3072
    buffer_load_dwordx4 v[208:211], v228, s[4:7], s24 offen offset:3072
    buffer_load_dwordx4 v[212:215], v228, s[4:7], s25 offen offset:3072
    buffer_load_dwordx4 v[216:219], v228, s[4:7], s26 offen offset:3072
    buffer_load_dwordx4 v[220:223], v228, s[4:7], s27 offen offset:3072
    buffer_load_dwordx4 v[224:227], v228, s[4:7], s28 offen offset:3072
    v_add_u32 v244, 0, v229
    v_mul_u32_u24 v245, 52429, v244
    v_lshrrev_b32 v245, 19, v245
    v_mul_u32_u24 v246, 10, v245
    v_sub_u32 v246, v244, v246
    v_mul_u32_u24 v247, 1280, v245
    v_lshl_add_u32 v248, v246, 4, v247
    v_mul_u32_u24 v247, 176, v245
    v_lshl_add_u32 v251, v246, 4, v247
    v_add_u32 v244, 64, v229
    v_mul_u32_u24 v245, 52429, v244
    v_lshrrev_b32 v245, 19, v245
    v_mul_u32_u24 v246, 10, v245
    v_sub_u32 v246, v244, v246
    v_mul_u32_u24 v247, 1280, v245
    v_lshl_add_u32 v249, v246, 4, v247
    v_mul_u32_u24 v247, 176, v245
    v_lshl_add_u32 v252, v246, 4, v247
    v_add_u32 v244, 128, v229
    v_mul_u32_u24 v245, 52429, v244
    v_lshrrev_b32 v245, 19, v245
    v_mul_u32_u24 v246, 10, v245
    v_sub_u32 v246, v244, v246
    v_mul_u32_u24 v247, 1280, v245
    v_lshl_add_u32 v250, v246, 4, v247
    v_mul_u32_u24 v247, 176, v245
    v_lshl_add_u32 v253, v246, 4, v247
    v_cmp_le_u32 vcc, 160, v244
    v_mov_b32 v247, 0x40000000
    s_nop 0
    v_cndmask_b32 v250, v250, v247, vcc
    s_mul_i32 s30, s16, 2816
    s_add_u32 s30, s30, 61440
    v_add_u32 v251, s30, v251
    v_add_u32 v252, s30, v252
    v_add_u32 v253, s30, v253
    v_and_b32 v244, 15, v229
    v_mul_u32_u24 v244, 176, v244
    v_lshrrev_b32 v245, 4, v229
    v_lshl_add_u32 v244, v245, 3, v244
    v_add_u32 v244, s30, v244
    s_lshl_b32 s30, s17, 6
    s_lshl_b32 s31, s16, 4
    s_add_u32 s30, s30, s31
    s_mul_i32 s30, s30, 1280
    s_mul_i32 s31, s18, 160
    s_add_u32 s36, s30, s31
    buffer_load_dwordx4 v[232:235], v248, s[8:11], s36 offen
    buffer_load_dwordx4 v[236:239], v249, s[8:11], s36 offen
    buffer_load_dwordx4 v[240:243], v250, s[8:11], s36 offen
    v_mov_b32 v4, 0
    v_mov_b32 v5, 0
    v_mov_b32 v6, 0
    v_mov_b32 v7, 0
    v_mov_b32 v8, 0
    v_mov_b32 v9, 0
    v_mov_b32 v10, 0
    v_mov_b32 v11, 0
    v_mov_b32 v12, 0
    v_mov_b32 v13, 0
    v_mov_b32 v14, 0
    v_mov_b32 v15, 0
    v_mov_b32 v16, 0
    v_mov_b32 v17, 0
    v_mov_b32 v18, 0
    v_mov_b32 v19, 0
    v_mov_b32 v20, 0
    v_mov_b32 v21, 0
    v_mov_b32 v22, 0
    v_mov_b32 v23, 0
    v_mov_b32 v24, 0
    v_mov_b32 v25, 0
    v_mov_b32 v26, 0
    v_mov_b32 v27, 0
    v_mov_b32 v28, 0
    v_mov_b32 v29, 0
    v_mov_b32 v30, 0
    v_mov_b32 v31, 0
    v_mov_b32 v32, 0
    v_mov_b32 v33, 0
    v_mov_b32 v34, 0
    v_mov_b32 v35, 0
    v_mov_b32 v36, 0
    v_mov_b32 v37, 0
    v_mov_b32 v38, 0
    v_mov_b32 v39, 0
    v_mov_b32 v40, 0
    v_mov_b32 v41, 0
    v_mov_b32 v42, 0
    v_mov_b32 v43, 0
    v_mov_b32 v44, 0
    v_mov_b32 v45, 0
    v_mov_b32 v46, 0
    v_mov_b32 v47, 0
    v_mov_b32 v48, 0
    v_mov_b32 v49, 0
    v_mov_b32 v50, 0
    v_mov_b32 v51, 0
    v_mov_b32 v52, 0
    v_mov_b32 v53, 0
    v_mov_b32 v54, 0
    v_mov_b32 v55, 0
    v_mov_b32 v56, 0
    v_mov_b32 v57, 0
    v_mov_b32 v58, 0
    v_mov_b32 v59, 0
    v_mov_b32 v60, 0
    v_mov_b32 v61, 0
    v_mov_b32 v62, 0
    v_mov_b32 v63, 0
    v_mov_b32 v64, 0
    v_mov_b32 v65, 0
    v_mov_b32 v66, 0
    v_mov_b32 v67, 0
    v_mov_b32 v68, 0
    v_mov_b32 v69, 0
    v_mov_b32 v70, 0
    v_mov_b32 v71, 0
    v_mov_b32 v72, 0
    v_mov_b32 v73, 0
    v_mov_b32 v74, 0
    v_mov_b32 v75, 0
    v_mov_b32 v76, 0
    v_mov_b32 v77, 0
    v_mov_b32 v78, 0
    v_mov_b32 v79, 0
    v_mov_b32 v80, 0
    v_mov_b32 v81, 0
    v_mov_b32 v82, 0
    v_mov_b32 v83, 0
    s_waitcnt vmcnt(30)
    v_mfma_f32_16x16x32_bf16 v[4:7], v[100:103], v[84:87], v[4:7]
    v_mfma_f32_16x16x32_bf16 v[24:27], v[100:103], v[88:91], v[24:27]
    v_mfma_f32_16x16x32_bf16 v[44:47], v[100:103], v[92:95], v[44:47]
    v_mfma_f32_16x16x32_bf16 v[64:67], v[100:103], v[96:99], v[64:67]
    v_mfma_f32_16x16x32_bf16 v[8:11], v[104:107], v[84:87], v[8:11]
    v_mfma_f32_16x16x32_bf16 v[28:31], v[104:107], v[88:91], v[28:31]
    v_mfma_f32_16x16x32_bf16 v[48:51], v[104:107], v[92:95], v[48:51]
    v_mfma_f32_16x16x32_bf16 v[68:71], v[104:107], v[96:99], v[68:71]
    v_mfma_f32_16x16x32_bf16 v[12:15], v[108:111], v[84:87], v[12:15]
    v_mfma_f32_16x16x32_bf16 v[32:35], v[108:111], v[88:91], v[32:35]
    v_mfma_f32_16x16x32_bf16 v[52:55], v[108:111], v[92:95], v[52:55]
    v_mfma_f32_16x16x32_bf16 v[72:75], v[108:111], v[96:99], v[72:75]
    v_mfma_f32_16x16x32_bf16 v[16:19], v[112:115], v[84:87], v[16:19]
    v_mfma_f32_16x16x32_bf16 v[36:39], v[112:115], v[88:91], v[36:39]
    v_mfma_f32_16x16x32_bf16 v[56:59], v[112:115], v[92:95], v[56:59]
    v_mfma_f32_16x16x32_bf16 v[76:79], v[112:115], v[96:99], v[76:79]
    v_mfma_f32_16x16x32_bf16 v[20:23], v[116:119], v[84:87], v[20:23]
    v_mfma_f32_16x16x32_bf16 v[40:43], v[116:119], v[88:91], v[40:43]
    v_mfma_f32_16x16x32_bf16 v[60:63], v[116:119], v[92:95], v[60:63]
    v_mfma_f32_16x16x32_bf16 v[80:83], v[116:119], v[96:99], v[80:83]
    buffer_load_dwordx4 v[84:87], v255, s[4:7], s20 offen
    buffer_load_dwordx4 v[88:91], v255, s[4:7], s21 offen
    buffer_load_dwordx4 v[92:95], v255, s[4:7], s22 offen
    buffer_load_dwordx4 v[96:99], v255, s[4:7], s23 offen
    buffer_load_dwordx4 v[100:103], v255, s[4:7], s24 offen
    buffer_load_dwordx4 v[104:107], v255, s[4:7], s25 offen
    buffer_load_dwordx4 v[108:111], v255, s[4:7], s26 offen
    buffer_load_dwordx4 v[112:115], v255, s[4:7], s27 offen
    buffer_load_dwordx4 v[116:119], v255, s[4:7], s28 offen
    s_waitcnt vmcnt(30)
    v_mfma_f32_16x16x32_bf16 v[4:7], v[136:139], v[120:123], v[4:7]
    v_mfma_f32_16x16x32_bf16 v[24:27], v[136:139], v[124:127], v[24:27]
    v_mfma_f32_16x16x32_bf16 v[44:47], v[136:139], v[128:131], v[44:47]
    v_mfma_f32_16x16x32_bf16 v[64:67], v[136:139], v[132:135], v[64:67]
    v_mfma_f32_16x16x32_bf16 v[8:11], v[140:143], v[120:123], v[8:11]
    v_mfma_f32_16x16x32_bf16 v[28:31], v[140:143], v[124:127], v[28:31]
    v_mfma_f32_16x16x32_bf16 v[48:51], v[140:143], v[128:131], v[48:51]
    v_mfma_f32_16x16x32_bf16 v[68:71], v[140:143], v[132:135], v[68:71]
    v_mfma_f32_16x16x32_bf16 v[12:15], v[144:147], v[120:123], v[12:15]
    v_mfma_f32_16x16x32_bf16 v[32:35], v[144:147], v[124:127], v[32:35]
    v_mfma_f32_16x16x32_bf16 v[52:55], v[144:147], v[128:131], v[52:55]
    v_mfma_f32_16x16x32_bf16 v[72:75], v[144:147], v[132:135], v[72:75]
    v_mfma_f32_16x16x32_bf16 v[16:19], v[148:151], v[120:123], v[16:19]
    v_mfma_f32_16x16x32_bf16 v[36:39], v[148:151], v[124:127], v[36:39]
    v_mfma_f32_16x16x32_bf16 v[56:59], v[148:151], v[128:131], v[56:59]
    v_mfma_f32_16x16x32_bf16 v[76:79], v[148:151], v[132:135], v[76:79]
    v_mfma_f32_16x16x32_bf16 v[20:23], v[152:155], v[120:123], v[20:23]
    v_mfma_f32_16x16x32_bf16 v[40:43], v[152:155], v[124:127], v[40:43]
    v_mfma_f32_16x16x32_bf16 v[60:63], v[152:155], v[128:131], v[60:63]
    v_mfma_f32_16x16x32_bf16 v[80:83], v[152:155], v[132:135], v[80:83]
    s_waitcnt vmcnt(21)
    v_mfma_f32_16x16x32_bf16 v[4:7], v[172:175], v[156:159], v[4:7]
    v_mfma_f32_16x16x32_bf16 v[24:27], v[172:175], v[160:163], v[24:27]
    v_mfma_f32_16x16x32_bf16 v[44:47], v[172:175], v[164:167], v[44:47]
    v_mfma_f32_16x16x32_bf16 v[64:67], v[172:175], v[168:171], v[64:67]
    v_mfma_f32_16x16x32_bf16 v[8:11], v[176:179], v[156:159], v[8:11]
    v_mfma_f32_16x16x32_bf16 v[28:31], v[176:179], v[160:163], v[28:31]
    v_mfma_f32_16x16x32_bf16 v[48:51], v[176:179], v[164:167], v[48:51]
    v_mfma_f32_16x16x32_bf16 v[68:71], v[176:179], v[168:171], v[68:71]
    v_mfma_f32_16x16x32_bf16 v[12:15], v[180:183], v[156:159], v[12:15]
    v_mfma_f32_16x16x32_bf16 v[32:35], v[180:183], v[160:163], v[32:35]
    v_mfma_f32_16x16x32_bf16 v[52:55], v[180:183], v[164:167], v[52:55]
    v_mfma_f32_16x16x32_bf16 v[72:75], v[180:183], v[168:171], v[72:75]
    v_mfma_f32_16x16x32_bf16 v[16:19], v[184:187], v[156:159], v[16:19]
    v_mfma_f32_16x16x32_bf16 v[36:39], v[184:187], v[160:163], v[36:39]
    v_mfma_f32_16x16x32_bf16 v[56:59], v[184:187], v[164:167], v[56:59]
    v_mfma_f32_16x16x32_bf16 v[76:79], v[184:187], v[168:171], v[76:79]
    v_mfma_f32_16x16x32_bf16 v[20:23], v[188:191], v[156:159], v[20:23]
    v_mfma_f32_16x16x32_bf16 v[40:43], v[188:191], v[160:163], v[40:43]
    v_mfma_f32_16x16x32_bf16 v[60:63], v[188:191], v[164:167], v[60:63]
    v_mfma_f32_16x16x32_bf16 v[80:83], v[188:191], v[168:171], v[80:83]
    s_waitcnt vmcnt(12)
    v_mfma_f32_16x16x32_bf16 v[4:7], v[208:211], v[192:195], v[4:7]
    v_mfma_f32_16x16x32_bf16 v[24:27], v[208:211], v[196:199], v[24:27]
    v_mfma_f32_16x16x32_bf16 v[44:47], v[208:211], v[200:203], v[44:47]
    v_mfma_f32_16x16x32_bf16 v[64:67], v[208:211], v[204:207], v[64:67]
    v_mfma_f32_16x16x32_bf16 v[8:11], v[212:215], v[192:195], v[8:11]
    v_mfma_f32_16x16x32_bf16 v[28:31], v[212:215], v[196:199], v[28:31]
    v_mfma_f32_16x16x32_bf16 v[48:51], v[212:215], v[200:203], v[48:51]
    v_mfma_f32_16x16x32_bf16 v[68:71], v[212:215], v[204:207], v[68:71]
    v_mfma_f32_16x16x32_bf16 v[12:15], v[216:219], v[192:195], v[12:15]
    v_mfma_f32_16x16x32_bf16 v[32:35], v[216:219], v[196:199], v[32:35]
    v_mfma_f32_16x16x32_bf16 v[52:55], v[216:219], v[200:203], v[52:55]
    v_mfma_f32_16x16x32_bf16 v[72:75], v[216:219], v[204:207], v[72:75]
    v_mfma_f32_16x16x32_bf16 v[16:19], v[220:223], v[192:195], v[16:19]
    v_mfma_f32_16x16x32_bf16 v[36:39], v[220:223], v[196:199], v[36:39]
    v_mfma_f32_16x16x32_bf16 v[56:59], v[220:223], v[200:203], v[56:59]
    v_mfma_f32_16x16x32_bf16 v[76:79], v[220:223], v[204:207], v[76:79]
    v_mfma_f32_16x16x32_bf16 v[20:23], v[224:227], v[192:195], v[20:23]
    v_mfma_f32_16x16x32_bf16 v[40:43], v[224:227], v[196:199], v[40:43]
    v_mfma_f32_16x16x32_bf16 v[60:63], v[224:227], v[200:203], v[60:63]
    v_mfma_f32_16x16x32_bf16 v[80:83], v[224:227], v[204:207], v[80:83]
    s_lshl_b32 s30, s17, 2
    s_add_u32 s30, s30, s16
    s_mul_i32 s30, s30, 40
    s_mul_i32 s31, s18, 5
    s_add_u32 s30, s30, s31
    s_lshl_b32 s30, s30, 9
    s_add_u32 s30, s30, 23068672
    v_lshrrev_b32 v254, 1, v228
    buffer_load_dwordx2 v[120:121], v254, s[4:7], s30 offen offset:0
    buffer_load_dwordx2 v[122:123], v254, s[4:7], s30 offen offset:512
    buffer_load_dwordx2 v[124:125], v254, s[4:7], s30 offen offset:1024
    buffer_load_dwordx2 v[126:127], v254, s[4:7], s30 offen offset:1536
    buffer_load_dwordx2 v[128:129], v254, s[4:7], s30 offen offset:2048
    s_waitcnt vmcnt(5)
    ds_write_b128 v251, v[232:235]
    ds_write_b128 v252, v[236:239]
    s_mov_b32 exec_lo, -1
    s_mov_b32 exec_hi, 0
    ds_write_b128 v253, v[240:243]
    s_mov_b64 exec, -1
    v_mfma_f32_16x16x32_bf16 v[4:7], v[100:103], v[84:87], v[4:7]
    v_mfma_f32_16x16x32_bf16 v[24:27], v[100:103], v[88:91], v[24:27]
    v_mfma_f32_16x16x32_bf16 v[44:47], v[100:103], v[92:95], v[44:47]
    v_mfma_f32_16x16x32_bf16 v[64:67], v[100:103], v[96:99], v[64:67]
    v_mfma_f32_16x16x32_bf16 v[8:11], v[104:107], v[84:87], v[8:11]
    v_mfma_f32_16x16x32_bf16 v[28:31], v[104:107], v[88:91], v[28:31]
    v_mfma_f32_16x16x32_bf16 v[48:51], v[104:107], v[92:95], v[48:51]
    v_mfma_f32_16x16x32_bf16 v[68:71], v[104:107], v[96:99], v[68:71]
    v_mfma_f32_16x16x32_bf16 v[12:15], v[108:111], v[84:87], v[12:15]
    v_mfma_f32_16x16x32_bf16 v[32:35], v[108:111], v[88:91], v[32:35]
    v_mfma_f32_16x16x32_bf16 v[52:55], v[108:111], v[92:95], v[52:55]
    v_mfma_f32_16x16x32_bf16 v[72:75], v[108:111], v[96:99], v[72:75]
    v_mfma_f32_16x16x32_bf16 v[16:19], v[112:115], v[84:87], v[16:19]
    v_mfma_f32_16x16x32_bf16 v[36:39], v[112:115], v[88:91], v[36:39]
    v_mfma_f32_16x16x32_bf16 v[56:59], v[112:115], v[92:95], v[56:59]
    v_mfma_f32_16x16x32_bf16 v[76:79], v[112:115], v[96:99], v[76:79]
    v_mfma_f32_16x16x32_bf16 v[20:23], v[116:119], v[84:87], v[20:23]
    v_mfma_f32_16x16x32_bf16 v[40:43], v[116:119], v[88:91], v[40:43]
    v_mfma_f32_16x16x32_bf16 v[60:63], v[116:119], v[92:95], v[60:63]
    v_mfma_f32_16x16x32_bf16 v[80:83], v[116:119], v[96:99], v[80:83]
    s_nop 7
    v_mov_b32 v156, v228
    s_cmp_lg_u32 s16, 0
    s_cbranch_scc1 L_k3_w1
    ds_write_b128 v156, v[24:27] offset:15360
    ds_write_b128 v156, v[28:31] offset:16384
    ds_write_b128 v156, v[32:35] offset:17408
    ds_write_b128 v156, v[36:39] offset:18432
    ds_write_b128 v156, v[40:43] offset:19456
    ds_write_b128 v156, v[44:47] offset:30720
    ds_write_b128 v156, v[48:51] offset:31744
    ds_write_b128 v156, v[52:55] offset:32768
    ds_write_b128 v156, v[56:59] offset:33792
    ds_write_b128 v156, v[60:63] offset:34816
    ds_write_b128 v156, v[64:67] offset:46080
    ds_write_b128 v156, v[68:71] offset:47104
    ds_write_b128 v156, v[72:75] offset:48128
    ds_write_b128 v156, v[76:79] offset:49152
    ds_write_b128 v156, v[80:83] offset:50176
    s_waitcnt lgkmcnt(0)
    s_barrier
    ds_read_b128 v[160:163], v156 offset:0
    ds_read_b128 v[164:167], v156 offset:1024
    ds_read_b128 v[168:171], v156 offset:2048
    ds_read_b128 v[172:175], v156 offset:3072
    ds_read_b128 v[176:179], v156 offset:4096
    ds_read_b128 v[180:183], v156 offset:5120
    ds_read_b128 v[184:187], v156 offset:6144
    ds_read_b128 v[188:191], v156 offset:7168
    ds_read_b128 v[192:195], v156 offset:8192
    ds_read_b128 v[196:199], v156 offset:9216
    ds_read_b128 v[200:203], v156 offset:10240
    ds_read_b128 v[204:207], v156 offset:11264
    ds_read_b128 v[208:211], v156 offset:12288
    ds_read_b128 v[212:215], v156 offset:13312
    ds_read_b128 v[216:219], v156 offset:14336
    ds_read_b64 v[232:233], v244 offset:0
    ds_read_b64 v[234:235], v244 offset:32
    ds_read_b64 v[236:237], v244 offset:64
    ds_read_b64 v[238:239], v244 offset:96
    ds_read_b64 v[240:241], v244 offset:128
    s_waitcnt vmcnt(0) lgkmcnt(0)
    v_lshlrev_b32 v84, 16, v232
    v_and_b32 v85, 0xffff0000, v232
    v_lshlrev_b32 v86, 16, v233
    v_and_b32 v87, 0xffff0000, v233
    v_lshlrev_b32 v88, 16, v234
    v_and_b32 v89, 0xffff0000, v234
    v_lshlrev_b32 v90, 16, v235
    v_and_b32 v91, 0xffff0000, v235
    v_lshlrev_b32 v92, 16, v236
    v_and_b32 v93, 0xffff0000, v236
    v_lshlrev_b32 v94, 16, v237
    v_and_b32 v95, 0xffff0000, v237
    v_lshlrev_b32 v96, 16, v238
    v_and_b32 v97, 0xffff0000, v238
    v_lshlrev_b32 v98, 16, v239
    v_and_b32 v99, 0xffff0000, v239
    v_lshlrev_b32 v100, 16, v240
    v_and_b32 v101, 0xffff0000, v240
    v_lshlrev_b32 v102, 16, v241
    v_and_b32 v103, 0xffff0000, v241
    v_lshlrev_b32 v132, 16, v120
    v_and_b32 v133, 0xffff0000, v120
    v_lshlrev_b32 v134, 16, v121
    v_and_b32 v135, 0xffff0000, v121
    v_lshlrev_b32 v136, 16, v122
    v_and_b32 v137, 0xffff0000, v122
    v_lshlrev_b32 v138, 16, v123
    v_and_b32 v139, 0xffff0000, v123
    v_lshlrev_b32 v140, 16, v124
    v_and_b32 v141, 0xffff0000, v124
    v_lshlrev_b32 v142, 16, v125
    v_and_b32 v143, 0xffff0000, v125
    v_lshlrev_b32 v144, 16, v126
    v_and_b32 v145, 0xffff0000, v126
    v_lshlrev_b32 v146, 16, v127
    v_and_b32 v147, 0xffff0000, v127
    v_lshlrev_b32 v148, 16, v128
    v_and_b32 v149, 0xffff0000, v128
    v_lshlrev_b32 v150, 16, v129
    v_and_b32 v151, 0xffff0000, v129
    v_mul_f32 v104, 0xbfb8aa3b, v132
    v_mul_f32 v105, 0xbfb8aa3b, v133
    v_mul_f32 v106, 0xbfb8aa3b, v134
    v_mul_f32 v107, 0xbfb8aa3b, v135
    v_mul_f32 v108, 0xbfb8aa3b, v136
    v_mul_f32 v109, 0xbfb8aa3b, v137
    v_mul_f32 v110, 0xbfb8aa3b, v138
    v_mul_f32 v111, 0xbfb8aa3b, v139
    v_mul_f32 v112, 0xbfb8aa3b, v140
    v_mul_f32 v113, 0xbfb8aa3b, v141
    v_exp_f32 v104, v104
    v_exp_f32 v105, v105
    v_exp_f32 v106, v106
    v_exp_f32 v107, v107
    v_exp_f32 v108, v108
    v_exp_f32 v109, v109
    v_exp_f32 v110, v110
    v_exp_f32 v111, v111
    v_exp_f32 v112, v112
    v_exp_f32 v113, v113
    s_nop 0
    v_add_f32 v104, 1.0, v104
    v_add_f32 v105, 1.0, v105
    v_add_f32 v106, 1.0, v106
    v_add_f32 v107, 1.0, v107
    v_add_f32 v108, 1.0, v108
    v_add_f32 v109, 1.0, v109
    v_add_f32 v110, 1.0, v110
    v_add_f32 v111, 1.0, v111
    v_add_f32 v112, 1.0, v112
    v_add_f32 v113, 1.0, v113
    v_rcp_f32 v104, v104
    v_rcp_f32 v105, v105
    v_rcp_f32 v106, v106
    v_rcp_f32 v107, v107
    v_rcp_f32 v108, v108
    v_rcp_f32 v109, v109
    v_rcp_f32 v110, v110
    v_rcp_f32 v111, v111
    v_rcp_f32 v112, v112
    v_rcp_f32 v113, v113
    s_nop 0
    v_mul_f32 v132, v132, v104
    v_mul_f32 v133, v133, v105
    v_mul_f32 v134, v134, v106
    v_mul_f32 v135, v135, v107
    v_mul_f32 v136, v136, v108
    v_mul_f32 v137, v137, v109
    v_mul_f32 v138, v138, v110
    v_mul_f32 v139, v139, v111
    v_mul_f32 v140, v140, v112
    v_mul_f32 v141, v141, v113
    v_mul_f32 v104, 0xbfb8aa3b, v142
    v_mul_f32 v105, 0xbfb8aa3b, v143
    v_mul_f32 v106, 0xbfb8aa3b, v144
    v_mul_f32 v107, 0xbfb8aa3b, v145
    v_mul_f32 v108, 0xbfb8aa3b, v146
    v_mul_f32 v109, 0xbfb8aa3b, v147
    v_mul_f32 v110, 0xbfb8aa3b, v148
    v_mul_f32 v111, 0xbfb8aa3b, v149
    v_mul_f32 v112, 0xbfb8aa3b, v150
    v_mul_f32 v113, 0xbfb8aa3b, v151
    v_exp_f32 v104, v104
    v_exp_f32 v105, v105
    v_exp_f32 v106, v106
    v_exp_f32 v107, v107
    v_exp_f32 v108, v108
    v_exp_f32 v109, v109
    v_exp_f32 v110, v110
    v_exp_f32 v111, v111
    v_exp_f32 v112, v112
    v_exp_f32 v113, v113
    s_nop 0
    v_add_f32 v104, 1.0, v104
    v_add_f32 v105, 1.0, v105
    v_add_f32 v106, 1.0, v106
    v_add_f32 v107, 1.0, v107
    v_add_f32 v108, 1.0, v108
    v_add_f32 v109, 1.0, v109
    v_add_f32 v110, 1.0, v110
    v_add_f32 v111, 1.0, v111
    v_add_f32 v112, 1.0, v112
    v_add_f32 v113, 1.0, v113
    v_rcp_f32 v104, v104
    v_rcp_f32 v105, v105
    v_rcp_f32 v106, v106
    v_rcp_f32 v107, v107
    v_rcp_f32 v108, v108
    v_rcp_f32 v109, v109
    v_rcp_f32 v110, v110
    v_rcp_f32 v111, v111
    v_rcp_f32 v112, v112
    v_rcp_f32 v113, v113
    s_nop 0
    v_mul_f32 v142, v142, v104
    v_mul_f32 v143, v143, v105
    v_mul_f32 v144, v144, v106
    v_mul_f32 v145, v145, v107
    v_mul_f32 v146, v146, v108
    v_mul_f32 v147, v147, v109
    v_mul_f32 v148, v148, v110
    v_mul_f32 v149, v149, v111
    v_mul_f32 v150, v150, v112
    v_mul_f32 v151, v151, v113
    s_waitcnt lgkmcnt(0)
    v_pk_add_f32 v[4:5], v[4:5], v[160:161]
    v_pk_add_f32 v[6:7], v[6:7], v[162:163]
    v_pk_add_f32 v[8:9], v[8:9], v[164:165]
    v_pk_add_f32 v[10:11], v[10:11], v[166:167]
    v_pk_add_f32 v[12:13], v[12:13], v[168:169]
    v_pk_add_f32 v[14:15], v[14:15], v[170:171]
    v_pk_add_f32 v[16:17], v[16:17], v[172:173]
    v_pk_add_f32 v[18:19], v[18:19], v[174:175]
    v_pk_add_f32 v[20:21], v[20:21], v[176:177]
    v_pk_add_f32 v[22:23], v[22:23], v[178:179]
    v_pk_add_f32 v[4:5], v[4:5], v[180:181]
    v_pk_add_f32 v[6:7], v[6:7], v[182:183]
    v_pk_add_f32 v[8:9], v[8:9], v[184:185]
    v_pk_add_f32 v[10:11], v[10:11], v[186:187]
    v_pk_add_f32 v[12:13], v[12:13], v[188:189]
    v_pk_add_f32 v[14:15], v[14:15], v[190:191]
    v_pk_add_f32 v[16:17], v[16:17], v[192:193]
    v_pk_add_f32 v[18:19], v[18:19], v[194:195]
    v_pk_add_f32 v[20:21], v[20:21], v[196:197]
    v_pk_add_f32 v[22:23], v[22:23], v[198:199]
    v_pk_add_f32 v[4:5], v[4:5], v[200:201]
    v_pk_add_f32 v[6:7], v[6:7], v[202:203]
    v_pk_add_f32 v[8:9], v[8:9], v[204:205]
    v_pk_add_f32 v[10:11], v[10:11], v[206:207]
    v_pk_add_f32 v[12:13], v[12:13], v[208:209]
    v_pk_add_f32 v[14:15], v[14:15], v[210:211]
    v_pk_add_f32 v[16:17], v[16:17], v[212:213]
    v_pk_add_f32 v[18:19], v[18:19], v[214:215]
    v_pk_add_f32 v[20:21], v[20:21], v[216:217]
    v_pk_add_f32 v[22:23], v[22:23], v[218:219]
    v_pk_fma_f32 v[4:5], v[4:5], v[132:133], v[84:85]
    v_pk_fma_f32 v[6:7], v[6:7], v[134:135], v[86:87]
    v_pk_fma_f32 v[8:9], v[8:9], v[136:137], v[88:89]
    v_pk_fma_f32 v[10:11], v[10:11], v[138:139], v[90:91]
    v_pk_fma_f32 v[12:13], v[12:13], v[140:141], v[92:93]
    v_pk_fma_f32 v[14:15], v[14:15], v[142:143], v[94:95]
    v_pk_fma_f32 v[16:17], v[16:17], v[144:145], v[96:97]
    v_pk_fma_f32 v[18:19], v[18:19], v[146:147], v[98:99]
    v_pk_fma_f32 v[20:21], v[20:21], v[148:149], v[100:101]
    v_pk_fma_f32 v[22:23], v[22:23], v[150:151], v[102:103]
    v_cvt_pk_bf16_f32 v108, v4, v5
    v_cvt_pk_bf16_f32 v109, v6, v7
    v_cvt_pk_bf16_f32 v110, v8, v9
    v_cvt_pk_bf16_f32 v111, v10, v11
    v_cvt_pk_bf16_f32 v112, v12, v13
    v_cvt_pk_bf16_f32 v113, v14, v15
    v_cvt_pk_bf16_f32 v114, v16, v17
    v_cvt_pk_bf16_f32 v115, v18, v19
    v_cvt_pk_bf16_f32 v116, v20, v21
    v_cvt_pk_bf16_f32 v117, v22, v23
    ds_write_b64 v244, v[108:109] offset:0
    ds_write_b64 v244, v[110:111] offset:32
    ds_write_b64 v244, v[112:113] offset:64
    ds_write_b64 v244, v[114:115] offset:96
    ds_write_b64 v244, v[116:117] offset:128
    s_waitcnt lgkmcnt(0)
    ds_read_b128 v[160:163], v251
    ds_read_b128 v[164:167], v252
    ds_read_b128 v[168:171], v253
    s_waitcnt lgkmcnt(2)
    buffer_store_dwordx4 v[160:163], v248, s[12:15], s36 offen
    s_waitcnt lgkmcnt(1)
    buffer_store_dwordx4 v[164:167], v249, s[12:15], s36 offen
    s_waitcnt lgkmcnt(0)
    buffer_store_dwordx4 v[168:171], v250, s[12:15], s36 offen
    s_branch L_k3_fin
L_k3_w1:
    s_cmp_lg_u32 s16, 1
    s_cbranch_scc1 L_k3_w2
    ds_write_b128 v156, v[4:7] offset:0
    ds_write_b128 v156, v[8:11] offset:1024
    ds_write_b128 v156, v[12:15] offset:2048
    ds_write_b128 v156, v[16:19] offset:3072
    ds_write_b128 v156, v[20:23] offset:4096
    ds_write_b128 v156, v[44:47] offset:35840
    ds_write_b128 v156, v[48:51] offset:36864
    ds_write_b128 v156, v[52:55] offset:37888
    ds_write_b128 v156, v[56:59] offset:38912
    ds_write_b128 v156, v[60:63] offset:39936
    ds_write_b128 v156, v[64:67] offset:51200
    ds_write_b128 v156, v[68:71] offset:52224
    ds_write_b128 v156, v[72:75] offset:53248
    ds_write_b128 v156, v[76:79] offset:54272
    ds_write_b128 v156, v[80:83] offset:55296
    s_waitcnt lgkmcnt(0)
    s_barrier
    ds_read_b128 v[160:163], v156 offset:15360
    ds_read_b128 v[164:167], v156 offset:16384
    ds_read_b128 v[168:171], v156 offset:17408
    ds_read_b128 v[172:175], v156 offset:18432
    ds_read_b128 v[176:179], v156 offset:19456
    ds_read_b128 v[180:183], v156 offset:20480
    ds_read_b128 v[184:187], v156 offset:21504
    ds_read_b128 v[188:191], v156 offset:22528
    ds_read_b128 v[192:195], v156 offset:23552
    ds_read_b128 v[196:199], v156 offset:24576
    ds_read_b128 v[200:203], v156 offset:25600
    ds_read_b128 v[204:207], v156 offset:26624
    ds_read_b128 v[208:211], v156 offset:27648
    ds_read_b128 v[212:215], v156 offset:28672
    ds_read_b128 v[216:219], v156 offset:29696
    ds_read_b64 v[232:233], v244 offset:0
    ds_read_b64 v[234:235], v244 offset:32
    ds_read_b64 v[236:237], v244 offset:64
    ds_read_b64 v[238:239], v244 offset:96
    ds_read_b64 v[240:241], v244 offset:128
    s_waitcnt vmcnt(0) lgkmcnt(0)
    v_lshlrev_b32 v84, 16, v232
    v_and_b32 v85, 0xffff0000, v232
    v_lshlrev_b32 v86, 16, v233
    v_and_b32 v87, 0xffff0000, v233
    v_lshlrev_b32 v88, 16, v234
    v_and_b32 v89, 0xffff0000, v234
    v_lshlrev_b32 v90, 16, v235
    v_and_b32 v91, 0xffff0000, v235
    v_lshlrev_b32 v92, 16, v236
    v_and_b32 v93, 0xffff0000, v236
    v_lshlrev_b32 v94, 16, v237
    v_and_b32 v95, 0xffff0000, v237
    v_lshlrev_b32 v96, 16, v238
    v_and_b32 v97, 0xffff0000, v238
    v_lshlrev_b32 v98, 16, v239
    v_and_b32 v99, 0xffff0000, v239
    v_lshlrev_b32 v100, 16, v240
    v_and_b32 v101, 0xffff0000, v240
    v_lshlrev_b32 v102, 16, v241
    v_and_b32 v103, 0xffff0000, v241
    v_lshlrev_b32 v132, 16, v120
    v_and_b32 v133, 0xffff0000, v120
    v_lshlrev_b32 v134, 16, v121
    v_and_b32 v135, 0xffff0000, v121
    v_lshlrev_b32 v136, 16, v122
    v_and_b32 v137, 0xffff0000, v122
    v_lshlrev_b32 v138, 16, v123
    v_and_b32 v139, 0xffff0000, v123
    v_lshlrev_b32 v140, 16, v124
    v_and_b32 v141, 0xffff0000, v124
    v_lshlrev_b32 v142, 16, v125
    v_and_b32 v143, 0xffff0000, v125
    v_lshlrev_b32 v144, 16, v126
    v_and_b32 v145, 0xffff0000, v126
    v_lshlrev_b32 v146, 16, v127
    v_and_b32 v147, 0xffff0000, v127
    v_lshlrev_b32 v148, 16, v128
    v_and_b32 v149, 0xffff0000, v128
    v_lshlrev_b32 v150, 16, v129
    v_and_b32 v151, 0xffff0000, v129
    v_mul_f32 v104, 0xbfb8aa3b, v132
    v_mul_f32 v105, 0xbfb8aa3b, v133
    v_mul_f32 v106, 0xbfb8aa3b, v134
    v_mul_f32 v107, 0xbfb8aa3b, v135
    v_mul_f32 v108, 0xbfb8aa3b, v136
    v_mul_f32 v109, 0xbfb8aa3b, v137
    v_mul_f32 v110, 0xbfb8aa3b, v138
    v_mul_f32 v111, 0xbfb8aa3b, v139
    v_mul_f32 v112, 0xbfb8aa3b, v140
    v_mul_f32 v113, 0xbfb8aa3b, v141
    v_exp_f32 v104, v104
    v_exp_f32 v105, v105
    v_exp_f32 v106, v106
    v_exp_f32 v107, v107
    v_exp_f32 v108, v108
    v_exp_f32 v109, v109
    v_exp_f32 v110, v110
    v_exp_f32 v111, v111
    v_exp_f32 v112, v112
    v_exp_f32 v113, v113
    s_nop 0
    v_add_f32 v104, 1.0, v104
    v_add_f32 v105, 1.0, v105
    v_add_f32 v106, 1.0, v106
    v_add_f32 v107, 1.0, v107
    v_add_f32 v108, 1.0, v108
    v_add_f32 v109, 1.0, v109
    v_add_f32 v110, 1.0, v110
    v_add_f32 v111, 1.0, v111
    v_add_f32 v112, 1.0, v112
    v_add_f32 v113, 1.0, v113
    v_rcp_f32 v104, v104
    v_rcp_f32 v105, v105
    v_rcp_f32 v106, v106
    v_rcp_f32 v107, v107
    v_rcp_f32 v108, v108
    v_rcp_f32 v109, v109
    v_rcp_f32 v110, v110
    v_rcp_f32 v111, v111
    v_rcp_f32 v112, v112
    v_rcp_f32 v113, v113
    s_nop 0
    v_mul_f32 v132, v132, v104
    v_mul_f32 v133, v133, v105
    v_mul_f32 v134, v134, v106
    v_mul_f32 v135, v135, v107
    v_mul_f32 v136, v136, v108
    v_mul_f32 v137, v137, v109
    v_mul_f32 v138, v138, v110
    v_mul_f32 v139, v139, v111
    v_mul_f32 v140, v140, v112
    v_mul_f32 v141, v141, v113
    v_mul_f32 v104, 0xbfb8aa3b, v142
    v_mul_f32 v105, 0xbfb8aa3b, v143
    v_mul_f32 v106, 0xbfb8aa3b, v144
    v_mul_f32 v107, 0xbfb8aa3b, v145
    v_mul_f32 v108, 0xbfb8aa3b, v146
    v_mul_f32 v109, 0xbfb8aa3b, v147
    v_mul_f32 v110, 0xbfb8aa3b, v148
    v_mul_f32 v111, 0xbfb8aa3b, v149
    v_mul_f32 v112, 0xbfb8aa3b, v150
    v_mul_f32 v113, 0xbfb8aa3b, v151
    v_exp_f32 v104, v104
    v_exp_f32 v105, v105
    v_exp_f32 v106, v106
    v_exp_f32 v107, v107
    v_exp_f32 v108, v108
    v_exp_f32 v109, v109
    v_exp_f32 v110, v110
    v_exp_f32 v111, v111
    v_exp_f32 v112, v112
    v_exp_f32 v113, v113
    s_nop 0
    v_add_f32 v104, 1.0, v104
    v_add_f32 v105, 1.0, v105
    v_add_f32 v106, 1.0, v106
    v_add_f32 v107, 1.0, v107
    v_add_f32 v108, 1.0, v108
    v_add_f32 v109, 1.0, v109
    v_add_f32 v110, 1.0, v110
    v_add_f32 v111, 1.0, v111
    v_add_f32 v112, 1.0, v112
    v_add_f32 v113, 1.0, v113
    v_rcp_f32 v104, v104
    v_rcp_f32 v105, v105
    v_rcp_f32 v106, v106
    v_rcp_f32 v107, v107
    v_rcp_f32 v108, v108
    v_rcp_f32 v109, v109
    v_rcp_f32 v110, v110
    v_rcp_f32 v111, v111
    v_rcp_f32 v112, v112
    v_rcp_f32 v113, v113
    s_nop 0
    v_mul_f32 v142, v142, v104
    v_mul_f32 v143, v143, v105
    v_mul_f32 v144, v144, v106
    v_mul_f32 v145, v145, v107
    v_mul_f32 v146, v146, v108
    v_mul_f32 v147, v147, v109
    v_mul_f32 v148, v148, v110
    v_mul_f32 v149, v149, v111
    v_mul_f32 v150, v150, v112
    v_mul_f32 v151, v151, v113
    s_waitcnt lgkmcnt(0)
    v_pk_add_f32 v[24:25], v[24:25], v[160:161]
    v_pk_add_f32 v[26:27], v[26:27], v[162:163]
    v_pk_add_f32 v[28:29], v[28:29], v[164:165]
    v_pk_add_f32 v[30:31], v[30:31], v[166:167]
    v_pk_add_f32 v[32:33], v[32:33], v[168:169]
    v_pk_add_f32 v[34:35], v[34:35], v[170:171]
    v_pk_add_f32 v[36:37], v[36:37], v[172:173]
    v_pk_add_f32 v[38:39], v[38:39], v[174:175]
    v_pk_add_f32 v[40:41], v[40:41], v[176:177]
    v_pk_add_f32 v[42:43], v[42:43], v[178:179]
    v_pk_add_f32 v[24:25], v[24:25], v[180:181]
    v_pk_add_f32 v[26:27], v[26:27], v[182:183]
    v_pk_add_f32 v[28:29], v[28:29], v[184:185]
    v_pk_add_f32 v[30:31], v[30:31], v[186:187]
    v_pk_add_f32 v[32:33], v[32:33], v[188:189]
    v_pk_add_f32 v[34:35], v[34:35], v[190:191]
    v_pk_add_f32 v[36:37], v[36:37], v[192:193]
    v_pk_add_f32 v[38:39], v[38:39], v[194:195]
    v_pk_add_f32 v[40:41], v[40:41], v[196:197]
    v_pk_add_f32 v[42:43], v[42:43], v[198:199]
    v_pk_add_f32 v[24:25], v[24:25], v[200:201]
    v_pk_add_f32 v[26:27], v[26:27], v[202:203]
    v_pk_add_f32 v[28:29], v[28:29], v[204:205]
    v_pk_add_f32 v[30:31], v[30:31], v[206:207]
    v_pk_add_f32 v[32:33], v[32:33], v[208:209]
    v_pk_add_f32 v[34:35], v[34:35], v[210:211]
    v_pk_add_f32 v[36:37], v[36:37], v[212:213]
    v_pk_add_f32 v[38:39], v[38:39], v[214:215]
    v_pk_add_f32 v[40:41], v[40:41], v[216:217]
    v_pk_add_f32 v[42:43], v[42:43], v[218:219]
    v_pk_fma_f32 v[24:25], v[24:25], v[132:133], v[84:85]
    v_pk_fma_f32 v[26:27], v[26:27], v[134:135], v[86:87]
    v_pk_fma_f32 v[28:29], v[28:29], v[136:137], v[88:89]
    v_pk_fma_f32 v[30:31], v[30:31], v[138:139], v[90:91]
    v_pk_fma_f32 v[32:33], v[32:33], v[140:141], v[92:93]
    v_pk_fma_f32 v[34:35], v[34:35], v[142:143], v[94:95]
    v_pk_fma_f32 v[36:37], v[36:37], v[144:145], v[96:97]
    v_pk_fma_f32 v[38:39], v[38:39], v[146:147], v[98:99]
    v_pk_fma_f32 v[40:41], v[40:41], v[148:149], v[100:101]
    v_pk_fma_f32 v[42:43], v[42:43], v[150:151], v[102:103]
    v_cvt_pk_bf16_f32 v108, v24, v25
    v_cvt_pk_bf16_f32 v109, v26, v27
    v_cvt_pk_bf16_f32 v110, v28, v29
    v_cvt_pk_bf16_f32 v111, v30, v31
    v_cvt_pk_bf16_f32 v112, v32, v33
    v_cvt_pk_bf16_f32 v113, v34, v35
    v_cvt_pk_bf16_f32 v114, v36, v37
    v_cvt_pk_bf16_f32 v115, v38, v39
    v_cvt_pk_bf16_f32 v116, v40, v41
    v_cvt_pk_bf16_f32 v117, v42, v43
    ds_write_b64 v244, v[108:109] offset:0
    ds_write_b64 v244, v[110:111] offset:32
    ds_write_b64 v244, v[112:113] offset:64
    ds_write_b64 v244, v[114:115] offset:96
    ds_write_b64 v244, v[116:117] offset:128
    s_waitcnt lgkmcnt(0)
    ds_read_b128 v[160:163], v251
    ds_read_b128 v[164:167], v252
    ds_read_b128 v[168:171], v253
    s_waitcnt lgkmcnt(2)
    buffer_store_dwordx4 v[160:163], v248, s[12:15], s36 offen
    s_waitcnt lgkmcnt(1)
    buffer_store_dwordx4 v[164:167], v249, s[12:15], s36 offen
    s_waitcnt lgkmcnt(0)
    buffer_store_dwordx4 v[168:171], v250, s[12:15], s36 offen
    s_branch L_k3_fin
L_k3_w2:
    s_cmp_lg_u32 s16, 2
    s_cbranch_scc1 L_k3_w3
    ds_write_b128 v156, v[4:7] offset:5120
    ds_write_b128 v156, v[8:11] offset:6144
    ds_write_b128 v156, v[12:15] offset:7168
    ds_write_b128 v156, v[16:19] offset:8192
    ds_write_b128 v156, v[20:23] offset:9216
    ds_write_b128 v156, v[24:27] offset:20480
    ds_write_b128 v156, v[28:31] offset:21504
    ds_write_b128 v156, v[32:35] offset:22528
    ds_write_b128 v156, v[36:39] offset:23552
    ds_write_b128 v156, v[40:43] offset:24576
    ds_write_b128 v156, v[64:67] offset:56320
    ds_write_b128 v156, v[68:71] offset:57344
    ds_write_b128 v156, v[72:75] offset:58368
    ds_write_b128 v156, v[76:79] offset:59392
    ds_write_b128 v156, v[80:83] offset:60416
    s_waitcnt lgkmcnt(0)
    s_barrier
    ds_read_b128 v[160:163], v156 offset:30720
    ds_read_b128 v[164:167], v156 offset:31744
    ds_read_b128 v[168:171], v156 offset:32768
    ds_read_b128 v[172:175], v156 offset:33792
    ds_read_b128 v[176:179], v156 offset:34816
    ds_read_b128 v[180:183], v156 offset:35840
    ds_read_b128 v[184:187], v156 offset:36864
    ds_read_b128 v[188:191], v156 offset:37888
    ds_read_b128 v[192:195], v156 offset:38912
    ds_read_b128 v[196:199], v156 offset:39936
    ds_read_b128 v[200:203], v156 offset:40960
    ds_read_b128 v[204:207], v156 offset:41984
    ds_read_b128 v[208:211], v156 offset:43008
    ds_read_b128 v[212:215], v156 offset:44032
    ds_read_b128 v[216:219], v156 offset:45056
    ds_read_b64 v[232:233], v244 offset:0
    ds_read_b64 v[234:235], v244 offset:32
    ds_read_b64 v[236:237], v244 offset:64
    ds_read_b64 v[238:239], v244 offset:96
    ds_read_b64 v[240:241], v244 offset:128
    s_waitcnt vmcnt(0) lgkmcnt(0)
    v_lshlrev_b32 v84, 16, v232
    v_and_b32 v85, 0xffff0000, v232
    v_lshlrev_b32 v86, 16, v233
    v_and_b32 v87, 0xffff0000, v233
    v_lshlrev_b32 v88, 16, v234
    v_and_b32 v89, 0xffff0000, v234
    v_lshlrev_b32 v90, 16, v235
    v_and_b32 v91, 0xffff0000, v235
    v_lshlrev_b32 v92, 16, v236
    v_and_b32 v93, 0xffff0000, v236
    v_lshlrev_b32 v94, 16, v237
    v_and_b32 v95, 0xffff0000, v237
    v_lshlrev_b32 v96, 16, v238
    v_and_b32 v97, 0xffff0000, v238
    v_lshlrev_b32 v98, 16, v239
    v_and_b32 v99, 0xffff0000, v239
    v_lshlrev_b32 v100, 16, v240
    v_and_b32 v101, 0xffff0000, v240
    v_lshlrev_b32 v102, 16, v241
    v_and_b32 v103, 0xffff0000, v241
    v_lshlrev_b32 v132, 16, v120
    v_and_b32 v133, 0xffff0000, v120
    v_lshlrev_b32 v134, 16, v121
    v_and_b32 v135, 0xffff0000, v121
    v_lshlrev_b32 v136, 16, v122
    v_and_b32 v137, 0xffff0000, v122
    v_lshlrev_b32 v138, 16, v123
    v_and_b32 v139, 0xffff0000, v123
    v_lshlrev_b32 v140, 16, v124
    v_and_b32 v141, 0xffff0000, v124
    v_lshlrev_b32 v142, 16, v125
    v_and_b32 v143, 0xffff0000, v125
    v_lshlrev_b32 v144, 16, v126
    v_and_b32 v145, 0xffff0000, v126
    v_lshlrev_b32 v146, 16, v127
    v_and_b32 v147, 0xffff0000, v127
    v_lshlrev_b32 v148, 16, v128
    v_and_b32 v149, 0xffff0000, v128
    v_lshlrev_b32 v150, 16, v129
    v_and_b32 v151, 0xffff0000, v129
    v_mul_f32 v104, 0xbfb8aa3b, v132
    v_mul_f32 v105, 0xbfb8aa3b, v133
    v_mul_f32 v106, 0xbfb8aa3b, v134
    v_mul_f32 v107, 0xbfb8aa3b, v135
    v_mul_f32 v108, 0xbfb8aa3b, v136
    v_mul_f32 v109, 0xbfb8aa3b, v137
    v_mul_f32 v110, 0xbfb8aa3b, v138
    v_mul_f32 v111, 0xbfb8aa3b, v139
    v_mul_f32 v112, 0xbfb8aa3b, v140
    v_mul_f32 v113, 0xbfb8aa3b, v141
    v_exp_f32 v104, v104
    v_exp_f32 v105, v105
    v_exp_f32 v106, v106
    v_exp_f32 v107, v107
    v_exp_f32 v108, v108
    v_exp_f32 v109, v109
    v_exp_f32 v110, v110
    v_exp_f32 v111, v111
    v_exp_f32 v112, v112
    v_exp_f32 v113, v113
    s_nop 0
    v_add_f32 v104, 1.0, v104
    v_add_f32 v105, 1.0, v105
    v_add_f32 v106, 1.0, v106
    v_add_f32 v107, 1.0, v107
    v_add_f32 v108, 1.0, v108
    v_add_f32 v109, 1.0, v109
    v_add_f32 v110, 1.0, v110
    v_add_f32 v111, 1.0, v111
    v_add_f32 v112, 1.0, v112
    v_add_f32 v113, 1.0, v113
    v_rcp_f32 v104, v104
    v_rcp_f32 v105, v105
    v_rcp_f32 v106, v106
    v_rcp_f32 v107, v107
    v_rcp_f32 v108, v108
    v_rcp_f32 v109, v109
    v_rcp_f32 v110, v110
    v_rcp_f32 v111, v111
    v_rcp_f32 v112, v112
    v_rcp_f32 v113, v113
    s_nop 0
    v_mul_f32 v132, v132, v104
    v_mul_f32 v133, v133, v105
    v_mul_f32 v134, v134, v106
    v_mul_f32 v135, v135, v107
    v_mul_f32 v136, v136, v108
    v_mul_f32 v137, v137, v109
    v_mul_f32 v138, v138, v110
    v_mul_f32 v139, v139, v111
    v_mul_f32 v140, v140, v112
    v_mul_f32 v141, v141, v113
    v_mul_f32 v104, 0xbfb8aa3b, v142
    v_mul_f32 v105, 0xbfb8aa3b, v143
    v_mul_f32 v106, 0xbfb8aa3b, v144
    v_mul_f32 v107, 0xbfb8aa3b, v145
    v_mul_f32 v108, 0xbfb8aa3b, v146
    v_mul_f32 v109, 0xbfb8aa3b, v147
    v_mul_f32 v110, 0xbfb8aa3b, v148
    v_mul_f32 v111, 0xbfb8aa3b, v149
    v_mul_f32 v112, 0xbfb8aa3b, v150
    v_mul_f32 v113, 0xbfb8aa3b, v151
    v_exp_f32 v104, v104
    v_exp_f32 v105, v105
    v_exp_f32 v106, v106
    v_exp_f32 v107, v107
    v_exp_f32 v108, v108
    v_exp_f32 v109, v109
    v_exp_f32 v110, v110
    v_exp_f32 v111, v111
    v_exp_f32 v112, v112
    v_exp_f32 v113, v113
    s_nop 0
    v_add_f32 v104, 1.0, v104
    v_add_f32 v105, 1.0, v105
    v_add_f32 v106, 1.0, v106
    v_add_f32 v107, 1.0, v107
    v_add_f32 v108, 1.0, v108
    v_add_f32 v109, 1.0, v109
    v_add_f32 v110, 1.0, v110
    v_add_f32 v111, 1.0, v111
    v_add_f32 v112, 1.0, v112
    v_add_f32 v113, 1.0, v113
    v_rcp_f32 v104, v104
    v_rcp_f32 v105, v105
    v_rcp_f32 v106, v106
    v_rcp_f32 v107, v107
    v_rcp_f32 v108, v108
    v_rcp_f32 v109, v109
    v_rcp_f32 v110, v110
    v_rcp_f32 v111, v111
    v_rcp_f32 v112, v112
    v_rcp_f32 v113, v113
    s_nop 0
    v_mul_f32 v142, v142, v104
    v_mul_f32 v143, v143, v105
    v_mul_f32 v144, v144, v106
    v_mul_f32 v145, v145, v107
    v_mul_f32 v146, v146, v108
    v_mul_f32 v147, v147, v109
    v_mul_f32 v148, v148, v110
    v_mul_f32 v149, v149, v111
    v_mul_f32 v150, v150, v112
    v_mul_f32 v151, v151, v113
    s_waitcnt lgkmcnt(0)
    v_pk_add_f32 v[44:45], v[44:45], v[160:161]
    v_pk_add_f32 v[46:47], v[46:47], v[162:163]
    v_pk_add_f32 v[48:49], v[48:49], v[164:165]
    v_pk_add_f32 v[50:51], v[50:51], v[166:167]
    v_pk_add_f32 v[52:53], v[52:53], v[168:169]
    v_pk_add_f32 v[54:55], v[54:55], v[170:171]
    v_pk_add_f32 v[56:57], v[56:57], v[172:173]
    v_pk_add_f32 v[58:59], v[58:59], v[174:175]
    v_pk_add_f32 v[60:61], v[60:61], v[176:177]
    v_pk_add_f32 v[62:63], v[62:63], v[178:179]
    v_pk_add_f32 v[44:45], v[44:45], v[180:181]
    v_pk_add_f32 v[46:47], v[46:47], v[182:183]
    v_pk_add_f32 v[48:49], v[48:49], v[184:185]
    v_pk_add_f32 v[50:51], v[50:51], v[186:187]
    v_pk_add_f32 v[52:53], v[52:53], v[188:189]
    v_pk_add_f32 v[54:55], v[54:55], v[190:191]
    v_pk_add_f32 v[56:57], v[56:57], v[192:193]
    v_pk_add_f32 v[58:59], v[58:59], v[194:195]
    v_pk_add_f32 v[60:61], v[60:61], v[196:197]
    v_pk_add_f32 v[62:63], v[62:63], v[198:199]
    v_pk_add_f32 v[44:45], v[44:45], v[200:201]
    v_pk_add_f32 v[46:47], v[46:47], v[202:203]
    v_pk_add_f32 v[48:49], v[48:49], v[204:205]
    v_pk_add_f32 v[50:51], v[50:51], v[206:207]
    v_pk_add_f32 v[52:53], v[52:53], v[208:209]
    v_pk_add_f32 v[54:55], v[54:55], v[210:211]
    v_pk_add_f32 v[56:57], v[56:57], v[212:213]
    v_pk_add_f32 v[58:59], v[58:59], v[214:215]
    v_pk_add_f32 v[60:61], v[60:61], v[216:217]
    v_pk_add_f32 v[62:63], v[62:63], v[218:219]
    v_pk_fma_f32 v[44:45], v[44:45], v[132:133], v[84:85]
    v_pk_fma_f32 v[46:47], v[46:47], v[134:135], v[86:87]
    v_pk_fma_f32 v[48:49], v[48:49], v[136:137], v[88:89]
    v_pk_fma_f32 v[50:51], v[50:51], v[138:139], v[90:91]
    v_pk_fma_f32 v[52:53], v[52:53], v[140:141], v[92:93]
    v_pk_fma_f32 v[54:55], v[54:55], v[142:143], v[94:95]
    v_pk_fma_f32 v[56:57], v[56:57], v[144:145], v[96:97]
    v_pk_fma_f32 v[58:59], v[58:59], v[146:147], v[98:99]
    v_pk_fma_f32 v[60:61], v[60:61], v[148:149], v[100:101]
    v_pk_fma_f32 v[62:63], v[62:63], v[150:151], v[102:103]
    v_cvt_pk_bf16_f32 v108, v44, v45
    v_cvt_pk_bf16_f32 v109, v46, v47
    v_cvt_pk_bf16_f32 v110, v48, v49
    v_cvt_pk_bf16_f32 v111, v50, v51
    v_cvt_pk_bf16_f32 v112, v52, v53
    v_cvt_pk_bf16_f32 v113, v54, v55
    v_cvt_pk_bf16_f32 v114, v56, v57
    v_cvt_pk_bf16_f32 v115, v58, v59
    v_cvt_pk_bf16_f32 v116, v60, v61
    v_cvt_pk_bf16_f32 v117, v62, v63
    ds_write_b64 v244, v[108:109] offset:0
    ds_write_b64 v244, v[110:111] offset:32
    ds_write_b64 v244, v[112:113] offset:64
    ds_write_b64 v244, v[114:115] offset:96
    ds_write_b64 v244, v[116:117] offset:128
    s_waitcnt lgkmcnt(0)
    ds_read_b128 v[160:163], v251
    ds_read_b128 v[164:167], v252
    ds_read_b128 v[168:171], v253
    s_waitcnt lgkmcnt(2)
    buffer_store_dwordx4 v[160:163], v248, s[12:15], s36 offen
    s_waitcnt lgkmcnt(1)
    buffer_store_dwordx4 v[164:167], v249, s[12:15], s36 offen
    s_waitcnt lgkmcnt(0)
    buffer_store_dwordx4 v[168:171], v250, s[12:15], s36 offen
    s_branch L_k3_fin
L_k3_w3:
    ds_write_b128 v156, v[4:7] offset:10240
    ds_write_b128 v156, v[8:11] offset:11264
    ds_write_b128 v156, v[12:15] offset:12288
    ds_write_b128 v156, v[16:19] offset:13312
    ds_write_b128 v156, v[20:23] offset:14336
    ds_write_b128 v156, v[24:27] offset:25600
    ds_write_b128 v156, v[28:31] offset:26624
    ds_write_b128 v156, v[32:35] offset:27648
    ds_write_b128 v156, v[36:39] offset:28672
    ds_write_b128 v156, v[40:43] offset:29696
    ds_write_b128 v156, v[44:47] offset:40960
    ds_write_b128 v156, v[48:51] offset:41984
    ds_write_b128 v156, v[52:55] offset:43008
    ds_write_b128 v156, v[56:59] offset:44032
    ds_write_b128 v156, v[60:63] offset:45056
    s_waitcnt lgkmcnt(0)
    s_barrier
    ds_read_b128 v[160:163], v156 offset:46080
    ds_read_b128 v[164:167], v156 offset:47104
    ds_read_b128 v[168:171], v156 offset:48128
    ds_read_b128 v[172:175], v156 offset:49152
    ds_read_b128 v[176:179], v156 offset:50176
    ds_read_b128 v[180:183], v156 offset:51200
    ds_read_b128 v[184:187], v156 offset:52224
    ds_read_b128 v[188:191], v156 offset:53248
    ds_read_b128 v[192:195], v156 offset:54272
    ds_read_b128 v[196:199], v156 offset:55296
    ds_read_b128 v[200:203], v156 offset:56320
    ds_read_b128 v[204:207], v156 offset:57344
    ds_read_b128 v[208:211], v156 offset:58368
    ds_read_b128 v[212:215], v156 offset:59392
    ds_read_b128 v[216:219], v156 offset:60416
    ds_read_b64 v[232:233], v244 offset:0
    ds_read_b64 v[234:235], v244 offset:32
    ds_read_b64 v[236:237], v244 offset:64
    ds_read_b64 v[238:239], v244 offset:96
    ds_read_b64 v[240:241], v244 offset:128
    s_waitcnt vmcnt(0) lgkmcnt(0)
    v_lshlrev_b32 v84, 16, v232
    v_and_b32 v85, 0xffff0000, v232
    v_lshlrev_b32 v86, 16, v233
    v_and_b32 v87, 0xffff0000, v233
    v_lshlrev_b32 v88, 16, v234
    v_and_b32 v89, 0xffff0000, v234
    v_lshlrev_b32 v90, 16, v235
    v_and_b32 v91, 0xffff0000, v235
    v_lshlrev_b32 v92, 16, v236
    v_and_b32 v93, 0xffff0000, v236
    v_lshlrev_b32 v94, 16, v237
    v_and_b32 v95, 0xffff0000, v237
    v_lshlrev_b32 v96, 16, v238
    v_and_b32 v97, 0xffff0000, v238
    v_lshlrev_b32 v98, 16, v239
    v_and_b32 v99, 0xffff0000, v239
    v_lshlrev_b32 v100, 16, v240
    v_and_b32 v101, 0xffff0000, v240
    v_lshlrev_b32 v102, 16, v241
    v_and_b32 v103, 0xffff0000, v241
    v_lshlrev_b32 v132, 16, v120
    v_and_b32 v133, 0xffff0000, v120
    v_lshlrev_b32 v134, 16, v121
    v_and_b32 v135, 0xffff0000, v121
    v_lshlrev_b32 v136, 16, v122
    v_and_b32 v137, 0xffff0000, v122
    v_lshlrev_b32 v138, 16, v123
    v_and_b32 v139, 0xffff0000, v123
    v_lshlrev_b32 v140, 16, v124
    v_and_b32 v141, 0xffff0000, v124
    v_lshlrev_b32 v142, 16, v125
    v_and_b32 v143, 0xffff0000, v125
    v_lshlrev_b32 v144, 16, v126
    v_and_b32 v145, 0xffff0000, v126
    v_lshlrev_b32 v146, 16, v127
    v_and_b32 v147, 0xffff0000, v127
    v_lshlrev_b32 v148, 16, v128
    v_and_b32 v149, 0xffff0000, v128
    v_lshlrev_b32 v150, 16, v129
    v_and_b32 v151, 0xffff0000, v129
    v_mul_f32 v104, 0xbfb8aa3b, v132
    v_mul_f32 v105, 0xbfb8aa3b, v133
    v_mul_f32 v106, 0xbfb8aa3b, v134
    v_mul_f32 v107, 0xbfb8aa3b, v135
    v_mul_f32 v108, 0xbfb8aa3b, v136
    v_mul_f32 v109, 0xbfb8aa3b, v137
    v_mul_f32 v110, 0xbfb8aa3b, v138
    v_mul_f32 v111, 0xbfb8aa3b, v139
    v_mul_f32 v112, 0xbfb8aa3b, v140
    v_mul_f32 v113, 0xbfb8aa3b, v141
    v_exp_f32 v104, v104
    v_exp_f32 v105, v105
    v_exp_f32 v106, v106
    v_exp_f32 v107, v107
    v_exp_f32 v108, v108
    v_exp_f32 v109, v109
    v_exp_f32 v110, v110
    v_exp_f32 v111, v111
    v_exp_f32 v112, v112
    v_exp_f32 v113, v113
    s_nop 0
    v_add_f32 v104, 1.0, v104
    v_add_f32 v105, 1.0, v105
    v_add_f32 v106, 1.0, v106
    v_add_f32 v107, 1.0, v107
    v_add_f32 v108, 1.0, v108
    v_add_f32 v109, 1.0, v109
    v_add_f32 v110, 1.0, v110
    v_add_f32 v111, 1.0, v111
    v_add_f32 v112, 1.0, v112
    v_add_f32 v113, 1.0, v113
    v_rcp_f32 v104, v104
    v_rcp_f32 v105, v105
    v_rcp_f32 v106, v106
    v_rcp_f32 v107, v107
    v_rcp_f32 v108, v108
    v_rcp_f32 v109, v109
    v_rcp_f32 v110, v110
    v_rcp_f32 v111, v111
    v_rcp_f32 v112, v112
    v_rcp_f32 v113, v113
    s_nop 0
    v_mul_f32 v132, v132, v104
    v_mul_f32 v133, v133, v105
    v_mul_f32 v134, v134, v106
    v_mul_f32 v135, v135, v107
    v_mul_f32 v136, v136, v108
    v_mul_f32 v137, v137, v109
    v_mul_f32 v138, v138, v110
    v_mul_f32 v139, v139, v111
    v_mul_f32 v140, v140, v112
    v_mul_f32 v141, v141, v113
    v_mul_f32 v104, 0xbfb8aa3b, v142
    v_mul_f32 v105, 0xbfb8aa3b, v143
    v_mul_f32 v106, 0xbfb8aa3b, v144
    v_mul_f32 v107, 0xbfb8aa3b, v145
    v_mul_f32 v108, 0xbfb8aa3b, v146
    v_mul_f32 v109, 0xbfb8aa3b, v147
    v_mul_f32 v110, 0xbfb8aa3b, v148
    v_mul_f32 v111, 0xbfb8aa3b, v149
    v_mul_f32 v112, 0xbfb8aa3b, v150
    v_mul_f32 v113, 0xbfb8aa3b, v151
    v_exp_f32 v104, v104
    v_exp_f32 v105, v105
    v_exp_f32 v106, v106
    v_exp_f32 v107, v107
    v_exp_f32 v108, v108
    v_exp_f32 v109, v109
    v_exp_f32 v110, v110
    v_exp_f32 v111, v111
    v_exp_f32 v112, v112
    v_exp_f32 v113, v113
    s_nop 0
    v_add_f32 v104, 1.0, v104
    v_add_f32 v105, 1.0, v105
    v_add_f32 v106, 1.0, v106
    v_add_f32 v107, 1.0, v107
    v_add_f32 v108, 1.0, v108
    v_add_f32 v109, 1.0, v109
    v_add_f32 v110, 1.0, v110
    v_add_f32 v111, 1.0, v111
    v_add_f32 v112, 1.0, v112
    v_add_f32 v113, 1.0, v113
    v_rcp_f32 v104, v104
    v_rcp_f32 v105, v105
    v_rcp_f32 v106, v106
    v_rcp_f32 v107, v107
    v_rcp_f32 v108, v108
    v_rcp_f32 v109, v109
    v_rcp_f32 v110, v110
    v_rcp_f32 v111, v111
    v_rcp_f32 v112, v112
    v_rcp_f32 v113, v113
    s_nop 0
    v_mul_f32 v142, v142, v104
    v_mul_f32 v143, v143, v105
    v_mul_f32 v144, v144, v106
    v_mul_f32 v145, v145, v107
    v_mul_f32 v146, v146, v108
    v_mul_f32 v147, v147, v109
    v_mul_f32 v148, v148, v110
    v_mul_f32 v149, v149, v111
    v_mul_f32 v150, v150, v112
    v_mul_f32 v151, v151, v113
    s_waitcnt lgkmcnt(0)
    v_pk_add_f32 v[64:65], v[64:65], v[160:161]
    v_pk_add_f32 v[66:67], v[66:67], v[162:163]
    v_pk_add_f32 v[68:69], v[68:69], v[164:165]
    v_pk_add_f32 v[70:71], v[70:71], v[166:167]
    v_pk_add_f32 v[72:73], v[72:73], v[168:169]
    v_pk_add_f32 v[74:75], v[74:75], v[170:171]
    v_pk_add_f32 v[76:77], v[76:77], v[172:173]
    v_pk_add_f32 v[78:79], v[78:79], v[174:175]
    v_pk_add_f32 v[80:81], v[80:81], v[176:177]
    v_pk_add_f32 v[82:83], v[82:83], v[178:179]
    v_pk_add_f32 v[64:65], v[64:65], v[180:181]
    v_pk_add_f32 v[66:67], v[66:67], v[182:183]
    v_pk_add_f32 v[68:69], v[68:69], v[184:185]
    v_pk_add_f32 v[70:71], v[70:71], v[186:187]
    v_pk_add_f32 v[72:73], v[72:73], v[188:189]
    v_pk_add_f32 v[74:75], v[74:75], v[190:191]
    v_pk_add_f32 v[76:77], v[76:77], v[192:193]
    v_pk_add_f32 v[78:79], v[78:79], v[194:195]
    v_pk_add_f32 v[80:81], v[80:81], v[196:197]
    v_pk_add_f32 v[82:83], v[82:83], v[198:199]
    v_pk_add_f32 v[64:65], v[64:65], v[200:201]
    v_pk_add_f32 v[66:67], v[66:67], v[202:203]
    v_pk_add_f32 v[68:69], v[68:69], v[204:205]
    v_pk_add_f32 v[70:71], v[70:71], v[206:207]
    v_pk_add_f32 v[72:73], v[72:73], v[208:209]
    v_pk_add_f32 v[74:75], v[74:75], v[210:211]
    v_pk_add_f32 v[76:77], v[76:77], v[212:213]
    v_pk_add_f32 v[78:79], v[78:79], v[214:215]
    v_pk_add_f32 v[80:81], v[80:81], v[216:217]
    v_pk_add_f32 v[82:83], v[82:83], v[218:219]
    v_pk_fma_f32 v[64:65], v[64:65], v[132:133], v[84:85]
    v_pk_fma_f32 v[66:67], v[66:67], v[134:135], v[86:87]
    v_pk_fma_f32 v[68:69], v[68:69], v[136:137], v[88:89]
    v_pk_fma_f32 v[70:71], v[70:71], v[138:139], v[90:91]
    v_pk_fma_f32 v[72:73], v[72:73], v[140:141], v[92:93]
    v_pk_fma_f32 v[74:75], v[74:75], v[142:143], v[94:95]
    v_pk_fma_f32 v[76:77], v[76:77], v[144:145], v[96:97]
    v_pk_fma_f32 v[78:79], v[78:79], v[146:147], v[98:99]
    v_pk_fma_f32 v[80:81], v[80:81], v[148:149], v[100:101]
    v_pk_fma_f32 v[82:83], v[82:83], v[150:151], v[102:103]
    v_cvt_pk_bf16_f32 v108, v64, v65
    v_cvt_pk_bf16_f32 v109, v66, v67
    v_cvt_pk_bf16_f32 v110, v68, v69
    v_cvt_pk_bf16_f32 v111, v70, v71
    v_cvt_pk_bf16_f32 v112, v72, v73
    v_cvt_pk_bf16_f32 v113, v74, v75
    v_cvt_pk_bf16_f32 v114, v76, v77
    v_cvt_pk_bf16_f32 v115, v78, v79
    v_cvt_pk_bf16_f32 v116, v80, v81
    v_cvt_pk_bf16_f32 v117, v82, v83
    ds_write_b64 v244, v[108:109] offset:0
    ds_write_b64 v244, v[110:111] offset:32
    ds_write_b64 v244, v[112:113] offset:64
    ds_write_b64 v244, v[114:115] offset:96
    ds_write_b64 v244, v[116:117] offset:128
    s_waitcnt lgkmcnt(0)
    ds_read_b128 v[160:163], v251
    ds_read_b128 v[164:167], v252
    ds_read_b128 v[168:171], v253
    s_waitcnt lgkmcnt(2)
    buffer_store_dwordx4 v[160:163], v248, s[12:15], s36 offen
    s_waitcnt lgkmcnt(1)
    buffer_store_dwordx4 v[164:167], v249, s[12:15], s36 offen
    s_waitcnt lgkmcnt(0)
    buffer_store_dwordx4 v[168:171], v250, s[12:15], s36 offen
L_k3_fin:
L_k3_end:
    s_endpgm
L_k3_codeend:
.section .rodata,"a"
.p2align 6
.amdhsa_kernel k12_kernel
  .amdhsa_next_free_vgpr 168
  .amdhsa_next_free_sgpr 100
  .amdhsa_accum_offset 168
  .amdhsa_group_segment_fixed_size 0
  .amdhsa_kernarg_size 80
  .amdhsa_user_sgpr_count 2
  .amdhsa_user_sgpr_kernarg_segment_ptr 1
  .amdhsa_system_sgpr_workgroup_id_x 1
.end_amdhsa_kernel
.p2align 6
.amdhsa_kernel k3_kernel
  .amdhsa_next_free_vgpr 256
  .amdhsa_next_free_sgpr 100
  .amdhsa_accum_offset 256
  .amdhsa_group_segment_fixed_size 0
  .amdhsa_kernarg_size 80
  .amdhsa_user_sgpr_count 2
  .amdhsa_user_sgpr_kernarg_segment_ptr 1
  .amdhsa_system_sgpr_workgroup_id_x 1
.end_amdhsa_kernel
```
